```python
import torch

def _softmax(x, axis=-1):
    return torch.softmax(x, dim=axis)

def _gelu(x):
    return torch.nn.functional.gelu(x, approximate='tanh')

def _silu(x):
    return torch.nn.functional.silu(x)

def _sigmoid(x):
    return torch.sigmoid(x)

def _layernorm(x, axis=-1, eps=1e-05):
    m = x.mean(dim=axis, keepdim=True)
    v = x.var(dim=axis, keepdim=True, unbiased=False)
    return (x - m) / torch.sqrt(v + eps)

def _scatter_add(tgt, idx, src, axis=0):
    return tgt.clone().index_add_(axis, idx, src)

def _segment_sum(src, seg, n):
    out = torch.zeros((n,) + src.shape[1:], dtype=src.dtype)
    return out.index_add_(0, seg, src)

def _pad(x, pw):
    flat = tuple((v for pair in reversed(pw) for v in pair))
    return torch.nn.functional.pad(x, flat)
kernel_name = 'adaLN_cond__softmax_full_mha__dense_activation_silu__prompt'

def setup_inputs():

    _w = lambda a: (lambda t: t.to(torch.bfloat16) if t.is_floating_point() else t)(torch.as_tensor(a))

    def _A_setup():
        B, S, D = (1, 2048, 512)
        return {'x': _w((lambda *s: torch.randn(*s, dtype=torch.bfloat16) * 0.05)(B, S, D)), 'wqkv': _w((lambda *s: torch.randn(*s, dtype=torch.bfloat16) * 0.05)(D, 3 * D)), 'wo': _w((lambda *s: torch.randn(*s, dtype=torch.bfloat16) * 0.05)(D, D))}
    _A_in = _A_setup()

    def _B_setup():
        B, S, D, F = (1, 2048, 512, 1792)
        return {'x': _w((lambda *s: torch.randn(*s, dtype=torch.bfloat16) * 0.05)(B, S, D)), 'w1': _w((lambda *s: torch.randn(*s, dtype=torch.bfloat16) * 3.2)(D, F) * D ** (-0.5)), 'w2': _w((lambda *s: torch.randn(*s, dtype=torch.bfloat16) * 0.2)(F, D) * F ** (-0.5))}
    _B_in = _B_setup()
    return {'A_x': _A_in['x'], 'A_wqkv': _A_in['wqkv'], 'A_wo': _A_in['wo'], 'B_x': _B_in['x'], 'B_w1': _B_in['w1'], 'B_w2': _B_in['w2'], 'c': _w((lambda *s: torch.randn(*s, dtype=torch.bfloat16) * 0.1)(1, 512) * 8.0), 'w_mod': _w((lambda *s: torch.randn(*s, dtype=torch.bfloat16) * 0.1)(512, 6 * 512) * 512 ** (-0.5) * 8.0)}

def reference(A_x, A_wqkv, A_wo, B_x, B_w1, B_w2, c, w_mod):

    def _A_ref(x, wqkv, wo):
        B, S, D = x.shape
        H = 32
        Dh = D // H
        qkv = (lambda x, *d: x.permute(*d))((x @ wqkv).reshape(B, S, 3, H, Dh), 2, 0, 3, 1, 4)
        q, k, v = (qkv[0], qkv[1], qkv[2])
        scale = Dh ** (-0.5)
        scores = torch.einsum('bhqd,bhkd->bhqk', q, k) * scale
        p = _softmax(scores, axis=-1)
        o = torch.einsum('bhqk,bhkd->bhqd', p, v)
        return (lambda x, *d: x.permute(*d))(o, 0, 2, 1, 3).reshape(B, S, D) @ wo

    def _B_ref(x, w1, w2):
        h = torch.einsum('bsd,df->bsf', x, w1)
        h = _silu(h)
        out = torch.einsum('bsf,fd->bsd', h, w2)
        return out
    x = A_x
    mod = (_silu(c) @ w_mod).reshape(c.shape[0], 6, 1, -1)
    sa, ca, ga, sb, cb, gb = (mod[:, 0].clone(), mod[:, 1].clone(), mod[:, 2].clone(), mod[:, 3].clone(), mod[:, 4].clone(), mod[:, 5].clone())
    h = _layernorm(x, axis=-1) * (1 + ca) + sa
    x = x + ga * _A_ref(h, A_wqkv, A_wo)
    h = _layernorm(x, axis=-1) * (1 + cb) + sb
    x = x + gb * _B_ref(h, B_w1, B_w2)
    return x
```

```asm
; @launch grid=(256,1,1) block=(512,1,1) lds=163840
.amdgcn_target "amdgcn-amd-amdhsa--gfx950"
.text
.globl adaLN_cond__softmax_full_mha__dense_activation_silu__prompt_kernel
.p2align 8
.type adaLN_cond__softmax_full_mha__dense_activation_silu__prompt_kernel,@function
adaLN_cond__softmax_full_mha__dense_activation_silu__prompt_kernel:
    s_cmp_ge_u32 s2, 256
    s_cbranch_scc1 Lend
    s_load_dwordx2 s[4:5], s[0:1], 0
    s_load_dwordx2 s[36:37], s[0:1], 72
    s_load_dwordx2 s[28:29], s[0:1], 56
    s_load_dwordx2 s[24:25], s[0:1], 48
    s_load_dwordx2 s[8:9], s[0:1], 8
    s_load_dwordx2 s[40:41], s[0:1], 80
    s_load_dwordx2 s[12:13], s[0:1], 16
    s_load_dwordx2 s[16:17], s[0:1], 32
    s_load_dwordx2 s[20:21], s[0:1], 40
    s_load_dwordx2 s[32:33], s[0:1], 64
    v_lshrrev_b32 v4, 6, v0
    v_and_b32 v1, 63, v0
    v_mov_b32 v3, 0
    v_readfirstlane_b32 s44, v4
    v_lshlrev_b32 v2, 4, v1
    s_getpc_b64 s[56:57]
Lpc:
    s_sub_u32 s56, s56, Lpc-adaLN_cond__softmax_full_mha__dense_activation_silu__prompt_kernel
    s_subb_u32 s57, s57, 0
    s_and_b32 s49, s2, 7
    s_lshr_b32 s48, s2, 3
    s_sub_u32 s67, s44, 4
    s_cmp_lt_u32 s44, 6
    s_cbranch_scc1 Le_nopf
    s_lshl_b32 s58, s48, 1
    s_add_u32 s58, s58, s67
    s_sub_u32 s58, s58, 2
    s_lshl_b32 s58, s58, 10
    s_min_u32 s58, s58, Lcode_end-adaLN_cond__softmax_full_mha__dense_activation_silu__prompt_kernel-1024
    v_add_u32 v5, s58, v2
    global_load_dwordx4 v[16:19], v5, s[56:57]
Le_nopf:
    s_lshr_b32 s45, s49, 1
    s_lshl_b32 s45, s45, 2
    s_lshr_b32 s52, s48, 3
    s_add_u32 s45, s45, s52
    s_and_b32 s69, s48, 7
    s_and_b32 s46, s49, 1
    s_lshl_b32 s46, s46, 3
    s_add_u32 s46, s46, s69
    s_mov_b32 s6, 0x200000
    s_mov_b32 s7, 0x20000
    s_mov_b32 s38, 0x100
    s_mov_b32 s39, 0x20000
    s_mov_b32 s30, 0x300000
    s_mov_b32 s31, 0x20000
    s_mov_b32 s26, 0x400
    s_mov_b32 s27, 0x20000
    s_mov_b32 s10, 0x180000
    s_mov_b32 s11, 0x20000
    s_mov_b32 s42, 0x1700000
    s_mov_b32 s43, 0x20000
    s_memrealtime s[54:55]
    s_cmp_ge_u32 s44, 4
    s_cbranch_scc1 Lp0_h
    s_cmp_lt_u32 s48, 8
    s_cbranch_scc1 Lp0_mod
    s_cmp_ge_u32 s48, 24
    s_cbranch_scc1 Lp0_warm
    s_and_b32 s52, s49, 1
    s_lshl_b32 s52, s52, 4
    s_add_u32 s52, s52, s48
    s_sub_u32 s52, s52, 8
    s_lshl_b32 s52, s52, 2
    s_add_u32 s52, s52, s44
    s_lshr_b32 s53, s49, 1
    s_lshl_b32 s53, s53, 7
    s_add_u32 s56, s52, s53
    s_lshl_b32 s53, s56, 12
    v_and_b32 v4, 3, v1
    v_lshrrev_b32 v5, 2, v1
    v_lshlrev_b32 v6, 10, v4
    v_lshl_add_u32 v6, v5, 4, v6
    s_waitcnt lgkmcnt(0)
    buffer_load_dwordx4 v[16:19], v6, s[4:7], s53 offen offset:0
    buffer_load_dwordx4 v[20:23], v6, s[4:7], s53 offen offset:256
    buffer_load_dwordx4 v[24:27], v6, s[4:7], s53 offen offset:512
    buffer_load_dwordx4 v[28:31], v6, s[4:7], s53 offen offset:768
    s_mov_b32 s14, 0x80000
    s_mov_b32 s15, 0x20000
    s_mov_b32 s18, 0x1c0000
    s_mov_b32 s19, 0x20000
    s_mov_b32 s22, 0x1c0000
    s_mov_b32 s23, 0x20000
    s_mov_b32 s34, 0x200000
    s_mov_b32 s35, 0x20000
    v_mov_b32 v8, 160512
    v_mov_b32 v10, 0
    v_mov_b32 v11, 0
    ds_write_b64 v8, v[10:11]
    ds_write_b64 v8, v[10:11] offset:8
    ds_write_b64 v8, v[10:11] offset:16
    ds_write_b64 v8, v[10:11] offset:24
    ds_write_b64 v8, v[10:11] offset:32
    ds_write_b64 v8, v[10:11] offset:40
    s_waitcnt lgkmcnt(0)
    s_barrier
    v_lshrrev_b32 v7, 1, v5
    v_lshlrev_b32 v7, 10, v7
    v_and_b32 v8, 1, v5
    v_lshl_add_u32 v7, v8, 9, v7
    v_lshl_add_u32 v7, v4, 4, v7
    s_lshr_b32 s53, s56, 3
    s_lshl_b32 s53, s53, 15
    s_and_b32 s54, s56, 7
    s_lshl_b32 s54, s54, 6
    s_add_u32 s53, s53, s54
    s_add_u32 s53, s53, 0x200000
    s_lshr_b32 s50, s56, 3
    s_lshl_b32 s50, s50, 7
    s_and_b32 s55, s56, 7
    s_lshl_b32 s55, s55, 2
    s_add_u32 s55, s55, s50
    s_add_u32 s55, s55, 0x50000
    s_waitcnt vmcnt(0)
    buffer_load_dword v15, v3, s[36:39], 0 offen sc1
    v_lshlrev_b32 v32, 16, v16
    v_and_b32 v33, 0xffff0000, v16
    v_lshlrev_b32 v34, 16, v17
    v_and_b32 v35, 0xffff0000, v17
    v_lshlrev_b32 v36, 16, v18
    v_and_b32 v37, 0xffff0000, v18
    v_lshlrev_b32 v38, 16, v19
    v_and_b32 v39, 0xffff0000, v19
    v_lshlrev_b32 v40, 16, v20
    v_and_b32 v41, 0xffff0000, v20
    v_lshlrev_b32 v42, 16, v21
    v_and_b32 v43, 0xffff0000, v21
    v_lshlrev_b32 v44, 16, v22
    v_and_b32 v45, 0xffff0000, v22
    v_lshlrev_b32 v46, 16, v23
    v_and_b32 v47, 0xffff0000, v23
    v_lshlrev_b32 v48, 16, v24
    v_and_b32 v49, 0xffff0000, v24
    v_lshlrev_b32 v50, 16, v25
    v_and_b32 v51, 0xffff0000, v25
    v_lshlrev_b32 v52, 16, v26
    v_and_b32 v53, 0xffff0000, v26
    v_lshlrev_b32 v54, 16, v27
    v_and_b32 v55, 0xffff0000, v27
    v_lshlrev_b32 v56, 16, v28
    v_and_b32 v57, 0xffff0000, v28
    v_lshlrev_b32 v58, 16, v29
    v_and_b32 v59, 0xffff0000, v29
    v_lshlrev_b32 v60, 16, v30
    v_and_b32 v61, 0xffff0000, v30
    v_lshlrev_b32 v62, 16, v31
    v_and_b32 v63, 0xffff0000, v31
    v_pk_add_f32 v[64:65], v[32:33], v[34:35]
    v_pk_add_f32 v[66:67], v[36:37], v[38:39]
    v_pk_add_f32 v[64:65], v[64:65], v[40:41]
    v_pk_add_f32 v[66:67], v[66:67], v[42:43]
    v_pk_add_f32 v[64:65], v[64:65], v[44:45]
    v_pk_add_f32 v[66:67], v[66:67], v[46:47]
    v_pk_add_f32 v[64:65], v[64:65], v[48:49]
    v_pk_add_f32 v[66:67], v[66:67], v[50:51]
    v_pk_add_f32 v[64:65], v[64:65], v[52:53]
    v_pk_add_f32 v[66:67], v[66:67], v[54:55]
    v_pk_add_f32 v[64:65], v[64:65], v[56:57]
    v_pk_add_f32 v[66:67], v[66:67], v[58:59]
    v_pk_add_f32 v[64:65], v[64:65], v[60:61]
    v_pk_add_f32 v[66:67], v[66:67], v[62:63]
    v_pk_add_f32 v[64:65], v[64:65], v[66:67]
    v_add_f32 v64, v64, v65
    s_nop 1
    v_add_f32_dpp v64, v64, v64 row_ror:4 row_mask:0xf bank_mask:0xf
    s_nop 1
    v_add_f32_dpp v64, v64, v64 row_ror:8 row_mask:0xf bank_mask:0xf
    v_mov_b32 v65, v64
    s_nop 1
    v_permlane16_swap_b32 v64, v65
    v_add_f32 v64, v64, v65
    v_mov_b32 v65, v64
    s_nop 1
    v_permlane32_swap_b32 v64, v65
    v_add_f32 v64, v64, v65
    v_mul_f32 v64, 0xbb000000, v64
    v_pk_add_f32 v[32:33], v[32:33], v[64:65] op_sel_hi:[1,0]
    v_pk_add_f32 v[34:35], v[34:35], v[64:65] op_sel_hi:[1,0]
    v_pk_add_f32 v[36:37], v[36:37], v[64:65] op_sel_hi:[1,0]
    v_pk_add_f32 v[38:39], v[38:39], v[64:65] op_sel_hi:[1,0]
    v_pk_add_f32 v[40:41], v[40:41], v[64:65] op_sel_hi:[1,0]
    v_pk_add_f32 v[42:43], v[42:43], v[64:65] op_sel_hi:[1,0]
    v_pk_add_f32 v[44:45], v[44:45], v[64:65] op_sel_hi:[1,0]
    v_pk_add_f32 v[46:47], v[46:47], v[64:65] op_sel_hi:[1,0]
    v_pk_add_f32 v[48:49], v[48:49], v[64:65] op_sel_hi:[1,0]
    v_pk_add_f32 v[50:51], v[50:51], v[64:65] op_sel_hi:[1,0]
    v_pk_add_f32 v[52:53], v[52:53], v[64:65] op_sel_hi:[1,0]
    v_pk_add_f32 v[54:55], v[54:55], v[64:65] op_sel_hi:[1,0]
    v_pk_add_f32 v[56:57], v[56:57], v[64:65] op_sel_hi:[1,0]
    v_pk_add_f32 v[58:59], v[58:59], v[64:65] op_sel_hi:[1,0]
    v_pk_add_f32 v[60:61], v[60:61], v[64:65] op_sel_hi:[1,0]
    v_pk_add_f32 v[62:63], v[62:63], v[64:65] op_sel_hi:[1,0]
    v_pk_mul_f32 v[66:67], v[32:33], v[32:33]
    v_pk_mul_f32 v[68:69], v[34:35], v[34:35]
    v_pk_fma_f32 v[66:67], v[36:37], v[36:37], v[66:67]
    v_pk_fma_f32 v[68:69], v[38:39], v[38:39], v[68:69]
    v_pk_fma_f32 v[66:67], v[40:41], v[40:41], v[66:67]
    v_pk_fma_f32 v[68:69], v[42:43], v[42:43], v[68:69]
    v_pk_fma_f32 v[66:67], v[44:45], v[44:45], v[66:67]
    v_pk_fma_f32 v[68:69], v[46:47], v[46:47], v[68:69]
    v_pk_fma_f32 v[66:67], v[48:49], v[48:49], v[66:67]
    v_pk_fma_f32 v[68:69], v[50:51], v[50:51], v[68:69]
    v_pk_fma_f32 v[66:67], v[52:53], v[52:53], v[66:67]
    v_pk_fma_f32 v[68:69], v[54:55], v[54:55], v[68:69]
    v_pk_fma_f32 v[66:67], v[56:57], v[56:57], v[66:67]
    v_pk_fma_f32 v[68:69], v[58:59], v[58:59], v[68:69]
    v_pk_fma_f32 v[66:67], v[60:61], v[60:61], v[66:67]
    v_pk_fma_f32 v[68:69], v[62:63], v[62:63], v[68:69]
    v_pk_add_f32 v[66:67], v[66:67], v[68:69]
    v_add_f32 v66, v66, v67
    s_nop 1
    v_add_f32_dpp v66, v66, v66 row_ror:4 row_mask:0xf bank_mask:0xf
    s_nop 1
    v_add_f32_dpp v66, v66, v66 row_ror:8 row_mask:0xf bank_mask:0xf
    v_mov_b32 v67, v66
    s_nop 1
    v_permlane16_swap_b32 v66, v67
    v_add_f32 v66, v66, v67
    v_mov_b32 v67, v66
    s_nop 1
    v_permlane32_swap_b32 v66, v67
    v_add_f32 v66, v66, v67
    v_mov_b32 v67, 0x3727c5ac
    v_fmac_f32 v67, 0x3b000000, v66
    v_rsq_f32 v66, v67
    s_nop 0
    v_pk_mul_f32 v[32:33], v[32:33], v[66:67] op_sel_hi:[1,0]
    v_pk_mul_f32 v[34:35], v[34:35], v[66:67] op_sel_hi:[1,0]
    v_pk_mul_f32 v[36:37], v[36:37], v[66:67] op_sel_hi:[1,0]
    v_pk_mul_f32 v[38:39], v[38:39], v[66:67] op_sel_hi:[1,0]
    v_pk_mul_f32 v[40:41], v[40:41], v[66:67] op_sel_hi:[1,0]
    v_pk_mul_f32 v[42:43], v[42:43], v[66:67] op_sel_hi:[1,0]
    v_pk_mul_f32 v[44:45], v[44:45], v[66:67] op_sel_hi:[1,0]
    v_pk_mul_f32 v[46:47], v[46:47], v[66:67] op_sel_hi:[1,0]
    v_pk_mul_f32 v[48:49], v[48:49], v[66:67] op_sel_hi:[1,0]
    v_pk_mul_f32 v[50:51], v[50:51], v[66:67] op_sel_hi:[1,0]
    v_pk_mul_f32 v[52:53], v[52:53], v[66:67] op_sel_hi:[1,0]
    v_pk_mul_f32 v[54:55], v[54:55], v[66:67] op_sel_hi:[1,0]
    v_pk_mul_f32 v[56:57], v[56:57], v[66:67] op_sel_hi:[1,0]
    v_pk_mul_f32 v[58:59], v[58:59], v[66:67] op_sel_hi:[1,0]
    v_pk_mul_f32 v[60:61], v[60:61], v[66:67] op_sel_hi:[1,0]
    v_pk_mul_f32 v[62:63], v[62:63], v[66:67] op_sel_hi:[1,0]
    v_cvt_pk_bf16_f32 v16, v32, v33
    v_cvt_pk_bf16_f32 v17, v34, v35
    v_cvt_pk_bf16_f32 v18, v36, v37
    v_cvt_pk_bf16_f32 v19, v38, v39
    buffer_store_dwordx4 v[16:19], v7, s[40:43], s53 offen sc1
    s_add_u32 s53, s53, 8192
    v_cvt_pk_bf16_f32 v20, v40, v41
    v_cvt_pk_bf16_f32 v21, v42, v43
    v_cvt_pk_bf16_f32 v22, v44, v45
    v_cvt_pk_bf16_f32 v23, v46, v47
    buffer_store_dwordx4 v[20:23], v7, s[40:43], s53 offen sc1
    s_add_u32 s53, s53, 8192
    v_cvt_pk_bf16_f32 v24, v48, v49
    v_cvt_pk_bf16_f32 v25, v50, v51
    v_cvt_pk_bf16_f32 v26, v52, v53
    v_cvt_pk_bf16_f32 v27, v54, v55
    buffer_store_dwordx4 v[24:27], v7, s[40:43], s53 offen sc1
    s_add_u32 s53, s53, 8192
    v_cvt_pk_bf16_f32 v28, v56, v57
    v_cvt_pk_bf16_f32 v29, v58, v59
    v_cvt_pk_bf16_f32 v30, v60, v61
    v_cvt_pk_bf16_f32 v31, v62, v63
    buffer_store_dwordx4 v[28:31], v7, s[40:43], s53 offen sc1
    s_waitcnt vmcnt(0)
    s_mov_b32 s50, 20000
Ltn1:
    v_readfirstlane_b32 s47, v15
    s_sub_u32 s50, s50, 1
    s_cmp_lg_u32 s47, 0
    s_cbranch_scc1 Ltnd1
    s_cmp_eq_u32 s50, 0
    s_cbranch_scc1 Ltnd1
    buffer_load_dword v15, v3, s[36:39], 0 offen sc1
    s_waitcnt vmcnt(0)
    s_branch Ltn1
Ltnd1:
    s_waitcnt vmcnt(0)
    v_mov_b32 v8, s47
    s_mov_b64 exec, 1
    buffer_store_dword v8, v3, s[40:43], s55 offen sc1
    s_mov_b64 exec, -1
    v_mov_b32 v8, s47
    v_mov_b32 v9, 160516
    ds_write_b32 v9, v8
    s_waitcnt lgkmcnt(0)
    s_barrier
    s_branch La_p1
Lp0_h:
    v_mov_b32 v32, 0
    v_mov_b32 v33, 0
    v_mov_b32 v34, 0
    v_mov_b32 v35, 0
    s_lshl_b32 s52, s67, 12
    s_add_u32 s52, s52, 98304
    v_add_u32 v9, s52, v2
    ds_write_b128 v9, v[32:35] offset:0
    ds_write_b128 v9, v[32:35] offset:1024
    ds_write_b128 v9, v[32:35] offset:2048
    ds_write_b128 v9, v[32:35] offset:3072
    s_lshl_b32 s52, s2, 2
    s_add_u32 s52, s52, s67
    s_and_b32 s53, s52, 1
    s_lshr_b32 s52, s52, 1
    s_mul_i32 s52, s52, 3072
    s_lshl_b32 s57, s53, 9
    s_add_u32 s57, s57, s52
    s_lshl_b32 s53, s53, 10
    s_add_u32 s52, s52, s53
    s_add_u32 s52, s52, 1024
    s_waitcnt lgkmcnt(0)
    s_andn2_b32 s58, s2, 4
    s_lshl_b32 s58, s58, 3
    s_add_u32 s58, s58, s44
    s_cmp_lg_u32 s58, 516
    s_cbranch_scc1 Le_notag
    s_or_b32 s54, s54, 1
    v_mov_b32 v6, s54
    v_mov_b32 v7, 0
    s_mov_b64 exec, 1
    buffer_atomic_cmpswap v[6:7], v3, s[36:39], 0 offen sc1
    s_mov_b64 exec, -1
Le_notag:
    s_buffer_load_dwordx2 s[0:1], s[8:11], s52 offset:60
    s_mov_b32 s14, 0x80000
    s_mov_b32 s15, 0x20000
    s_mov_b32 s18, 0x1c0000
    s_mov_b32 s19, 0x20000
    s_mov_b32 s22, 0x1c0000
    s_mov_b32 s23, 0x20000
    s_mov_b32 s34, 0x200000
    s_mov_b32 s35, 0x20000
    s_barrier
    s_waitcnt lgkmcnt(0)
    s_buffer_load_dwordx2 s[0:1], s[8:11], s52 offset:188
    s_buffer_load_dwordx2 s[0:1], s[8:11], s52 offset:316
    s_buffer_load_dwordx2 s[0:1], s[8:11], s52 offset:444
    s_buffer_load_dwordx2 s[0:1], s[8:11], s52 offset:572
    s_buffer_load_dwordx2 s[0:1], s[8:11], s52 offset:700
    s_buffer_load_dwordx2 s[0:1], s[8:11], s52 offset:828
    s_buffer_load_dwordx2 s[0:1], s[8:11], s52 offset:956
    s_buffer_load_dwordx2 s[0:1], s[8:11], s57 offset:60
    s_buffer_load_dwordx2 s[0:1], s[8:11], s57 offset:188
    s_buffer_load_dwordx2 s[0:1], s[8:11], s57 offset:316
    s_buffer_load_dwordx2 s[0:1], s[8:11], s57 offset:444
    v_lshrrev_b32 v4, 3, v1
    v_mul_u32_u24 v4, 3072, v4
    v_bfe_u32 v5, v1, 4, 1
    v_lshlrev_b32 v5, 2, v5
    v_xor_b32 v5, v5, v1
    v_and_b32 v5, 7, v5
    v_lshl_add_u32 v12, v5, 4, v4
    s_and_b32 s56, s46, 1
    s_add_u32 s56, s56, 1
    s_lshl_b32 s56, s56, 10
    s_lshr_b32 s52, s46, 1
    s_lshl_b32 s52, s52, 7
    s_add_u32 s56, s56, s52
    s_and_b32 s55, s45, 3
    s_lshl_b32 s55, s55, 3
    s_add_u32 s55, s55, s67
    s_lshl_b32 s57, s69, 2
    s_mov_b32 s51, 8
    s_barrier
Lh_wl:
    s_and_b32 s55, s55, 31
    s_lshl_b32 s53, s55, 11
    s_add_u32 s52, s55, s57
    s_and_b32 s52, s52, 31
    s_mul_i32 s52, s52, 49152
    s_mov_b32 m0, s53
    s_add_u32 s52, s52, s56
    buffer_load_dwordx4 v12, s[8:11], s52 offen lds
    s_add_u32 m0, s53, 1024
    s_add_u32 s52, s52, 24576
    buffer_load_dwordx4 v12, s[8:11], s52 offen lds
    s_add_u32 s55, s55, 4
    s_sub_u32 s51, s51, 1
    s_cmp_lg_u32 s51, 0
    s_cbranch_scc1 Lh_wl
    v_mov_b32 v8, 160516
    s_mov_b32 s50, 400000
Ltg2:
    ds_read_b32 v9, v8
    s_sub_u32 s50, s50, 1
    s_waitcnt lgkmcnt(0)
    v_readfirstlane_b32 s47, v9
    s_nop 0
    s_cmp_lg_u32 s47, 0
    s_cbranch_scc1 Ltgd2
    s_cmp_lg_u32 s50, 0
    s_cbranch_scc1 Ltg2
Ltgd2:
    s_cmp_ge_u32 s67, 2
    s_cbranch_scc1 Lh_b2
    s_lshl_b32 s52, s67, 11
    v_lshrrev_b32 v5, 3, v1
    s_lshl_b32 s53, s69, 1
    v_subrev_u32 v5, s53, v5
    v_and_b32 v5, 15, v5
    v_xor_b32 v6, 8, v5
    s_mov_b32 s50, 20000
Lgp3:
    buffer_load_dwordx4 v[16:19], v2, s[40:43], s52 offen sc1
    buffer_load_dwordx4 v[20:23], v2, s[40:43], s52 offen offset:1024 sc1
    s_waitcnt vmcnt(0)
    v_xor_b32 v15, s47, v17
    v_xor_b32 v14, s47, v19
    v_or_b32 v15, v15, v14
    v_xor_b32 v14, s47, v21
    v_or_b32 v15, v15, v14
    v_xor_b32 v14, s47, v23
    v_or_b32 v15, v15, v14
    v_cmp_ne_u32 vcc, 0, v15
    s_sub_u32 s50, s50, 1
    s_cbranch_vccz Lgpd3
    s_sleep 1
    s_cmp_lg_u32 s50, 0
    s_cbranch_scc1 Lgp3
Lgpd3:
    s_cmp_lg_u32 s67, 0
    s_cbranch_scc1 Lh_g1
    v_lshlrev_b32 v24, 16, v16
    v_and_b32 v25, 0xffff0000, v16
    v_lshlrev_b32 v26, 16, v18
    v_and_b32 v27, 0xffff0000, v18
    v_lshlrev_b32 v28, 16, v20
    v_and_b32 v29, 0xffff0000, v20
    v_lshlrev_b32 v30, 16, v22
    v_and_b32 v31, 0xffff0000, v22
    v_and_b32 v7, 1, v1
    v_lshlrev_b32 v7, 6, v7
    v_bfe_u32 v9, v1, 1, 2
    v_lshl_add_u32 v7, v9, 4, v7
    v_add_u32 v7, 114688, v7
    v_lshl_add_u32 v5, v5, 7, v7
    v_lshl_add_u32 v6, v6, 7, v7
    ds_write_b128 v5, v[24:27]
    ds_write_b128 v6, v[28:31]
    s_branch Lh_b2
Lh_g1:
    v_and_b32 v7, 7, v1
    v_lshlrev_b32 v7, 6, v7
    v_bfe_u32 v9, v1, 2, 1
    v_lshl_add_u32 v7, v9, 9, v7
    v_and_b32 v9, 3, v1
    v_lshl_add_u32 v7, v9, 2, v7
    v_add_u32 v7, 98304, v7
    v_lshl_add_u32 v5, v5, 10, v7
    v_lshl_add_u32 v6, v6, 10, v7
    ds_write_b16 v5, v16 offset:0
    ds_write_b16_d16_hi v5, v16 offset:18
    ds_write_b16 v5, v18 offset:32
    ds_write_b16_d16_hi v5, v18 offset:50
    ds_write_b16 v6, v20 offset:0
    ds_write_b16_d16_hi v6, v20 offset:18
    ds_write_b16 v6, v22 offset:32
    ds_write_b16_d16_hi v6, v22 offset:50
    s_branch Lh_b2
Lp0_mod:
    s_lshl_b32 s51, s49, 1
    s_lshr_b32 s52, s48, 2
    s_add_u32 s51, s51, s52
    s_lshl_b32 s51, s51, 6
    s_and_b32 s52, s48, 3
    s_lshl_b32 s52, s52, 4
    s_add_u32 s51, s51, s52
    s_waitcnt lgkmcnt(0)
    v_bfe_u32 v4, v0, 1, 7
    v_and_b32 v5, 1, v0
    v_mul_u32_u24 v6, 6144, v4
    v_lshl_add_u32 v6, v5, 4, v6
    v_lshlrev_b32 v7, 1, v4
    s_lshl_b32 s52, s51, 1
    buffer_load_dwordx4 v[16:19], v6, s[28:31], s52 offen
    s_add_u32 s52, s52, 786432
    buffer_load_dwordx4 v[20:23], v6, s[28:31], s52 offen
    s_add_u32 s52, s52, 786432
    buffer_load_dwordx4 v[24:27], v6, s[28:31], s52 offen
    s_add_u32 s52, s52, 786432
    buffer_load_dwordx4 v[28:31], v6, s[28:31], s52 offen
    buffer_load_ushort v32, v7, s[24:27], 0 offen offset:0
    buffer_load_ushort v33, v7, s[24:27], 0 offen offset:256
    buffer_load_ushort v34, v7, s[24:27], 0 offen offset:512
    buffer_load_ushort v35, v7, s[24:27], 0 offen offset:768
    s_mov_b32 s14, 0x80000
    s_mov_b32 s15, 0x20000
    s_mov_b32 s18, 0x1c0000
    s_mov_b32 s19, 0x20000
    s_mov_b32 s22, 0x1c0000
    s_mov_b32 s23, 0x20000
    s_mov_b32 s34, 0x200000
    s_mov_b32 s35, 0x20000
    v_mov_b32 v8, 160512
    v_mov_b32 v10, 0
    v_mov_b32 v11, 0
    ds_write_b64 v8, v[10:11]
    ds_write_b64 v8, v[10:11] offset:8
    ds_write_b64 v8, v[10:11] offset:16
    ds_write_b64 v8, v[10:11] offset:24
    ds_write_b64 v8, v[10:11] offset:32
    ds_write_b64 v8, v[10:11] offset:40
    s_waitcnt lgkmcnt(0)
    s_barrier
    s_waitcnt vmcnt(0)
    buffer_load_dword v15, v3, s[36:39], 0 offen sc1
    v_lshlrev_b32 v32, 16, v32
    v_lshlrev_b32 v33, 16, v33
    v_lshlrev_b32 v34, 16, v34
    v_lshlrev_b32 v35, 16, v35
    v_mul_f32 v36, 0xbfb8aa3b, v32
    v_mul_f32 v37, 0xbfb8aa3b, v33
    v_mul_f32 v38, 0xbfb8aa3b, v34
    v_mul_f32 v39, 0xbfb8aa3b, v35
    v_exp_f32 v36, v36
    v_exp_f32 v37, v37
    v_exp_f32 v38, v38
    v_exp_f32 v39, v39
    v_add_f32 v36, 1.0, v36
    v_add_f32 v37, 1.0, v37
    v_add_f32 v38, 1.0, v38
    v_add_f32 v39, 1.0, v39
    v_rcp_f32 v36, v36
    v_rcp_f32 v37, v37
    v_rcp_f32 v38, v38
    v_rcp_f32 v39, v39
    v_mul_f32 v32, v32, v36
    v_mul_f32 v33, v33, v37
    v_mul_f32 v34, v34, v38
    v_mul_f32 v35, v35, v39
    v_cvt_pk_bf16_f32 v32, v32, v32
    v_cvt_pk_bf16_f32 v33, v33, v33
    v_cvt_pk_bf16_f32 v34, v34, v34
    v_cvt_pk_bf16_f32 v35, v35, v35
    v_lshlrev_b32 v32, 16, v32
    v_lshlrev_b32 v33, 16, v33
    v_lshlrev_b32 v34, 16, v34
    v_lshlrev_b32 v35, 16, v35
    v_lshlrev_b32 v40, 16, v16
    v_and_b32 v41, 0xffff0000, v16
    v_lshlrev_b32 v42, 16, v17
    v_and_b32 v43, 0xffff0000, v17
    v_lshlrev_b32 v44, 16, v18
    v_and_b32 v45, 0xffff0000, v18
    v_lshlrev_b32 v46, 16, v19
    v_and_b32 v47, 0xffff0000, v19
    v_mul_f32 v48, v40, v32
    v_mul_f32 v49, v41, v32
    v_mul_f32 v50, v42, v32
    v_mul_f32 v51, v43, v32
    v_mul_f32 v52, v44, v32
    v_mul_f32 v53, v45, v32
    v_mul_f32 v54, v46, v32
    v_mul_f32 v55, v47, v32
    v_lshlrev_b32 v40, 16, v20
    v_and_b32 v41, 0xffff0000, v20
    v_lshlrev_b32 v42, 16, v21
    v_and_b32 v43, 0xffff0000, v21
    v_lshlrev_b32 v44, 16, v22
    v_and_b32 v45, 0xffff0000, v22
    v_lshlrev_b32 v46, 16, v23
    v_and_b32 v47, 0xffff0000, v23
    v_fmac_f32 v48, v40, v33
    v_fmac_f32 v49, v41, v33
    v_fmac_f32 v50, v42, v33
    v_fmac_f32 v51, v43, v33
    v_fmac_f32 v52, v44, v33
    v_fmac_f32 v53, v45, v33
    v_fmac_f32 v54, v46, v33
    v_fmac_f32 v55, v47, v33
    v_lshlrev_b32 v40, 16, v24
    v_and_b32 v41, 0xffff0000, v24
    v_lshlrev_b32 v42, 16, v25
    v_and_b32 v43, 0xffff0000, v25
    v_lshlrev_b32 v44, 16, v26
    v_and_b32 v45, 0xffff0000, v26
    v_lshlrev_b32 v46, 16, v27
    v_and_b32 v47, 0xffff0000, v27
    v_fmac_f32 v48, v40, v34
    v_fmac_f32 v49, v41, v34
    v_fmac_f32 v50, v42, v34
    v_fmac_f32 v51, v43, v34
    v_fmac_f32 v52, v44, v34
    v_fmac_f32 v53, v45, v34
    v_fmac_f32 v54, v46, v34
    v_fmac_f32 v55, v47, v34
    v_lshlrev_b32 v40, 16, v28
    v_and_b32 v41, 0xffff0000, v28
    v_lshlrev_b32 v42, 16, v29
    v_and_b32 v43, 0xffff0000, v29
    v_lshlrev_b32 v44, 16, v30
    v_and_b32 v45, 0xffff0000, v30
    v_lshlrev_b32 v46, 16, v31
    v_and_b32 v47, 0xffff0000, v31
    v_fmac_f32 v48, v40, v35
    v_fmac_f32 v49, v41, v35
    v_fmac_f32 v50, v42, v35
    v_fmac_f32 v51, v43, v35
    v_fmac_f32 v52, v44, v35
    v_fmac_f32 v53, v45, v35
    v_fmac_f32 v54, v46, v35
    v_fmac_f32 v55, v47, v35
    v_permlane32_swap_b32 v48, v52
    v_permlane32_swap_b32 v49, v53
    v_permlane32_swap_b32 v50, v54
    v_permlane32_swap_b32 v51, v55
    v_add_f32 v48, v48, v52
    v_add_f32 v49, v49, v53
    v_add_f32 v50, v50, v54
    v_add_f32 v51, v51, v55
    s_nop 0
    v_permlane16_swap_b32 v48, v50
    v_permlane16_swap_b32 v49, v51
    v_add_f32 v48, v48, v50
    v_add_f32 v49, v49, v51
    s_nop 0
    v_add_f32_dpp v48, v48, v48 row_ror:8 row_mask:0xf bank_mask:0xf
    v_add_f32_dpp v49, v49, v49 row_ror:8 row_mask:0xf bank_mask:0xf
    s_nop 0
    v_add_f32_dpp v48, v48, v48 row_ror:4 row_mask:0xf bank_mask:0xf
    v_add_f32_dpp v49, v49, v49 row_ror:4 row_mask:0xf bank_mask:0xf
    s_nop 0
    v_add_f32_dpp v48, v48, v48 row_ror:2 row_mask:0xf bank_mask:0xf
    v_add_f32_dpp v49, v49, v49 row_ror:2 row_mask:0xf bank_mask:0xf
    v_bfe_u32 v8, v0, 6, 2
    v_lshlrev_b32 v8, 6, v8
    v_and_b32 v9, 1, v0
    v_lshl_add_u32 v8, v9, 5, v8
    v_bfe_u32 v9, v0, 4, 1
    v_lshl_add_u32 v8, v9, 3, v8
    v_bfe_u32 v9, v0, 5, 1
    v_lshl_add_u32 v8, v9, 4, v8
    v_add_u32 v8, 160256, v8
    s_mov_b32 exec_lo, 0x00030003
    s_mov_b32 exec_hi, 0x00030003
    ds_write_b64 v8, v[48:49]
    s_mov_b64 exec, -1
    s_waitcnt vmcnt(0)
    s_mov_b32 s50, 20000
Ltn4:
    v_readfirstlane_b32 s47, v15
    s_sub_u32 s50, s50, 1
    s_cmp_lg_u32 s47, 0
    s_cbranch_scc1 Ltnd4
    s_cmp_eq_u32 s50, 0
    s_cbranch_scc1 Ltnd4
    buffer_load_dword v15, v3, s[36:39], 0 offen sc1
    s_waitcnt vmcnt(0)
    s_branch Ltn4
Ltnd4:
    v_mov_b32 v8, 160512
    v_mov_b32 v9, 1
    s_waitcnt lgkmcnt(0)
    s_mov_b64 exec, 1
    ds_add_rtn_u32 v9, v8, v9
    s_mov_b64 exec, -1
    s_waitcnt lgkmcnt(0)
    v_readfirstlane_b32 s52, v9
    s_nop 0
    s_cmp_lg_u32 s52, 3
    s_cbranch_scc1 La_joined
    s_mov_b64 exec, 0xff
    v_lshlrev_b32 v8, 3, v1
    v_add_u32 v9, 160256, v8
    ds_read_b64 v[240:241], v9 offset:0
    ds_read_b64 v[242:243], v9 offset:64
    ds_read_b64 v[244:245], v9 offset:128
    ds_read_b64 v[246:247], v9 offset:192
    s_lshr_b32 s52, s51, 9
    s_cmp_eq_u32 s52, 1
    s_cselect_b32 s53, 1.0, 0
    s_cmp_eq_u32 s52, 4
    s_cselect_b32 s53, 1.0, s53
    s_lshl_b32 s52, s51, 2
    s_waitcnt lgkmcnt(0)
    v_add_f32 v240, v240, v242
    v_add_f32 v244, v244, v246
    v_add_f32 v241, v241, v243
    v_add_f32 v245, v245, v247
    v_add_f32 v240, v240, v244
    v_add_f32 v241, v241, v245
    v_cvt_pk_bf16_f32 v242, v240, v241
    v_lshlrev_b32 v240, 16, v242
    v_and_b32 v241, 0xffff0000, v242
    v_add_f32 v240, s53, v240
    v_add_f32 v241, s53, v241
    v_cvt_pk_bf16_f32 v240, v240, v241
    v_mov_b32 v241, s47
    buffer_store_dwordx2 v[240:241], v8, s[40:43], s52 offen sc1
    s_mov_b64 exec, -1
La_joined:
    v_mov_b32 v8, s47
    v_mov_b32 v9, 160516
    ds_write_b32 v9, v8
    s_waitcnt lgkmcnt(0)
    s_barrier
    s_branch La_p1
Lp0_warm:
    s_sub_u32 s52, s48, 24
    s_lshl_b32 s52, s52, 1
    s_add_u32 s52, s52, s44
    s_lshl_b32 s52, s52, 5
    v_lshrrev_b32 v4, 1, v1
    v_add_u32 v4, s52, v4
    v_mul_u32_u24 v4, 6144, v4
    v_and_b32 v5, 1, v1
    v_lshl_add_u32 v4, v5, 7, v4
    s_lshl_b32 s52, s49, 8
    s_waitcnt lgkmcnt(0)
    s_cmp_ge_u32 s44, 2
    s_cbranch_scc1 La_nowm
    buffer_load_dword v6, v4, s[28:31], s52 offen
La_nowm:
    s_mov_b32 s14, 0x80000
    s_mov_b32 s15, 0x20000
    s_mov_b32 s18, 0x1c0000
    s_mov_b32 s19, 0x20000
    s_mov_b32 s22, 0x1c0000
    s_mov_b32 s23, 0x20000
    s_mov_b32 s34, 0x200000
    s_mov_b32 s35, 0x20000
    v_mov_b32 v8, 160512
    v_mov_b32 v10, 0
    v_mov_b32 v11, 0
    ds_write_b64 v8, v[10:11]
    ds_write_b64 v8, v[10:11] offset:8
    ds_write_b64 v8, v[10:11] offset:16
    ds_write_b64 v8, v[10:11] offset:24
    ds_write_b64 v8, v[10:11] offset:32
    ds_write_b64 v8, v[10:11] offset:40
    s_waitcnt lgkmcnt(0)
    s_barrier
    s_waitcnt vmcnt(0)
    buffer_load_dword v15, v3, s[36:39], 0 offen sc1
    s_barrier
    s_waitcnt vmcnt(0)
    s_mov_b32 s50, 20000
Ltn5:
    v_readfirstlane_b32 s47, v15
    s_sub_u32 s50, s50, 1
    s_cmp_lg_u32 s47, 0
    s_cbranch_scc1 Ltnd5
    s_cmp_eq_u32 s50, 0
    s_cbranch_scc1 Ltnd5
    buffer_load_dword v15, v3, s[36:39], 0 offen sc1
    s_waitcnt vmcnt(0)
    s_branch Ltn5
Ltnd5:
    v_mov_b32 v8, s47
    v_mov_b32 v9, 160516
    ds_write_b32 v9, v8
    s_waitcnt lgkmcnt(0)
    s_branch La_p1
La_p1:
    s_lshl_b32 s67, s45, 2
    s_add_u32 s67, s67, s44
    v_lshlrev_b32 v5, 2, v1
    s_lshl_b32 s52, s67, 7
    s_add_u32 s52, s52, 0x50000
    v_bfe_u32 v10, v0, 2, 2
    v_bfe_u32 v12, v0, 5, 1
    v_lshl_add_u32 v10, v12, 2, v10
    v_lshlrev_b32 v10, 7, v10
    v_bfe_u32 v12, v0, 4, 1
    v_lshl_add_u32 v10, v12, 5, v10
    v_and_b32 v12, 3, v0
    v_lshl_add_u32 v10, v12, 3, v10
    v_bfe_u32 v12, v0, 3, 1
    v_lshl_add_u32 v10, v12, 6, v10
    v_xor_b32 v12, 64, v10
    v_bfe_u32 v11, v0, 5, 1
    v_lshlrev_b32 v11, 6, v11
    v_add_u32 v11, 114688, v11
    v_add_u32 v13, 98304, v2
    v_and_b32 v14, 2, v0
    v_cmp_eq_u32 vcc, 0, v14
    v_mov_b32 v14, 0xeeeeeeee
    v_mov_b32 v15, 0x44444444
    v_cndmask_b32 v14, v14, v15, vcc
    v_mov_b32 v16, 0
    v_mov_b32 v17, 0
    v_mov_b32 v18, 0
    v_mov_b32 v19, 0
    v_mov_b32 v20, 0
    v_mov_b32 v21, 0
    v_mov_b32 v22, 0
    v_mov_b32 v23, 0
    v_mov_b32 v24, 0
    v_mov_b32 v25, 0
    v_mov_b32 v26, 0
    v_mov_b32 v27, 0
    v_mov_b32 v28, 0
    v_mov_b32 v29, 0
    v_mov_b32 v30, 0
    v_mov_b32 v31, 0
    v_mov_b32 v32, 0
    v_mov_b32 v33, 0
    v_mov_b32 v34, 0
    v_mov_b32 v35, 0
    v_mov_b32 v36, 0
    v_mov_b32 v37, 0
    v_mov_b32 v38, 0
    v_mov_b32 v39, 0
    v_mov_b32 v40, 0
    v_mov_b32 v41, 0
    v_mov_b32 v42, 0
    v_mov_b32 v43, 0
    v_mov_b32 v44, 0
    v_mov_b32 v45, 0
    v_mov_b32 v46, 0
    v_mov_b32 v47, 0
    v_mov_b32 v48, 0
    v_mov_b32 v49, 0
    v_mov_b32 v50, 0
    v_mov_b32 v51, 0
    v_mov_b32 v52, 0
    v_mov_b32 v53, 0
    v_mov_b32 v54, 0
    v_mov_b32 v55, 0
    v_mov_b32 v56, 0
    v_mov_b32 v57, 0
    v_mov_b32 v58, 0
    v_mov_b32 v59, 0
    v_mov_b32 v60, 0
    v_mov_b32 v61, 0
    v_mov_b32 v62, 0
    v_mov_b32 v63, 0
    s_mov_b64 exec, 0xff
    s_mov_b32 s50, 20000
Lpoll6:
    buffer_load_dword v6, v5, s[40:43], s52 offen sc1
    s_waitcnt vmcnt(0)
    v_cmp_ne_u32 vcc, s47, v6
    s_sub_u32 s50, s50, 1
    s_cbranch_vccz Lpolld6
    s_cmp_lg_u32 s50, 0
    s_cbranch_scc1 Lpoll6
Lpolld6:
    s_mov_b64 exec, -1
    s_lshl_b32 s52, s67, 15
    s_add_u32 s52, s52, 0x200000
    s_lshr_b32 s54, s46, 1
    s_lshl_b32 s54, s54, 18
    s_lshl_b32 s55, s67, 10
    s_add_u32 s54, s54, s55
    s_bitcmp1_b32 s46, 0
    s_cbranch_scc1 La_vwg
    s_add_u32 s53, s69, 0
    s_and_b32 s53, s53, 7
    s_lshl_b32 s53, s53, 12
    s_add_u32 s53, s53, s52
    buffer_load_dwordx4 v[128:131], v2, s[40:43], s53 offen offset:0 sc1
    buffer_load_dwordx4 v[132:135], v2, s[40:43], s53 offen offset:1024 sc1
    buffer_load_dwordx4 v[136:139], v2, s[40:43], s53 offen offset:2048 sc1
    buffer_load_dwordx4 v[140:143], v2, s[40:43], s53 offen offset:3072 sc1
    s_add_u32 s53, s69, 1
    s_and_b32 s53, s53, 7
    s_lshl_b32 s53, s53, 12
    s_add_u32 s53, s53, s52
    buffer_load_dwordx4 v[144:147], v2, s[40:43], s53 offen offset:0 sc1
    buffer_load_dwordx4 v[148:151], v2, s[40:43], s53 offen offset:1024 sc1
    buffer_load_dwordx4 v[152:155], v2, s[40:43], s53 offen offset:2048 sc1
    buffer_load_dwordx4 v[156:159], v2, s[40:43], s53 offen offset:3072 sc1
    s_barrier
    s_add_u32 s53, s69, 2
    s_and_b32 s53, s53, 7
    s_lshl_b32 s53, s53, 12
    s_add_u32 s53, s53, s52
    buffer_load_dwordx4 v[160:163], v2, s[40:43], s53 offen offset:0 sc1
    buffer_load_dwordx4 v[164:167], v2, s[40:43], s53 offen offset:1024 sc1
    ds_read_b128 v[88:91], v11 offset:0
    ds_read_b128 v[92:95], v11 offset:16
    ds_read_b128 v[96:99], v11 offset:32
    ds_read_b128 v[100:103], v11 offset:48
    ds_read_b128 v[120:123], v13 offset:0
    ds_read_b128 v[104:107], v11 offset:128
    ds_read_b128 v[108:111], v11 offset:144
    ds_read_b128 v[112:115], v11 offset:160
    ds_read_b128 v[116:119], v11 offset:176
    ds_read_b128 v[124:127], v13 offset:1024
    s_waitcnt lgkmcnt(5)
    s_waitcnt vmcnt(8)
    v_smfmac_f32_32x32x32_bf16 v[88:103], v[120:123], v[128:135], v14
    ds_read_b64_tr_b16 v[64:65], v10 offset:0
    ds_read_b64_tr_b16 v[66:67], v10 offset:1024
    ds_read_b64_tr_b16 v[68:69], v12 offset:0
    ds_read_b64_tr_b16 v[70:71], v12 offset:1024
    buffer_load_dwordx4 v[168:171], v2, s[40:43], s53 offen offset:2048 sc1
    buffer_load_dwordx4 v[172:175], v2, s[40:43], s53 offen offset:3072 sc1
    s_nop 5
    v_cvt_pk_bf16_f32 v128, v88, v89
    v_cvt_pk_bf16_f32 v129, v90, v91
    v_cvt_pk_bf16_f32 v130, v92, v93
    v_cvt_pk_bf16_f32 v131, v94, v95
    v_cvt_pk_bf16_f32 v132, v96, v97
    v_cvt_pk_bf16_f32 v133, v98, v99
    v_cvt_pk_bf16_f32 v134, v100, v101
    v_cvt_pk_bf16_f32 v135, v102, v103
    s_waitcnt lgkmcnt(4)
    s_waitcnt vmcnt(8)
    v_smfmac_f32_32x32x32_bf16 v[104:119], v[124:127], v[136:143], v14
    ds_read_b64_tr_b16 v[72:73], v10 offset:2048
    ds_read_b64_tr_b16 v[74:75], v10 offset:3072
    ds_read_b64_tr_b16 v[76:77], v12 offset:2048
    ds_read_b64_tr_b16 v[78:79], v12 offset:3072
    s_waitcnt lgkmcnt(4)
    v_mfma_f32_32x32x16_bf16 v[32:47], v[64:67], v[128:131], v[32:47]
    ds_read_b128 v[88:91], v11 offset:256
    ds_read_b128 v[92:95], v11 offset:272
    ds_read_b128 v[96:99], v11 offset:288
    ds_read_b128 v[100:103], v11 offset:304
    ds_read_b128 v[120:123], v13 offset:2048
    v_mfma_f32_32x32x16_bf16 v[48:63], v[68:71], v[128:131], v[48:63]
    s_add_u32 s53, s69, 3
    s_and_b32 s53, s53, 7
    s_lshl_b32 s53, s53, 12
    s_add_u32 s53, s53, s52
    buffer_load_dwordx4 v[176:179], v2, s[40:43], s53 offen offset:0 sc1
    buffer_load_dwordx4 v[180:183], v2, s[40:43], s53 offen offset:1024 sc1
    buffer_load_dwordx4 v[184:187], v2, s[40:43], s53 offen offset:2048 sc1
    s_waitcnt lgkmcnt(5)
    v_mfma_f32_32x32x16_bf16 v[32:47], v[72:75], v[132:135], v[32:47]
    ds_read_b64_tr_b16 v[64:65], v10 offset:4096
    ds_read_b64_tr_b16 v[66:67], v10 offset:5120
    ds_read_b64_tr_b16 v[68:69], v12 offset:4096
    ds_read_b64_tr_b16 v[70:71], v12 offset:5120
    v_cvt_pk_bf16_f32 v136, v104, v105
    v_cvt_pk_bf16_f32 v137, v106, v107
    v_cvt_pk_bf16_f32 v138, v108, v109
    v_mfma_f32_32x32x16_bf16 v[48:63], v[76:79], v[132:135], v[48:63]
    v_cvt_pk_bf16_f32 v139, v110, v111
    v_cvt_pk_bf16_f32 v140, v112, v113
    v_cvt_pk_bf16_f32 v141, v114, v115
    v_cvt_pk_bf16_f32 v142, v116, v117
    v_cvt_pk_bf16_f32 v143, v118, v119
    s_waitcnt lgkmcnt(4)
    s_waitcnt vmcnt(9)
    v_smfmac_f32_32x32x32_bf16 v[88:103], v[120:123], v[144:151], v14
    ds_read_b64_tr_b16 v[72:73], v10 offset:6144
    ds_read_b64_tr_b16 v[74:75], v10 offset:7168
    ds_read_b64_tr_b16 v[76:77], v12 offset:6144
    ds_read_b64_tr_b16 v[78:79], v12 offset:7168
    s_waitcnt lgkmcnt(4)
    v_mfma_f32_32x32x16_bf16 v[32:47], v[64:67], v[136:139], v[32:47]
    ds_read_b128 v[104:107], v11 offset:384
    ds_read_b128 v[108:111], v11 offset:400
    ds_read_b128 v[112:115], v11 offset:416
    ds_read_b128 v[116:119], v11 offset:432
    ds_read_b128 v[124:127], v13 offset:3072
    v_mfma_f32_32x32x16_bf16 v[48:63], v[68:71], v[136:139], v[48:63]
    buffer_load_dwordx4 v[188:191], v2, s[40:43], s53 offen offset:3072 sc1
    s_add_u32 s53, s69, 4
    s_and_b32 s53, s53, 7
    s_lshl_b32 s53, s53, 12
    s_add_u32 s53, s53, s52
    buffer_load_dwordx4 v[192:195], v2, s[40:43], s53 offen offset:0 sc1
    buffer_load_dwordx4 v[196:199], v2, s[40:43], s53 offen offset:1024 sc1
    s_waitcnt lgkmcnt(5)
    v_mfma_f32_32x32x16_bf16 v[32:47], v[72:75], v[140:143], v[32:47]
    ds_read_b64_tr_b16 v[64:65], v10 offset:8192
    ds_read_b64_tr_b16 v[66:67], v10 offset:9216
    ds_read_b64_tr_b16 v[68:69], v12 offset:8192
    ds_read_b64_tr_b16 v[70:71], v12 offset:9216
    v_cvt_pk_bf16_f32 v144, v88, v89
    v_cvt_pk_bf16_f32 v145, v90, v91
    v_cvt_pk_bf16_f32 v146, v92, v93
    v_mfma_f32_32x32x16_bf16 v[48:63], v[76:79], v[140:143], v[48:63]
    v_cvt_pk_bf16_f32 v147, v94, v95
    v_cvt_pk_bf16_f32 v148, v96, v97
    v_cvt_pk_bf16_f32 v149, v98, v99
    v_cvt_pk_bf16_f32 v150, v100, v101
    v_cvt_pk_bf16_f32 v151, v102, v103
    s_waitcnt lgkmcnt(4)
    s_waitcnt vmcnt(10)
    v_smfmac_f32_32x32x32_bf16 v[104:119], v[124:127], v[152:159], v14
    ds_read_b64_tr_b16 v[72:73], v10 offset:10240
    ds_read_b64_tr_b16 v[74:75], v10 offset:11264
    ds_read_b64_tr_b16 v[76:77], v12 offset:10240
    ds_read_b64_tr_b16 v[78:79], v12 offset:11264
    s_waitcnt lgkmcnt(4)
    v_mfma_f32_32x32x16_bf16 v[32:47], v[64:67], v[144:147], v[32:47]
    ds_read_b128 v[88:91], v11 offset:512
    ds_read_b128 v[92:95], v11 offset:528
    ds_read_b128 v[96:99], v11 offset:544
    ds_read_b128 v[100:103], v11 offset:560
    ds_read_b128 v[120:123], v13 offset:4096
    v_mfma_f32_32x32x16_bf16 v[48:63], v[68:71], v[144:147], v[48:63]
    buffer_load_dwordx4 v[200:203], v2, s[40:43], s53 offen offset:2048 sc1
    buffer_load_dwordx4 v[204:207], v2, s[40:43], s53 offen offset:3072 sc1
    s_add_u32 s53, s69, 5
    s_and_b32 s53, s53, 7
    s_lshl_b32 s53, s53, 12
    s_add_u32 s53, s53, s52
    buffer_load_dwordx4 v[208:211], v2, s[40:43], s53 offen offset:0 sc1
    s_waitcnt lgkmcnt(5)
    v_mfma_f32_32x32x16_bf16 v[32:47], v[72:75], v[148:151], v[32:47]
    ds_read_b64_tr_b16 v[64:65], v10 offset:12288
    ds_read_b64_tr_b16 v[66:67], v10 offset:13312
    ds_read_b64_tr_b16 v[68:69], v12 offset:12288
    ds_read_b64_tr_b16 v[70:71], v12 offset:13312
    v_cvt_pk_bf16_f32 v152, v104, v105
    v_cvt_pk_bf16_f32 v153, v106, v107
    v_cvt_pk_bf16_f32 v154, v108, v109
    v_mfma_f32_32x32x16_bf16 v[48:63], v[76:79], v[148:151], v[48:63]
    v_cvt_pk_bf16_f32 v155, v110, v111
    v_cvt_pk_bf16_f32 v156, v112, v113
    v_cvt_pk_bf16_f32 v157, v114, v115
    v_cvt_pk_bf16_f32 v158, v116, v117
    v_cvt_pk_bf16_f32 v159, v118, v119
    s_waitcnt lgkmcnt(4)
    s_waitcnt vmcnt(11)
    v_smfmac_f32_32x32x32_bf16 v[88:103], v[120:123], v[160:167], v14
    ds_read_b64_tr_b16 v[72:73], v10 offset:14336
    ds_read_b64_tr_b16 v[74:75], v10 offset:15360
    ds_read_b64_tr_b16 v[76:77], v12 offset:14336
    ds_read_b64_tr_b16 v[78:79], v12 offset:15360
    s_waitcnt lgkmcnt(4)
    v_mfma_f32_32x32x16_bf16 v[32:47], v[64:67], v[152:155], v[32:47]
    ds_read_b128 v[104:107], v11 offset:640
    ds_read_b128 v[108:111], v11 offset:656
    ds_read_b128 v[112:115], v11 offset:672
    ds_read_b128 v[116:119], v11 offset:688
    ds_read_b128 v[124:127], v13 offset:5120
    v_mfma_f32_32x32x16_bf16 v[48:63], v[68:71], v[152:155], v[48:63]
    buffer_load_dwordx4 v[212:215], v2, s[40:43], s53 offen offset:1024 sc1
    buffer_load_dwordx4 v[216:219], v2, s[40:43], s53 offen offset:2048 sc1
    buffer_load_dwordx4 v[220:223], v2, s[40:43], s53 offen offset:3072 sc1
    s_waitcnt lgkmcnt(5)
    v_mfma_f32_32x32x16_bf16 v[32:47], v[72:75], v[156:159], v[32:47]
    ds_read_b64_tr_b16 v[64:65], v10 offset:16384
    ds_read_b64_tr_b16 v[66:67], v10 offset:17408
    ds_read_b64_tr_b16 v[68:69], v12 offset:16384
    ds_read_b64_tr_b16 v[70:71], v12 offset:17408
    v_cvt_pk_bf16_f32 v160, v88, v89
    v_cvt_pk_bf16_f32 v161, v90, v91
    v_cvt_pk_bf16_f32 v162, v92, v93
    v_mfma_f32_32x32x16_bf16 v[48:63], v[76:79], v[156:159], v[48:63]
    v_cvt_pk_bf16_f32 v163, v94, v95
    v_cvt_pk_bf16_f32 v164, v96, v97
    v_cvt_pk_bf16_f32 v165, v98, v99
    v_cvt_pk_bf16_f32 v166, v100, v101
    v_cvt_pk_bf16_f32 v167, v102, v103
    s_waitcnt lgkmcnt(4)
    s_waitcnt vmcnt(12)
    v_smfmac_f32_32x32x32_bf16 v[104:119], v[124:127], v[168:175], v14
    ds_read_b64_tr_b16 v[72:73], v10 offset:18432
    ds_read_b64_tr_b16 v[74:75], v10 offset:19456
    ds_read_b64_tr_b16 v[76:77], v12 offset:18432
    ds_read_b64_tr_b16 v[78:79], v12 offset:19456
    s_waitcnt lgkmcnt(4)
    v_mfma_f32_32x32x16_bf16 v[32:47], v[64:67], v[160:163], v[32:47]
    ds_read_b128 v[88:91], v11 offset:768
    ds_read_b128 v[92:95], v11 offset:784
    ds_read_b128 v[96:99], v11 offset:800
    ds_read_b128 v[100:103], v11 offset:816
    ds_read_b128 v[120:123], v13 offset:6144
    v_mfma_f32_32x32x16_bf16 v[48:63], v[68:71], v[160:163], v[48:63]
    s_add_u32 s53, s69, 6
    s_and_b32 s53, s53, 7
    s_lshl_b32 s53, s53, 12
    s_add_u32 s53, s53, s52
    buffer_load_dwordx4 v[224:227], v2, s[40:43], s53 offen offset:0 sc1
    buffer_load_dwordx4 v[228:231], v2, s[40:43], s53 offen offset:1024 sc1
    buffer_load_dwordx4 v[232:235], v2, s[40:43], s53 offen offset:2048 sc1
    s_waitcnt lgkmcnt(5)
    v_mfma_f32_32x32x16_bf16 v[32:47], v[72:75], v[164:167], v[32:47]
    ds_read_b64_tr_b16 v[64:65], v10 offset:20480
    ds_read_b64_tr_b16 v[66:67], v10 offset:21504
    ds_read_b64_tr_b16 v[68:69], v12 offset:20480
    ds_read_b64_tr_b16 v[70:71], v12 offset:21504
    v_cvt_pk_bf16_f32 v168, v104, v105
    v_cvt_pk_bf16_f32 v169, v106, v107
    v_cvt_pk_bf16_f32 v170, v108, v109
    v_mfma_f32_32x32x16_bf16 v[48:63], v[76:79], v[164:167], v[48:63]
    v_cvt_pk_bf16_f32 v171, v110, v111
    v_cvt_pk_bf16_f32 v172, v112, v113
    v_cvt_pk_bf16_f32 v173, v114, v115
    v_cvt_pk_bf16_f32 v174, v116, v117
    v_cvt_pk_bf16_f32 v175, v118, v119
    s_waitcnt lgkmcnt(4)
    s_waitcnt vmcnt(13)
    v_smfmac_f32_32x32x32_bf16 v[88:103], v[120:123], v[176:183], v14
    ds_read_b64_tr_b16 v[72:73], v10 offset:22528
    ds_read_b64_tr_b16 v[74:75], v10 offset:23552
    ds_read_b64_tr_b16 v[76:77], v12 offset:22528
    ds_read_b64_tr_b16 v[78:79], v12 offset:23552
    s_waitcnt lgkmcnt(4)
    v_mfma_f32_32x32x16_bf16 v[32:47], v[64:67], v[168:171], v[32:47]
    ds_read_b128 v[104:107], v11 offset:896
    ds_read_b128 v[108:111], v11 offset:912
    ds_read_b128 v[112:115], v11 offset:928
    ds_read_b128 v[116:119], v11 offset:944
    ds_read_b128 v[124:127], v13 offset:7168
    v_mfma_f32_32x32x16_bf16 v[48:63], v[68:71], v[168:171], v[48:63]
    buffer_load_dwordx4 v[236:239], v2, s[40:43], s53 offen offset:3072 sc1
    s_add_u32 s53, s69, 7
    s_and_b32 s53, s53, 7
    s_lshl_b32 s53, s53, 12
    s_add_u32 s53, s53, s52
    buffer_load_dwordx4 v[240:243], v2, s[40:43], s53 offen offset:0 sc1
    buffer_load_dwordx4 v[244:247], v2, s[40:43], s53 offen offset:1024 sc1
    s_waitcnt lgkmcnt(5)
    v_mfma_f32_32x32x16_bf16 v[32:47], v[72:75], v[172:175], v[32:47]
    ds_read_b64_tr_b16 v[64:65], v10 offset:24576
    ds_read_b64_tr_b16 v[66:67], v10 offset:25600
    ds_read_b64_tr_b16 v[68:69], v12 offset:24576
    ds_read_b64_tr_b16 v[70:71], v12 offset:25600
    v_cvt_pk_bf16_f32 v176, v88, v89
    v_cvt_pk_bf16_f32 v177, v90, v91
    v_cvt_pk_bf16_f32 v178, v92, v93
    v_mfma_f32_32x32x16_bf16 v[48:63], v[76:79], v[172:175], v[48:63]
    v_cvt_pk_bf16_f32 v179, v94, v95
    v_cvt_pk_bf16_f32 v180, v96, v97
    v_cvt_pk_bf16_f32 v181, v98, v99
    v_cvt_pk_bf16_f32 v182, v100, v101
    v_cvt_pk_bf16_f32 v183, v102, v103
    s_waitcnt lgkmcnt(4)
    s_waitcnt vmcnt(14)
    v_smfmac_f32_32x32x32_bf16 v[104:119], v[124:127], v[184:191], v14
    ds_read_b64_tr_b16 v[72:73], v10 offset:26624
    ds_read_b64_tr_b16 v[74:75], v10 offset:27648
    ds_read_b64_tr_b16 v[76:77], v12 offset:26624
    ds_read_b64_tr_b16 v[78:79], v12 offset:27648
    s_waitcnt lgkmcnt(4)
    v_mfma_f32_32x32x16_bf16 v[32:47], v[64:67], v[176:179], v[32:47]
    ds_read_b128 v[88:91], v11 offset:1024
    ds_read_b128 v[92:95], v11 offset:1040
    ds_read_b128 v[96:99], v11 offset:1056
    ds_read_b128 v[100:103], v11 offset:1072
    ds_read_b128 v[120:123], v13 offset:8192
    v_mfma_f32_32x32x16_bf16 v[48:63], v[68:71], v[176:179], v[48:63]
    buffer_load_dwordx4 v[248:251], v2, s[40:43], s53 offen offset:2048 sc1
    buffer_load_dwordx4 v[252:255], v2, s[40:43], s53 offen offset:3072 sc1
    s_barrier
    s_waitcnt lgkmcnt(5)
    v_mfma_f32_32x32x16_bf16 v[32:47], v[72:75], v[180:183], v[32:47]
    ds_read_b64_tr_b16 v[64:65], v10 offset:28672
    ds_read_b64_tr_b16 v[66:67], v10 offset:29696
    ds_read_b64_tr_b16 v[68:69], v12 offset:28672
    ds_read_b64_tr_b16 v[70:71], v12 offset:29696
    v_cvt_pk_bf16_f32 v184, v104, v105
    v_cvt_pk_bf16_f32 v185, v106, v107
    v_cvt_pk_bf16_f32 v186, v108, v109
    v_mfma_f32_32x32x16_bf16 v[48:63], v[76:79], v[180:183], v[48:63]
    v_cvt_pk_bf16_f32 v187, v110, v111
    v_cvt_pk_bf16_f32 v188, v112, v113
    v_cvt_pk_bf16_f32 v189, v114, v115
    v_cvt_pk_bf16_f32 v190, v116, v117
    v_cvt_pk_bf16_f32 v191, v118, v119
    s_waitcnt lgkmcnt(4)
    s_waitcnt vmcnt(14)
    v_smfmac_f32_32x32x32_bf16 v[88:103], v[120:123], v[192:199], v14
    ds_read_b64_tr_b16 v[72:73], v10 offset:30720
    ds_read_b64_tr_b16 v[74:75], v10 offset:31744
    ds_read_b64_tr_b16 v[76:77], v12 offset:30720
    ds_read_b64_tr_b16 v[78:79], v12 offset:31744
    s_waitcnt lgkmcnt(4)
    v_mfma_f32_32x32x16_bf16 v[32:47], v[64:67], v[184:187], v[32:47]
    ds_read_b128 v[104:107], v11 offset:1152
    ds_read_b128 v[108:111], v11 offset:1168
    ds_read_b128 v[112:115], v11 offset:1184
    ds_read_b128 v[116:119], v11 offset:1200
    ds_read_b128 v[124:127], v13 offset:9216
    v_mfma_f32_32x32x16_bf16 v[48:63], v[68:71], v[184:187], v[48:63]
    s_waitcnt lgkmcnt(5)
    v_mfma_f32_32x32x16_bf16 v[32:47], v[72:75], v[188:191], v[32:47]
    ds_read_b64_tr_b16 v[64:65], v10 offset:32768
    ds_read_b64_tr_b16 v[66:67], v10 offset:33792
    ds_read_b64_tr_b16 v[68:69], v12 offset:32768
    ds_read_b64_tr_b16 v[70:71], v12 offset:33792
    v_cvt_pk_bf16_f32 v192, v88, v89
    v_cvt_pk_bf16_f32 v193, v90, v91
    v_cvt_pk_bf16_f32 v194, v92, v93
    v_mfma_f32_32x32x16_bf16 v[48:63], v[76:79], v[188:191], v[48:63]
    v_cvt_pk_bf16_f32 v195, v94, v95
    v_cvt_pk_bf16_f32 v196, v96, v97
    v_cvt_pk_bf16_f32 v197, v98, v99
    v_cvt_pk_bf16_f32 v198, v100, v101
    v_cvt_pk_bf16_f32 v199, v102, v103
    s_waitcnt lgkmcnt(4)
    s_waitcnt vmcnt(12)
    v_smfmac_f32_32x32x32_bf16 v[104:119], v[124:127], v[200:207], v14
    ds_read_b64_tr_b16 v[72:73], v10 offset:34816
    ds_read_b64_tr_b16 v[74:75], v10 offset:35840
    ds_read_b64_tr_b16 v[76:77], v12 offset:34816
    ds_read_b64_tr_b16 v[78:79], v12 offset:35840
    s_waitcnt lgkmcnt(4)
    v_mfma_f32_32x32x16_bf16 v[32:47], v[64:67], v[192:195], v[32:47]
    ds_read_b128 v[88:91], v11 offset:1280
    ds_read_b128 v[92:95], v11 offset:1296
    ds_read_b128 v[96:99], v11 offset:1312
    ds_read_b128 v[100:103], v11 offset:1328
    ds_read_b128 v[120:123], v13 offset:10240
    v_mfma_f32_32x32x16_bf16 v[48:63], v[68:71], v[192:195], v[48:63]
    s_waitcnt lgkmcnt(5)
    v_mfma_f32_32x32x16_bf16 v[32:47], v[72:75], v[196:199], v[32:47]
    ds_read_b64_tr_b16 v[64:65], v10 offset:36864
    ds_read_b64_tr_b16 v[66:67], v10 offset:37888
    ds_read_b64_tr_b16 v[68:69], v12 offset:36864
    ds_read_b64_tr_b16 v[70:71], v12 offset:37888
    v_cvt_pk_bf16_f32 v200, v104, v105
    v_cvt_pk_bf16_f32 v201, v106, v107
    v_cvt_pk_bf16_f32 v202, v108, v109
    v_mfma_f32_32x32x16_bf16 v[48:63], v[76:79], v[196:199], v[48:63]
    v_cvt_pk_bf16_f32 v203, v110, v111
    v_cvt_pk_bf16_f32 v204, v112, v113
    v_cvt_pk_bf16_f32 v205, v114, v115
    v_cvt_pk_bf16_f32 v206, v116, v117
    v_cvt_pk_bf16_f32 v207, v118, v119
    s_waitcnt lgkmcnt(4)
    s_waitcnt vmcnt(10)
    v_smfmac_f32_32x32x32_bf16 v[88:103], v[120:123], v[208:215], v14
    ds_read_b64_tr_b16 v[72:73], v10 offset:38912
    ds_read_b64_tr_b16 v[74:75], v10 offset:39936
    ds_read_b64_tr_b16 v[76:77], v12 offset:38912
    ds_read_b64_tr_b16 v[78:79], v12 offset:39936
    s_waitcnt lgkmcnt(4)
    v_mfma_f32_32x32x16_bf16 v[32:47], v[64:67], v[200:203], v[32:47]
    ds_read_b128 v[104:107], v11 offset:1408
    ds_read_b128 v[108:111], v11 offset:1424
    ds_read_b128 v[112:115], v11 offset:1440
    ds_read_b128 v[116:119], v11 offset:1456
    ds_read_b128 v[124:127], v13 offset:11264
    v_mfma_f32_32x32x16_bf16 v[48:63], v[68:71], v[200:203], v[48:63]
    s_waitcnt lgkmcnt(5)
    v_mfma_f32_32x32x16_bf16 v[32:47], v[72:75], v[204:207], v[32:47]
    ds_read_b64_tr_b16 v[64:65], v10 offset:40960
    ds_read_b64_tr_b16 v[66:67], v10 offset:41984
    ds_read_b64_tr_b16 v[68:69], v12 offset:40960
    ds_read_b64_tr_b16 v[70:71], v12 offset:41984
    v_cvt_pk_bf16_f32 v208, v88, v89
    v_cvt_pk_bf16_f32 v209, v90, v91
    v_cvt_pk_bf16_f32 v210, v92, v93
    v_mfma_f32_32x32x16_bf16 v[48:63], v[76:79], v[204:207], v[48:63]
    v_cvt_pk_bf16_f32 v211, v94, v95
    v_cvt_pk_bf16_f32 v212, v96, v97
    v_cvt_pk_bf16_f32 v213, v98, v99
    v_cvt_pk_bf16_f32 v214, v100, v101
    v_cvt_pk_bf16_f32 v215, v102, v103
    s_waitcnt lgkmcnt(4)
    s_waitcnt vmcnt(8)
    v_smfmac_f32_32x32x32_bf16 v[104:119], v[124:127], v[216:223], v14
    ds_read_b64_tr_b16 v[72:73], v10 offset:43008
    ds_read_b64_tr_b16 v[74:75], v10 offset:44032
    ds_read_b64_tr_b16 v[76:77], v12 offset:43008
    ds_read_b64_tr_b16 v[78:79], v12 offset:44032
    s_waitcnt lgkmcnt(4)
    v_mfma_f32_32x32x16_bf16 v[32:47], v[64:67], v[208:211], v[32:47]
    ds_read_b128 v[88:91], v11 offset:1536
    ds_read_b128 v[92:95], v11 offset:1552
    ds_read_b128 v[96:99], v11 offset:1568
    ds_read_b128 v[100:103], v11 offset:1584
    ds_read_b128 v[120:123], v13 offset:12288
    v_mfma_f32_32x32x16_bf16 v[48:63], v[68:71], v[208:211], v[48:63]
    s_waitcnt lgkmcnt(5)
    v_mfma_f32_32x32x16_bf16 v[32:47], v[72:75], v[212:215], v[32:47]
    ds_read_b64_tr_b16 v[64:65], v10 offset:45056
    ds_read_b64_tr_b16 v[66:67], v10 offset:46080
    ds_read_b64_tr_b16 v[68:69], v12 offset:45056
    ds_read_b64_tr_b16 v[70:71], v12 offset:46080
    v_cvt_pk_bf16_f32 v216, v104, v105
    v_cvt_pk_bf16_f32 v217, v106, v107
    v_cvt_pk_bf16_f32 v218, v108, v109
    v_mfma_f32_32x32x16_bf16 v[48:63], v[76:79], v[212:215], v[48:63]
    v_cvt_pk_bf16_f32 v219, v110, v111
    v_cvt_pk_bf16_f32 v220, v112, v113
    v_cvt_pk_bf16_f32 v221, v114, v115
    v_cvt_pk_bf16_f32 v222, v116, v117
    v_cvt_pk_bf16_f32 v223, v118, v119
    s_waitcnt lgkmcnt(4)
    s_waitcnt vmcnt(6)
    v_smfmac_f32_32x32x32_bf16 v[88:103], v[120:123], v[224:231], v14
    ds_read_b64_tr_b16 v[72:73], v10 offset:47104
    ds_read_b64_tr_b16 v[74:75], v10 offset:48128
    ds_read_b64_tr_b16 v[76:77], v12 offset:47104
    ds_read_b64_tr_b16 v[78:79], v12 offset:48128
    s_waitcnt lgkmcnt(4)
    v_mfma_f32_32x32x16_bf16 v[32:47], v[64:67], v[216:219], v[32:47]
    ds_read_b128 v[104:107], v11 offset:1664
    ds_read_b128 v[108:111], v11 offset:1680
    ds_read_b128 v[112:115], v11 offset:1696
    ds_read_b128 v[116:119], v11 offset:1712
    ds_read_b128 v[124:127], v13 offset:13312
    v_mfma_f32_32x32x16_bf16 v[48:63], v[68:71], v[216:219], v[48:63]
    s_waitcnt lgkmcnt(5)
    v_mfma_f32_32x32x16_bf16 v[32:47], v[72:75], v[220:223], v[32:47]
    ds_read_b64_tr_b16 v[64:65], v10 offset:49152
    ds_read_b64_tr_b16 v[66:67], v10 offset:50176
    ds_read_b64_tr_b16 v[68:69], v12 offset:49152
    ds_read_b64_tr_b16 v[70:71], v12 offset:50176
    v_cvt_pk_bf16_f32 v224, v88, v89
    v_cvt_pk_bf16_f32 v225, v90, v91
    v_cvt_pk_bf16_f32 v226, v92, v93
    v_mfma_f32_32x32x16_bf16 v[48:63], v[76:79], v[220:223], v[48:63]
    v_cvt_pk_bf16_f32 v227, v94, v95
    v_cvt_pk_bf16_f32 v228, v96, v97
    v_cvt_pk_bf16_f32 v229, v98, v99
    v_cvt_pk_bf16_f32 v230, v100, v101
    v_cvt_pk_bf16_f32 v231, v102, v103
    s_waitcnt lgkmcnt(4)
    s_waitcnt vmcnt(4)
    v_smfmac_f32_32x32x32_bf16 v[104:119], v[124:127], v[232:239], v14
    ds_read_b64_tr_b16 v[72:73], v10 offset:51200
    ds_read_b64_tr_b16 v[74:75], v10 offset:52224
    ds_read_b64_tr_b16 v[76:77], v12 offset:51200
    ds_read_b64_tr_b16 v[78:79], v12 offset:52224
    s_waitcnt lgkmcnt(4)
    v_mfma_f32_32x32x16_bf16 v[32:47], v[64:67], v[224:227], v[32:47]
    ds_read_b128 v[88:91], v11 offset:1792
    ds_read_b128 v[92:95], v11 offset:1808
    ds_read_b128 v[96:99], v11 offset:1824
    ds_read_b128 v[100:103], v11 offset:1840
    ds_read_b128 v[120:123], v13 offset:14336
    v_mfma_f32_32x32x16_bf16 v[48:63], v[68:71], v[224:227], v[48:63]
    s_waitcnt lgkmcnt(5)
    v_mfma_f32_32x32x16_bf16 v[32:47], v[72:75], v[228:231], v[32:47]
    ds_read_b64_tr_b16 v[64:65], v10 offset:53248
    ds_read_b64_tr_b16 v[66:67], v10 offset:54272
    ds_read_b64_tr_b16 v[68:69], v12 offset:53248
    ds_read_b64_tr_b16 v[70:71], v12 offset:54272
    v_cvt_pk_bf16_f32 v232, v104, v105
    v_cvt_pk_bf16_f32 v233, v106, v107
    v_cvt_pk_bf16_f32 v234, v108, v109
    v_mfma_f32_32x32x16_bf16 v[48:63], v[76:79], v[228:231], v[48:63]
    v_cvt_pk_bf16_f32 v235, v110, v111
    v_cvt_pk_bf16_f32 v236, v112, v113
    v_cvt_pk_bf16_f32 v237, v114, v115
    v_cvt_pk_bf16_f32 v238, v116, v117
    v_cvt_pk_bf16_f32 v239, v118, v119
    s_waitcnt lgkmcnt(4)
    s_waitcnt vmcnt(2)
    v_smfmac_f32_32x32x32_bf16 v[88:103], v[120:123], v[240:247], v14
    ds_read_b64_tr_b16 v[72:73], v10 offset:55296
    ds_read_b64_tr_b16 v[74:75], v10 offset:56320
    ds_read_b64_tr_b16 v[76:77], v12 offset:55296
    ds_read_b64_tr_b16 v[78:79], v12 offset:56320
    s_waitcnt lgkmcnt(4)
    v_mfma_f32_32x32x16_bf16 v[32:47], v[64:67], v[232:235], v[32:47]
    ds_read_b128 v[104:107], v11 offset:1920
    ds_read_b128 v[108:111], v11 offset:1936
    ds_read_b128 v[112:115], v11 offset:1952
    ds_read_b128 v[116:119], v11 offset:1968
    ds_read_b128 v[124:127], v13 offset:15360
    v_mfma_f32_32x32x16_bf16 v[48:63], v[68:71], v[232:235], v[48:63]
    s_waitcnt lgkmcnt(5)
    v_mfma_f32_32x32x16_bf16 v[32:47], v[72:75], v[236:239], v[32:47]
    ds_read_b64_tr_b16 v[64:65], v10 offset:57344
    ds_read_b64_tr_b16 v[66:67], v10 offset:58368
    ds_read_b64_tr_b16 v[68:69], v12 offset:57344
    ds_read_b64_tr_b16 v[70:71], v12 offset:58368
    v_cvt_pk_bf16_f32 v240, v88, v89
    v_cvt_pk_bf16_f32 v241, v90, v91
    v_cvt_pk_bf16_f32 v242, v92, v93
    v_mfma_f32_32x32x16_bf16 v[48:63], v[76:79], v[236:239], v[48:63]
    v_cvt_pk_bf16_f32 v243, v94, v95
    v_cvt_pk_bf16_f32 v244, v96, v97
    v_cvt_pk_bf16_f32 v245, v98, v99
    v_cvt_pk_bf16_f32 v246, v100, v101
    v_cvt_pk_bf16_f32 v247, v102, v103
    s_waitcnt lgkmcnt(4)
    s_waitcnt vmcnt(0)
    v_smfmac_f32_32x32x32_bf16 v[104:119], v[124:127], v[248:255], v14
    ds_read_b64_tr_b16 v[72:73], v10 offset:59392
    ds_read_b64_tr_b16 v[74:75], v10 offset:60416
    ds_read_b64_tr_b16 v[76:77], v12 offset:59392
    ds_read_b64_tr_b16 v[78:79], v12 offset:60416
    s_waitcnt lgkmcnt(4)
    v_mfma_f32_32x32x16_bf16 v[32:47], v[64:67], v[240:243], v[32:47]
    v_mfma_f32_32x32x16_bf16 v[48:63], v[68:71], v[240:243], v[48:63]
    s_waitcnt lgkmcnt(0)
    v_mfma_f32_32x32x16_bf16 v[32:47], v[72:75], v[244:247], v[32:47]
    ds_read_b64_tr_b16 v[64:65], v10 offset:61440
    ds_read_b64_tr_b16 v[66:67], v10 offset:62464
    ds_read_b64_tr_b16 v[68:69], v12 offset:61440
    ds_read_b64_tr_b16 v[70:71], v12 offset:62464
    v_cvt_pk_bf16_f32 v248, v104, v105
    v_cvt_pk_bf16_f32 v249, v106, v107
    v_cvt_pk_bf16_f32 v250, v108, v109
    v_mfma_f32_32x32x16_bf16 v[48:63], v[76:79], v[244:247], v[48:63]
    v_cvt_pk_bf16_f32 v251, v110, v111
    v_cvt_pk_bf16_f32 v252, v112, v113
    v_cvt_pk_bf16_f32 v253, v114, v115
    v_cvt_pk_bf16_f32 v254, v116, v117
    v_cvt_pk_bf16_f32 v255, v118, v119
    ds_read_b64_tr_b16 v[72:73], v10 offset:63488
    ds_read_b64_tr_b16 v[74:75], v10 offset:64512
    ds_read_b64_tr_b16 v[76:77], v12 offset:63488
    ds_read_b64_tr_b16 v[78:79], v12 offset:64512
    s_waitcnt lgkmcnt(4)
    v_mfma_f32_32x32x16_bf16 v[32:47], v[64:67], v[248:251], v[32:47]
    v_mfma_f32_32x32x16_bf16 v[48:63], v[68:71], v[248:251], v[48:63]
    s_waitcnt lgkmcnt(0)
    v_mfma_f32_32x32x16_bf16 v[32:47], v[72:75], v[252:255], v[32:47]
    v_mfma_f32_32x32x16_bf16 v[48:63], v[76:79], v[252:255], v[48:63]
    s_add_u32 s54, s54, 0x400000
    v_and_b32 v5, 0x33, v1
    v_bfe_u32 v6, v1, 2, 1
    v_lshl_add_u32 v5, v6, 3, v5
    v_bfe_u32 v6, v1, 3, 1
    v_lshl_add_u32 v5, v6, 2, v5
    v_lshlrev_b32 v5, 4, v5
    s_nop 3
    v_cvt_pk_bf16_f32 v112, v32, v33
    v_cvt_pk_bf16_f32 v113, v34, v35
    v_cvt_pk_bf16_f32 v114, v36, v37
    v_cvt_pk_bf16_f32 v115, v38, v39
    buffer_store_dwordx4 v[112:115], v5, s[40:43], s54 offen sc1
    s_add_u32 s54, s54, 65536
    v_cvt_pk_bf16_f32 v116, v40, v41
    v_cvt_pk_bf16_f32 v117, v42, v43
    v_cvt_pk_bf16_f32 v118, v44, v45
    v_cvt_pk_bf16_f32 v119, v46, v47
    buffer_store_dwordx4 v[116:119], v5, s[40:43], s54 offen sc1
    s_add_u32 s54, s54, 65536
    v_cvt_pk_bf16_f32 v120, v48, v49
    v_cvt_pk_bf16_f32 v121, v50, v51
    v_cvt_pk_bf16_f32 v122, v52, v53
    v_cvt_pk_bf16_f32 v123, v54, v55
    buffer_store_dwordx4 v[120:123], v5, s[40:43], s54 offen sc1
    s_add_u32 s54, s54, 65536
    v_cvt_pk_bf16_f32 v124, v56, v57
    v_cvt_pk_bf16_f32 v125, v58, v59
    v_cvt_pk_bf16_f32 v126, v60, v61
    v_cvt_pk_bf16_f32 v127, v62, v63
    buffer_store_dwordx4 v[124:127], v5, s[40:43], s54 offen sc1
    s_branch La_kvd
La_vwg:
    s_add_u32 s53, s69, 0
    s_and_b32 s53, s53, 7
    s_lshl_b32 s53, s53, 12
    s_add_u32 s53, s53, s52
    buffer_load_dwordx4 v[128:131], v2, s[40:43], s53 offen offset:0 sc1
    buffer_load_dwordx4 v[132:135], v2, s[40:43], s53 offen offset:1024 sc1
    buffer_load_dwordx4 v[136:139], v2, s[40:43], s53 offen offset:2048 sc1
    buffer_load_dwordx4 v[140:143], v2, s[40:43], s53 offen offset:3072 sc1
    s_add_u32 s53, s69, 1
    s_and_b32 s53, s53, 7
    s_lshl_b32 s53, s53, 12
    s_add_u32 s53, s53, s52
    buffer_load_dwordx4 v[144:147], v2, s[40:43], s53 offen offset:0 sc1
    buffer_load_dwordx4 v[148:151], v2, s[40:43], s53 offen offset:1024 sc1
    buffer_load_dwordx4 v[152:155], v2, s[40:43], s53 offen offset:2048 sc1
    buffer_load_dwordx4 v[156:159], v2, s[40:43], s53 offen offset:3072 sc1
    s_barrier
    s_add_u32 s53, s69, 2
    s_and_b32 s53, s53, 7
    s_lshl_b32 s53, s53, 12
    s_add_u32 s53, s53, s52
    buffer_load_dwordx4 v[160:163], v2, s[40:43], s53 offen offset:0 sc1
    buffer_load_dwordx4 v[164:167], v2, s[40:43], s53 offen offset:1024 sc1
    ds_read_b128 v[88:91], v11 offset:0
    ds_read_b128 v[92:95], v11 offset:16
    ds_read_b128 v[96:99], v11 offset:32
    ds_read_b128 v[100:103], v11 offset:48
    ds_read_b128 v[120:123], v13 offset:0
    ds_read_b128 v[104:107], v11 offset:128
    ds_read_b128 v[108:111], v11 offset:144
    ds_read_b128 v[112:115], v11 offset:160
    ds_read_b128 v[116:119], v11 offset:176
    ds_read_b128 v[124:127], v13 offset:1024
    s_waitcnt lgkmcnt(5)
    s_waitcnt vmcnt(8)
    v_smfmac_f32_32x32x32_bf16 v[88:103], v[120:123], v[128:135], v14
    ds_read_b64_tr_b16 v[64:65], v10 offset:0
    ds_read_b64_tr_b16 v[66:67], v10 offset:1024
    ds_read_b64_tr_b16 v[68:69], v12 offset:0
    ds_read_b64_tr_b16 v[70:71], v12 offset:1024
    buffer_load_dwordx4 v[168:171], v2, s[40:43], s53 offen offset:2048 sc1
    buffer_load_dwordx4 v[172:175], v2, s[40:43], s53 offen offset:3072 sc1
    s_nop 5
    v_cvt_pk_bf16_f32 v128, v88, v89
    v_cvt_pk_bf16_f32 v129, v90, v91
    v_cvt_pk_bf16_f32 v130, v92, v93
    v_cvt_pk_bf16_f32 v131, v94, v95
    v_cvt_pk_bf16_f32 v132, v96, v97
    v_cvt_pk_bf16_f32 v133, v98, v99
    v_cvt_pk_bf16_f32 v134, v100, v101
    v_cvt_pk_bf16_f32 v135, v102, v103
    s_waitcnt lgkmcnt(4)
    s_waitcnt vmcnt(8)
    v_smfmac_f32_32x32x32_bf16 v[104:119], v[124:127], v[136:143], v14
    ds_read_b64_tr_b16 v[72:73], v10 offset:2048
    ds_read_b64_tr_b16 v[74:75], v10 offset:3072
    ds_read_b64_tr_b16 v[76:77], v12 offset:2048
    ds_read_b64_tr_b16 v[78:79], v12 offset:3072
    s_waitcnt lgkmcnt(4)
    v_mfma_f32_32x32x16_bf16 v[32:47], v[128:131], v[64:67], v[32:47]
    ds_read_b128 v[88:91], v11 offset:256
    ds_read_b128 v[92:95], v11 offset:272
    ds_read_b128 v[96:99], v11 offset:288
    ds_read_b128 v[100:103], v11 offset:304
    ds_read_b128 v[120:123], v13 offset:2048
    v_mfma_f32_32x32x16_bf16 v[48:63], v[128:131], v[68:71], v[48:63]
    s_add_u32 s53, s69, 3
    s_and_b32 s53, s53, 7
    s_lshl_b32 s53, s53, 12
    s_add_u32 s53, s53, s52
    buffer_load_dwordx4 v[176:179], v2, s[40:43], s53 offen offset:0 sc1
    buffer_load_dwordx4 v[180:183], v2, s[40:43], s53 offen offset:1024 sc1
    buffer_load_dwordx4 v[184:187], v2, s[40:43], s53 offen offset:2048 sc1
    s_waitcnt lgkmcnt(5)
    v_mfma_f32_32x32x16_bf16 v[32:47], v[132:135], v[72:75], v[32:47]
    ds_read_b64_tr_b16 v[64:65], v10 offset:4096
    ds_read_b64_tr_b16 v[66:67], v10 offset:5120
    ds_read_b64_tr_b16 v[68:69], v12 offset:4096
    ds_read_b64_tr_b16 v[70:71], v12 offset:5120
    v_cvt_pk_bf16_f32 v136, v104, v105
    v_cvt_pk_bf16_f32 v137, v106, v107
    v_cvt_pk_bf16_f32 v138, v108, v109
    v_mfma_f32_32x32x16_bf16 v[48:63], v[132:135], v[76:79], v[48:63]
    v_cvt_pk_bf16_f32 v139, v110, v111
    v_cvt_pk_bf16_f32 v140, v112, v113
    v_cvt_pk_bf16_f32 v141, v114, v115
    v_cvt_pk_bf16_f32 v142, v116, v117
    v_cvt_pk_bf16_f32 v143, v118, v119
    s_waitcnt lgkmcnt(4)
    s_waitcnt vmcnt(9)
    v_smfmac_f32_32x32x32_bf16 v[88:103], v[120:123], v[144:151], v14
    ds_read_b64_tr_b16 v[72:73], v10 offset:6144
    ds_read_b64_tr_b16 v[74:75], v10 offset:7168
    ds_read_b64_tr_b16 v[76:77], v12 offset:6144
    ds_read_b64_tr_b16 v[78:79], v12 offset:7168
    s_waitcnt lgkmcnt(4)
    v_mfma_f32_32x32x16_bf16 v[32:47], v[136:139], v[64:67], v[32:47]
    ds_read_b128 v[104:107], v11 offset:384
    ds_read_b128 v[108:111], v11 offset:400
    ds_read_b128 v[112:115], v11 offset:416
    ds_read_b128 v[116:119], v11 offset:432
    ds_read_b128 v[124:127], v13 offset:3072
    v_mfma_f32_32x32x16_bf16 v[48:63], v[136:139], v[68:71], v[48:63]
    buffer_load_dwordx4 v[188:191], v2, s[40:43], s53 offen offset:3072 sc1
    s_add_u32 s53, s69, 4
    s_and_b32 s53, s53, 7
    s_lshl_b32 s53, s53, 12
    s_add_u32 s53, s53, s52
    buffer_load_dwordx4 v[192:195], v2, s[40:43], s53 offen offset:0 sc1
    buffer_load_dwordx4 v[196:199], v2, s[40:43], s53 offen offset:1024 sc1
    s_waitcnt lgkmcnt(5)
    v_mfma_f32_32x32x16_bf16 v[32:47], v[140:143], v[72:75], v[32:47]
    ds_read_b64_tr_b16 v[64:65], v10 offset:8192
    ds_read_b64_tr_b16 v[66:67], v10 offset:9216
    ds_read_b64_tr_b16 v[68:69], v12 offset:8192
    ds_read_b64_tr_b16 v[70:71], v12 offset:9216
    v_cvt_pk_bf16_f32 v144, v88, v89
    v_cvt_pk_bf16_f32 v145, v90, v91
    v_cvt_pk_bf16_f32 v146, v92, v93
    v_mfma_f32_32x32x16_bf16 v[48:63], v[140:143], v[76:79], v[48:63]
    v_cvt_pk_bf16_f32 v147, v94, v95
    v_cvt_pk_bf16_f32 v148, v96, v97
    v_cvt_pk_bf16_f32 v149, v98, v99
    v_cvt_pk_bf16_f32 v150, v100, v101
    v_cvt_pk_bf16_f32 v151, v102, v103
    s_waitcnt lgkmcnt(4)
    s_waitcnt vmcnt(10)
    v_smfmac_f32_32x32x32_bf16 v[104:119], v[124:127], v[152:159], v14
    ds_read_b64_tr_b16 v[72:73], v10 offset:10240
    ds_read_b64_tr_b16 v[74:75], v10 offset:11264
    ds_read_b64_tr_b16 v[76:77], v12 offset:10240
    ds_read_b64_tr_b16 v[78:79], v12 offset:11264
    s_waitcnt lgkmcnt(4)
    v_mfma_f32_32x32x16_bf16 v[32:47], v[144:147], v[64:67], v[32:47]
    ds_read_b128 v[88:91], v11 offset:512
    ds_read_b128 v[92:95], v11 offset:528
    ds_read_b128 v[96:99], v11 offset:544
    ds_read_b128 v[100:103], v11 offset:560
    ds_read_b128 v[120:123], v13 offset:4096
    v_mfma_f32_32x32x16_bf16 v[48:63], v[144:147], v[68:71], v[48:63]
    buffer_load_dwordx4 v[200:203], v2, s[40:43], s53 offen offset:2048 sc1
    buffer_load_dwordx4 v[204:207], v2, s[40:43], s53 offen offset:3072 sc1
    s_add_u32 s53, s69, 5
    s_and_b32 s53, s53, 7
    s_lshl_b32 s53, s53, 12
    s_add_u32 s53, s53, s52
    buffer_load_dwordx4 v[208:211], v2, s[40:43], s53 offen offset:0 sc1
    s_waitcnt lgkmcnt(5)
    v_mfma_f32_32x32x16_bf16 v[32:47], v[148:151], v[72:75], v[32:47]
    ds_read_b64_tr_b16 v[64:65], v10 offset:12288
    ds_read_b64_tr_b16 v[66:67], v10 offset:13312
    ds_read_b64_tr_b16 v[68:69], v12 offset:12288
    ds_read_b64_tr_b16 v[70:71], v12 offset:13312
    v_cvt_pk_bf16_f32 v152, v104, v105
    v_cvt_pk_bf16_f32 v153, v106, v107
    v_cvt_pk_bf16_f32 v154, v108, v109
    v_mfma_f32_32x32x16_bf16 v[48:63], v[148:151], v[76:79], v[48:63]
    v_cvt_pk_bf16_f32 v155, v110, v111
    v_cvt_pk_bf16_f32 v156, v112, v113
    v_cvt_pk_bf16_f32 v157, v114, v115
    v_cvt_pk_bf16_f32 v158, v116, v117
    v_cvt_pk_bf16_f32 v159, v118, v119
    s_waitcnt lgkmcnt(4)
    s_waitcnt vmcnt(11)
    v_smfmac_f32_32x32x32_bf16 v[88:103], v[120:123], v[160:167], v14
    ds_read_b64_tr_b16 v[72:73], v10 offset:14336
    ds_read_b64_tr_b16 v[74:75], v10 offset:15360
    ds_read_b64_tr_b16 v[76:77], v12 offset:14336
    ds_read_b64_tr_b16 v[78:79], v12 offset:15360
    s_waitcnt lgkmcnt(4)
    v_mfma_f32_32x32x16_bf16 v[32:47], v[152:155], v[64:67], v[32:47]
    ds_read_b128 v[104:107], v11 offset:640
    ds_read_b128 v[108:111], v11 offset:656
    ds_read_b128 v[112:115], v11 offset:672
    ds_read_b128 v[116:119], v11 offset:688
    ds_read_b128 v[124:127], v13 offset:5120
    v_mfma_f32_32x32x16_bf16 v[48:63], v[152:155], v[68:71], v[48:63]
    buffer_load_dwordx4 v[212:215], v2, s[40:43], s53 offen offset:1024 sc1
    buffer_load_dwordx4 v[216:219], v2, s[40:43], s53 offen offset:2048 sc1
    buffer_load_dwordx4 v[220:223], v2, s[40:43], s53 offen offset:3072 sc1
    s_waitcnt lgkmcnt(5)
    v_mfma_f32_32x32x16_bf16 v[32:47], v[156:159], v[72:75], v[32:47]
    ds_read_b64_tr_b16 v[64:65], v10 offset:16384
    ds_read_b64_tr_b16 v[66:67], v10 offset:17408
    ds_read_b64_tr_b16 v[68:69], v12 offset:16384
    ds_read_b64_tr_b16 v[70:71], v12 offset:17408
    v_cvt_pk_bf16_f32 v160, v88, v89
    v_cvt_pk_bf16_f32 v161, v90, v91
    v_cvt_pk_bf16_f32 v162, v92, v93
    v_mfma_f32_32x32x16_bf16 v[48:63], v[156:159], v[76:79], v[48:63]
    v_cvt_pk_bf16_f32 v163, v94, v95
    v_cvt_pk_bf16_f32 v164, v96, v97
    v_cvt_pk_bf16_f32 v165, v98, v99
    v_cvt_pk_bf16_f32 v166, v100, v101
    v_cvt_pk_bf16_f32 v167, v102, v103
    s_waitcnt lgkmcnt(4)
    s_waitcnt vmcnt(12)
    v_smfmac_f32_32x32x32_bf16 v[104:119], v[124:127], v[168:175], v14
    ds_read_b64_tr_b16 v[72:73], v10 offset:18432
    ds_read_b64_tr_b16 v[74:75], v10 offset:19456
    ds_read_b64_tr_b16 v[76:77], v12 offset:18432
    ds_read_b64_tr_b16 v[78:79], v12 offset:19456
    s_waitcnt lgkmcnt(4)
    v_mfma_f32_32x32x16_bf16 v[32:47], v[160:163], v[64:67], v[32:47]
    ds_read_b128 v[88:91], v11 offset:768
    ds_read_b128 v[92:95], v11 offset:784
    ds_read_b128 v[96:99], v11 offset:800
    ds_read_b128 v[100:103], v11 offset:816
    ds_read_b128 v[120:123], v13 offset:6144
    v_mfma_f32_32x32x16_bf16 v[48:63], v[160:163], v[68:71], v[48:63]
    s_add_u32 s53, s69, 6
    s_and_b32 s53, s53, 7
    s_lshl_b32 s53, s53, 12
    s_add_u32 s53, s53, s52
    buffer_load_dwordx4 v[224:227], v2, s[40:43], s53 offen offset:0 sc1
    buffer_load_dwordx4 v[228:231], v2, s[40:43], s53 offen offset:1024 sc1
    buffer_load_dwordx4 v[232:235], v2, s[40:43], s53 offen offset:2048 sc1
    s_waitcnt lgkmcnt(5)
    v_mfma_f32_32x32x16_bf16 v[32:47], v[164:167], v[72:75], v[32:47]
    ds_read_b64_tr_b16 v[64:65], v10 offset:20480
    ds_read_b64_tr_b16 v[66:67], v10 offset:21504
    ds_read_b64_tr_b16 v[68:69], v12 offset:20480
    ds_read_b64_tr_b16 v[70:71], v12 offset:21504
    v_cvt_pk_bf16_f32 v168, v104, v105
    v_cvt_pk_bf16_f32 v169, v106, v107
    v_cvt_pk_bf16_f32 v170, v108, v109
    v_mfma_f32_32x32x16_bf16 v[48:63], v[164:167], v[76:79], v[48:63]
    v_cvt_pk_bf16_f32 v171, v110, v111
    v_cvt_pk_bf16_f32 v172, v112, v113
    v_cvt_pk_bf16_f32 v173, v114, v115
    v_cvt_pk_bf16_f32 v174, v116, v117
    v_cvt_pk_bf16_f32 v175, v118, v119
    s_waitcnt lgkmcnt(4)
    s_waitcnt vmcnt(13)
    v_smfmac_f32_32x32x32_bf16 v[88:103], v[120:123], v[176:183], v14
    ds_read_b64_tr_b16 v[72:73], v10 offset:22528
    ds_read_b64_tr_b16 v[74:75], v10 offset:23552
    ds_read_b64_tr_b16 v[76:77], v12 offset:22528
    ds_read_b64_tr_b16 v[78:79], v12 offset:23552
    s_waitcnt lgkmcnt(4)
    v_mfma_f32_32x32x16_bf16 v[32:47], v[168:171], v[64:67], v[32:47]
    ds_read_b128 v[104:107], v11 offset:896
    ds_read_b128 v[108:111], v11 offset:912
    ds_read_b128 v[112:115], v11 offset:928
    ds_read_b128 v[116:119], v11 offset:944
    ds_read_b128 v[124:127], v13 offset:7168
    v_mfma_f32_32x32x16_bf16 v[48:63], v[168:171], v[68:71], v[48:63]
    buffer_load_dwordx4 v[236:239], v2, s[40:43], s53 offen offset:3072 sc1
    s_add_u32 s53, s69, 7
    s_and_b32 s53, s53, 7
    s_lshl_b32 s53, s53, 12
    s_add_u32 s53, s53, s52
    buffer_load_dwordx4 v[240:243], v2, s[40:43], s53 offen offset:0 sc1
    buffer_load_dwordx4 v[244:247], v2, s[40:43], s53 offen offset:1024 sc1
    s_waitcnt lgkmcnt(5)
    v_mfma_f32_32x32x16_bf16 v[32:47], v[172:175], v[72:75], v[32:47]
    ds_read_b64_tr_b16 v[64:65], v10 offset:24576
    ds_read_b64_tr_b16 v[66:67], v10 offset:25600
    ds_read_b64_tr_b16 v[68:69], v12 offset:24576
    ds_read_b64_tr_b16 v[70:71], v12 offset:25600
    v_cvt_pk_bf16_f32 v176, v88, v89
    v_cvt_pk_bf16_f32 v177, v90, v91
    v_cvt_pk_bf16_f32 v178, v92, v93
    v_mfma_f32_32x32x16_bf16 v[48:63], v[172:175], v[76:79], v[48:63]
    v_cvt_pk_bf16_f32 v179, v94, v95
    v_cvt_pk_bf16_f32 v180, v96, v97
    v_cvt_pk_bf16_f32 v181, v98, v99
    v_cvt_pk_bf16_f32 v182, v100, v101
    v_cvt_pk_bf16_f32 v183, v102, v103
    s_waitcnt lgkmcnt(4)
    s_waitcnt vmcnt(14)
    v_smfmac_f32_32x32x32_bf16 v[104:119], v[124:127], v[184:191], v14
    ds_read_b64_tr_b16 v[72:73], v10 offset:26624
    ds_read_b64_tr_b16 v[74:75], v10 offset:27648
    ds_read_b64_tr_b16 v[76:77], v12 offset:26624
    ds_read_b64_tr_b16 v[78:79], v12 offset:27648
    s_waitcnt lgkmcnt(4)
    v_mfma_f32_32x32x16_bf16 v[32:47], v[176:179], v[64:67], v[32:47]
    ds_read_b128 v[88:91], v11 offset:1024
    ds_read_b128 v[92:95], v11 offset:1040
    ds_read_b128 v[96:99], v11 offset:1056
    ds_read_b128 v[100:103], v11 offset:1072
    ds_read_b128 v[120:123], v13 offset:8192
    v_mfma_f32_32x32x16_bf16 v[48:63], v[176:179], v[68:71], v[48:63]
    buffer_load_dwordx4 v[248:251], v2, s[40:43], s53 offen offset:2048 sc1
    buffer_load_dwordx4 v[252:255], v2, s[40:43], s53 offen offset:3072 sc1
    s_barrier
    s_waitcnt lgkmcnt(5)
    v_mfma_f32_32x32x16_bf16 v[32:47], v[180:183], v[72:75], v[32:47]
    ds_read_b64_tr_b16 v[64:65], v10 offset:28672
    ds_read_b64_tr_b16 v[66:67], v10 offset:29696
    ds_read_b64_tr_b16 v[68:69], v12 offset:28672
    ds_read_b64_tr_b16 v[70:71], v12 offset:29696
    v_cvt_pk_bf16_f32 v184, v104, v105
    v_cvt_pk_bf16_f32 v185, v106, v107
    v_cvt_pk_bf16_f32 v186, v108, v109
    v_mfma_f32_32x32x16_bf16 v[48:63], v[180:183], v[76:79], v[48:63]
    v_cvt_pk_bf16_f32 v187, v110, v111
    v_cvt_pk_bf16_f32 v188, v112, v113
    v_cvt_pk_bf16_f32 v189, v114, v115
    v_cvt_pk_bf16_f32 v190, v116, v117
    v_cvt_pk_bf16_f32 v191, v118, v119
    s_waitcnt lgkmcnt(4)
    s_waitcnt vmcnt(14)
    v_smfmac_f32_32x32x32_bf16 v[88:103], v[120:123], v[192:199], v14
    ds_read_b64_tr_b16 v[72:73], v10 offset:30720
    ds_read_b64_tr_b16 v[74:75], v10 offset:31744
    ds_read_b64_tr_b16 v[76:77], v12 offset:30720
    ds_read_b64_tr_b16 v[78:79], v12 offset:31744
    s_waitcnt lgkmcnt(4)
    v_mfma_f32_32x32x16_bf16 v[32:47], v[184:187], v[64:67], v[32:47]
    ds_read_b128 v[104:107], v11 offset:1152
    ds_read_b128 v[108:111], v11 offset:1168
    ds_read_b128 v[112:115], v11 offset:1184
    ds_read_b128 v[116:119], v11 offset:1200
    ds_read_b128 v[124:127], v13 offset:9216
    v_mfma_f32_32x32x16_bf16 v[48:63], v[184:187], v[68:71], v[48:63]
    s_waitcnt lgkmcnt(5)
    v_mfma_f32_32x32x16_bf16 v[32:47], v[188:191], v[72:75], v[32:47]
    ds_read_b64_tr_b16 v[64:65], v10 offset:32768
    ds_read_b64_tr_b16 v[66:67], v10 offset:33792
    ds_read_b64_tr_b16 v[68:69], v12 offset:32768
    ds_read_b64_tr_b16 v[70:71], v12 offset:33792
    v_cvt_pk_bf16_f32 v192, v88, v89
    v_cvt_pk_bf16_f32 v193, v90, v91
    v_cvt_pk_bf16_f32 v194, v92, v93
    v_mfma_f32_32x32x16_bf16 v[48:63], v[188:191], v[76:79], v[48:63]
    v_cvt_pk_bf16_f32 v195, v94, v95
    v_cvt_pk_bf16_f32 v196, v96, v97
    v_cvt_pk_bf16_f32 v197, v98, v99
    v_cvt_pk_bf16_f32 v198, v100, v101
    v_cvt_pk_bf16_f32 v199, v102, v103
    s_waitcnt lgkmcnt(4)
    s_waitcnt vmcnt(12)
    v_smfmac_f32_32x32x32_bf16 v[104:119], v[124:127], v[200:207], v14
    ds_read_b64_tr_b16 v[72:73], v10 offset:34816
    ds_read_b64_tr_b16 v[74:75], v10 offset:35840
    ds_read_b64_tr_b16 v[76:77], v12 offset:34816
    ds_read_b64_tr_b16 v[78:79], v12 offset:35840
    s_waitcnt lgkmcnt(4)
    v_mfma_f32_32x32x16_bf16 v[32:47], v[192:195], v[64:67], v[32:47]
    ds_read_b128 v[88:91], v11 offset:1280
    ds_read_b128 v[92:95], v11 offset:1296
    ds_read_b128 v[96:99], v11 offset:1312
    ds_read_b128 v[100:103], v11 offset:1328
    ds_read_b128 v[120:123], v13 offset:10240
    v_mfma_f32_32x32x16_bf16 v[48:63], v[192:195], v[68:71], v[48:63]
    s_waitcnt lgkmcnt(5)
    v_mfma_f32_32x32x16_bf16 v[32:47], v[196:199], v[72:75], v[32:47]
    ds_read_b64_tr_b16 v[64:65], v10 offset:36864
    ds_read_b64_tr_b16 v[66:67], v10 offset:37888
    ds_read_b64_tr_b16 v[68:69], v12 offset:36864
    ds_read_b64_tr_b16 v[70:71], v12 offset:37888
    v_cvt_pk_bf16_f32 v200, v104, v105
    v_cvt_pk_bf16_f32 v201, v106, v107
    v_cvt_pk_bf16_f32 v202, v108, v109
    v_mfma_f32_32x32x16_bf16 v[48:63], v[196:199], v[76:79], v[48:63]
    v_cvt_pk_bf16_f32 v203, v110, v111
    v_cvt_pk_bf16_f32 v204, v112, v113
    v_cvt_pk_bf16_f32 v205, v114, v115
    v_cvt_pk_bf16_f32 v206, v116, v117
    v_cvt_pk_bf16_f32 v207, v118, v119
    s_waitcnt lgkmcnt(4)
    s_waitcnt vmcnt(10)
    v_smfmac_f32_32x32x32_bf16 v[88:103], v[120:123], v[208:215], v14
    ds_read_b64_tr_b16 v[72:73], v10 offset:38912
    ds_read_b64_tr_b16 v[74:75], v10 offset:39936
    ds_read_b64_tr_b16 v[76:77], v12 offset:38912
    ds_read_b64_tr_b16 v[78:79], v12 offset:39936
    s_waitcnt lgkmcnt(4)
    v_mfma_f32_32x32x16_bf16 v[32:47], v[200:203], v[64:67], v[32:47]
    ds_read_b128 v[104:107], v11 offset:1408
    ds_read_b128 v[108:111], v11 offset:1424
    ds_read_b128 v[112:115], v11 offset:1440
    ds_read_b128 v[116:119], v11 offset:1456
    ds_read_b128 v[124:127], v13 offset:11264
    v_mfma_f32_32x32x16_bf16 v[48:63], v[200:203], v[68:71], v[48:63]
    s_waitcnt lgkmcnt(5)
    v_mfma_f32_32x32x16_bf16 v[32:47], v[204:207], v[72:75], v[32:47]
    ds_read_b64_tr_b16 v[64:65], v10 offset:40960
    ds_read_b64_tr_b16 v[66:67], v10 offset:41984
    ds_read_b64_tr_b16 v[68:69], v12 offset:40960
    ds_read_b64_tr_b16 v[70:71], v12 offset:41984
    v_cvt_pk_bf16_f32 v208, v88, v89
    v_cvt_pk_bf16_f32 v209, v90, v91
    v_cvt_pk_bf16_f32 v210, v92, v93
    v_mfma_f32_32x32x16_bf16 v[48:63], v[204:207], v[76:79], v[48:63]
    v_cvt_pk_bf16_f32 v211, v94, v95
    v_cvt_pk_bf16_f32 v212, v96, v97
    v_cvt_pk_bf16_f32 v213, v98, v99
    v_cvt_pk_bf16_f32 v214, v100, v101
    v_cvt_pk_bf16_f32 v215, v102, v103
    s_waitcnt lgkmcnt(4)
    s_waitcnt vmcnt(8)
    v_smfmac_f32_32x32x32_bf16 v[104:119], v[124:127], v[216:223], v14
    ds_read_b64_tr_b16 v[72:73], v10 offset:43008
    ds_read_b64_tr_b16 v[74:75], v10 offset:44032
    ds_read_b64_tr_b16 v[76:77], v12 offset:43008
    ds_read_b64_tr_b16 v[78:79], v12 offset:44032
    s_waitcnt lgkmcnt(4)
    v_mfma_f32_32x32x16_bf16 v[32:47], v[208:211], v[64:67], v[32:47]
    ds_read_b128 v[88:91], v11 offset:1536
    ds_read_b128 v[92:95], v11 offset:1552
    ds_read_b128 v[96:99], v11 offset:1568
    ds_read_b128 v[100:103], v11 offset:1584
    ds_read_b128 v[120:123], v13 offset:12288
    v_mfma_f32_32x32x16_bf16 v[48:63], v[208:211], v[68:71], v[48:63]
    s_waitcnt lgkmcnt(5)
    v_mfma_f32_32x32x16_bf16 v[32:47], v[212:215], v[72:75], v[32:47]
    ds_read_b64_tr_b16 v[64:65], v10 offset:45056
    ds_read_b64_tr_b16 v[66:67], v10 offset:46080
    ds_read_b64_tr_b16 v[68:69], v12 offset:45056
    ds_read_b64_tr_b16 v[70:71], v12 offset:46080
    v_cvt_pk_bf16_f32 v216, v104, v105
    v_cvt_pk_bf16_f32 v217, v106, v107
    v_cvt_pk_bf16_f32 v218, v108, v109
    v_mfma_f32_32x32x16_bf16 v[48:63], v[212:215], v[76:79], v[48:63]
    v_cvt_pk_bf16_f32 v219, v110, v111
    v_cvt_pk_bf16_f32 v220, v112, v113
    v_cvt_pk_bf16_f32 v221, v114, v115
    v_cvt_pk_bf16_f32 v222, v116, v117
    v_cvt_pk_bf16_f32 v223, v118, v119
    s_waitcnt lgkmcnt(4)
    s_waitcnt vmcnt(6)
    v_smfmac_f32_32x32x32_bf16 v[88:103], v[120:123], v[224:231], v14
    ds_read_b64_tr_b16 v[72:73], v10 offset:47104
    ds_read_b64_tr_b16 v[74:75], v10 offset:48128
    ds_read_b64_tr_b16 v[76:77], v12 offset:47104
    ds_read_b64_tr_b16 v[78:79], v12 offset:48128
    s_waitcnt lgkmcnt(4)
    v_mfma_f32_32x32x16_bf16 v[32:47], v[216:219], v[64:67], v[32:47]
    ds_read_b128 v[104:107], v11 offset:1664
    ds_read_b128 v[108:111], v11 offset:1680
    ds_read_b128 v[112:115], v11 offset:1696
    ds_read_b128 v[116:119], v11 offset:1712
    ds_read_b128 v[124:127], v13 offset:13312
    v_mfma_f32_32x32x16_bf16 v[48:63], v[216:219], v[68:71], v[48:63]
    s_waitcnt lgkmcnt(5)
    v_mfma_f32_32x32x16_bf16 v[32:47], v[220:223], v[72:75], v[32:47]
    ds_read_b64_tr_b16 v[64:65], v10 offset:49152
    ds_read_b64_tr_b16 v[66:67], v10 offset:50176
    ds_read_b64_tr_b16 v[68:69], v12 offset:49152
    ds_read_b64_tr_b16 v[70:71], v12 offset:50176
    v_cvt_pk_bf16_f32 v224, v88, v89
    v_cvt_pk_bf16_f32 v225, v90, v91
    v_cvt_pk_bf16_f32 v226, v92, v93
    v_mfma_f32_32x32x16_bf16 v[48:63], v[220:223], v[76:79], v[48:63]
    v_cvt_pk_bf16_f32 v227, v94, v95
    v_cvt_pk_bf16_f32 v228, v96, v97
    v_cvt_pk_bf16_f32 v229, v98, v99
    v_cvt_pk_bf16_f32 v230, v100, v101
    v_cvt_pk_bf16_f32 v231, v102, v103
    s_waitcnt lgkmcnt(4)
    s_waitcnt vmcnt(4)
    v_smfmac_f32_32x32x32_bf16 v[104:119], v[124:127], v[232:239], v14
    ds_read_b64_tr_b16 v[72:73], v10 offset:51200
    ds_read_b64_tr_b16 v[74:75], v10 offset:52224
    ds_read_b64_tr_b16 v[76:77], v12 offset:51200
    ds_read_b64_tr_b16 v[78:79], v12 offset:52224
    s_waitcnt lgkmcnt(4)
    v_mfma_f32_32x32x16_bf16 v[32:47], v[224:227], v[64:67], v[32:47]
    ds_read_b128 v[88:91], v11 offset:1792
    ds_read_b128 v[92:95], v11 offset:1808
    ds_read_b128 v[96:99], v11 offset:1824
    ds_read_b128 v[100:103], v11 offset:1840
    ds_read_b128 v[120:123], v13 offset:14336
    v_mfma_f32_32x32x16_bf16 v[48:63], v[224:227], v[68:71], v[48:63]
    s_waitcnt lgkmcnt(5)
    v_mfma_f32_32x32x16_bf16 v[32:47], v[228:231], v[72:75], v[32:47]
    ds_read_b64_tr_b16 v[64:65], v10 offset:53248
    ds_read_b64_tr_b16 v[66:67], v10 offset:54272
    ds_read_b64_tr_b16 v[68:69], v12 offset:53248
    ds_read_b64_tr_b16 v[70:71], v12 offset:54272
    v_cvt_pk_bf16_f32 v232, v104, v105
    v_cvt_pk_bf16_f32 v233, v106, v107
    v_cvt_pk_bf16_f32 v234, v108, v109
    v_mfma_f32_32x32x16_bf16 v[48:63], v[228:231], v[76:79], v[48:63]
    v_cvt_pk_bf16_f32 v235, v110, v111
    v_cvt_pk_bf16_f32 v236, v112, v113
    v_cvt_pk_bf16_f32 v237, v114, v115
    v_cvt_pk_bf16_f32 v238, v116, v117
    v_cvt_pk_bf16_f32 v239, v118, v119
    s_waitcnt lgkmcnt(4)
    s_waitcnt vmcnt(2)
    v_smfmac_f32_32x32x32_bf16 v[88:103], v[120:123], v[240:247], v14
    ds_read_b64_tr_b16 v[72:73], v10 offset:55296
    ds_read_b64_tr_b16 v[74:75], v10 offset:56320
    ds_read_b64_tr_b16 v[76:77], v12 offset:55296
    ds_read_b64_tr_b16 v[78:79], v12 offset:56320
    s_waitcnt lgkmcnt(4)
    v_mfma_f32_32x32x16_bf16 v[32:47], v[232:235], v[64:67], v[32:47]
    ds_read_b128 v[104:107], v11 offset:1920
    ds_read_b128 v[108:111], v11 offset:1936
    ds_read_b128 v[112:115], v11 offset:1952
    ds_read_b128 v[116:119], v11 offset:1968
    ds_read_b128 v[124:127], v13 offset:15360
    v_mfma_f32_32x32x16_bf16 v[48:63], v[232:235], v[68:71], v[48:63]
    s_waitcnt lgkmcnt(5)
    v_mfma_f32_32x32x16_bf16 v[32:47], v[236:239], v[72:75], v[32:47]
    ds_read_b64_tr_b16 v[64:65], v10 offset:57344
    ds_read_b64_tr_b16 v[66:67], v10 offset:58368
    ds_read_b64_tr_b16 v[68:69], v12 offset:57344
    ds_read_b64_tr_b16 v[70:71], v12 offset:58368
    v_cvt_pk_bf16_f32 v240, v88, v89
    v_cvt_pk_bf16_f32 v241, v90, v91
    v_cvt_pk_bf16_f32 v242, v92, v93
    v_mfma_f32_32x32x16_bf16 v[48:63], v[236:239], v[76:79], v[48:63]
    v_cvt_pk_bf16_f32 v243, v94, v95
    v_cvt_pk_bf16_f32 v244, v96, v97
    v_cvt_pk_bf16_f32 v245, v98, v99
    v_cvt_pk_bf16_f32 v246, v100, v101
    v_cvt_pk_bf16_f32 v247, v102, v103
    s_waitcnt lgkmcnt(4)
    s_waitcnt vmcnt(0)
    v_smfmac_f32_32x32x32_bf16 v[104:119], v[124:127], v[248:255], v14
    ds_read_b64_tr_b16 v[72:73], v10 offset:59392
    ds_read_b64_tr_b16 v[74:75], v10 offset:60416
    ds_read_b64_tr_b16 v[76:77], v12 offset:59392
    ds_read_b64_tr_b16 v[78:79], v12 offset:60416
    s_waitcnt lgkmcnt(4)
    v_mfma_f32_32x32x16_bf16 v[32:47], v[240:243], v[64:67], v[32:47]
    v_mfma_f32_32x32x16_bf16 v[48:63], v[240:243], v[68:71], v[48:63]
    s_waitcnt lgkmcnt(0)
    v_mfma_f32_32x32x16_bf16 v[32:47], v[244:247], v[72:75], v[32:47]
    ds_read_b64_tr_b16 v[64:65], v10 offset:61440
    ds_read_b64_tr_b16 v[66:67], v10 offset:62464
    ds_read_b64_tr_b16 v[68:69], v12 offset:61440
    ds_read_b64_tr_b16 v[70:71], v12 offset:62464
    v_cvt_pk_bf16_f32 v248, v104, v105
    v_cvt_pk_bf16_f32 v249, v106, v107
    v_cvt_pk_bf16_f32 v250, v108, v109
    v_mfma_f32_32x32x16_bf16 v[48:63], v[244:247], v[76:79], v[48:63]
    v_cvt_pk_bf16_f32 v251, v110, v111
    v_cvt_pk_bf16_f32 v252, v112, v113
    v_cvt_pk_bf16_f32 v253, v114, v115
    v_cvt_pk_bf16_f32 v254, v116, v117
    v_cvt_pk_bf16_f32 v255, v118, v119
    ds_read_b64_tr_b16 v[72:73], v10 offset:63488
    ds_read_b64_tr_b16 v[74:75], v10 offset:64512
    ds_read_b64_tr_b16 v[76:77], v12 offset:63488
    ds_read_b64_tr_b16 v[78:79], v12 offset:64512
    s_waitcnt lgkmcnt(4)
    v_mfma_f32_32x32x16_bf16 v[32:47], v[248:251], v[64:67], v[32:47]
    v_mfma_f32_32x32x16_bf16 v[48:63], v[248:251], v[68:71], v[48:63]
    s_waitcnt lgkmcnt(0)
    v_mfma_f32_32x32x16_bf16 v[32:47], v[252:255], v[72:75], v[32:47]
    v_mfma_f32_32x32x16_bf16 v[48:63], v[252:255], v[76:79], v[48:63]
    s_add_u32 s54, s54, 0x600000
    v_and_b32 v6, 15, v1
    v_lshlrev_b32 v6, 4, v6
    v_bfe_u32 v7, v1, 5, 1
    v_lshl_add_u32 v6, v7, 8, v6
    v_bfe_u32 v7, v1, 4, 1
    v_lshl_add_u32 v6, v7, 16, v6
    s_nop 3
    v_cvt_pk_bf16_f32 v112, v32, v33
    v_cvt_pk_bf16_f32 v113, v34, v35
    v_cvt_pk_bf16_f32 v114, v36, v37
    v_cvt_pk_bf16_f32 v115, v38, v39
    buffer_store_dwordx4 v[112:115], v6, s[40:43], s54 offen offset:0 sc1
    v_cvt_pk_bf16_f32 v116, v40, v41
    v_cvt_pk_bf16_f32 v117, v42, v43
    v_cvt_pk_bf16_f32 v118, v44, v45
    v_cvt_pk_bf16_f32 v119, v46, v47
    buffer_store_dwordx4 v[116:119], v6, s[40:43], s54 offen offset:512 sc1
    s_add_u32 s54, s54, 131072
    v_cvt_pk_bf16_f32 v120, v48, v49
    v_cvt_pk_bf16_f32 v121, v50, v51
    v_cvt_pk_bf16_f32 v122, v52, v53
    v_cvt_pk_bf16_f32 v123, v54, v55
    buffer_store_dwordx4 v[120:123], v6, s[40:43], s54 offen offset:0 sc1
    v_cvt_pk_bf16_f32 v124, v56, v57
    v_cvt_pk_bf16_f32 v125, v58, v59
    v_cvt_pk_bf16_f32 v126, v60, v61
    v_cvt_pk_bf16_f32 v127, v62, v63
    buffer_store_dwordx4 v[124:127], v6, s[40:43], s54 offen offset:512 sc1
La_kvd:
    s_lshl_b32 s57, s44, 10
    s_add_u32 s57, s57, 147456
    v_add_u32 v7, s57, v2
    s_lshl_b32 s58, s46, 6
    s_add_u32 s58, s58, s67
    s_lshr_b32 s50, s58, 3
    s_lshl_b32 s50, s50, 7
    s_and_b32 s51, s58, 7
    s_lshl_b32 s51, s51, 2
    s_add_u32 s51, s51, s50
    s_add_u32 s51, s51, 0x52000
    v_bfe_u32 v10, v0, 2, 2
    v_bfe_u32 v12, v0, 5, 1
    v_lshl_add_u32 v10, v12, 2, v10
    v_lshlrev_b32 v10, 6, v10
    v_bfe_u32 v12, v0, 4, 1
    v_lshl_add_u32 v10, v12, 5, v10
    v_and_b32 v12, 3, v0
    v_lshl_add_u32 v10, v12, 3, v10
    v_add_u32 v10, 65536, v10
    s_barrier
    ds_read_b64_tr_b16 v[96:97], v10 offset:0
    ds_read_b64_tr_b16 v[98:99], v10 offset:512
    ds_read_b64_tr_b16 v[100:101], v10 offset:1024
    ds_read_b64_tr_b16 v[102:103], v10 offset:1536
    ds_read_b64_tr_b16 v[104:105], v10 offset:2048
    ds_read_b64_tr_b16 v[106:107], v10 offset:2560
    ds_read_b64_tr_b16 v[108:109], v10 offset:3072
    ds_read_b64_tr_b16 v[110:111], v10 offset:3584
    s_waitcnt lgkmcnt(6)
    v_mfma_f32_32x32x16_bf16 v[16:31], v[96:99], v[128:131], v[16:31]
    s_and_b32 s54, s44, 1
    s_lshr_b32 s55, s44, 1
    v_and_b32 v4, 15, v1
    v_lshlrev_b32 v4, 4, v4
    v_bfe_u32 v5, v1, 5, 1
    v_lshl_add_u32 v4, v5, 8, v4
    ds_read_b64_tr_b16 v[96:97], v10 offset:4096
    ds_read_b64_tr_b16 v[98:99], v10 offset:4608
    s_waitcnt lgkmcnt(6)
    v_mfma_f32_32x32x16_bf16 v[16:31], v[100:103], v[132:135], v[16:31]
    s_lshl_b32 s58, s46, 1
    s_add_u32 s58, s58, s54
    s_lshl_b32 s59, s58, 16
    s_lshl_b32 s52, s55, 14
    s_add_u32 s52, s52, s59
    s_add_u32 s56, s52, 0x400000
    ds_read_b64_tr_b16 v[100:101], v10 offset:5120
    ds_read_b64_tr_b16 v[102:103], v10 offset:5632
    s_waitcnt lgkmcnt(6)
    v_mfma_f32_32x32x16_bf16 v[16:31], v[104:107], v[136:139], v[16:31]
    s_add_u32 s57, s52, 0x600000
    s_mov_b32 s60, 0x0000ffff
    s_mov_b32 s61, 0x0000ffff
    s_lshl_b32 s52, s55, 8
    s_lshr_b32 s53, s46, 1
    s_lshl_b32 s53, s53, 11
    ds_read_b64_tr_b16 v[104:105], v10 offset:6144
    ds_read_b64_tr_b16 v[106:107], v10 offset:6656
    s_waitcnt lgkmcnt(6)
    v_mfma_f32_32x32x16_bf16 v[16:31], v[108:111], v[140:143], v[16:31]
    s_add_u32 s52, s52, s53
    s_add_u32 s62, s52, 0x52000
    s_and_b32 s65, s45, 3
    s_lshl_b32 s65, s65, 12
    v_lshrrev_b32 v6, 2, v1
    v_and_b32 v11, 3, v1
    ds_read_b64_tr_b16 v[108:109], v10 offset:7168
    ds_read_b64_tr_b16 v[110:111], v10 offset:7680
    s_waitcnt lgkmcnt(6)
    v_mfma_f32_32x32x16_bf16 v[16:31], v[96:99], v[144:147], v[16:31]
    v_lshlrev_b32 v12, 10, v6
    v_lshl_add_u32 v12, v11, 4, v12
    v_lshrrev_b32 v6, 2, v1
    v_and_b32 v11, 3, v1
    v_mul_u32_u24 v13, 3584, v6
    v_lshl_add_u32 v13, v11, 4, v13
    ds_read_b64_tr_b16 v[96:97], v10 offset:8192
    ds_read_b64_tr_b16 v[98:99], v10 offset:8704
    s_waitcnt lgkmcnt(6)
    v_mfma_f32_32x32x16_bf16 v[16:31], v[100:103], v[148:151], v[16:31]
    v_lshrrev_b32 v6, 1, v1
    v_and_b32 v11, 0x13, v6
    v_bfe_u32 v15, v6, 2, 1
    v_lshl_add_u32 v11, v15, 3, v11
    v_bfe_u32 v15, v6, 3, 1
    v_lshl_add_u32 v11, v15, 2, v11
    ds_read_b64_tr_b16 v[100:101], v10 offset:9216
    ds_read_b64_tr_b16 v[102:103], v10 offset:9728
    s_waitcnt lgkmcnt(6)
    v_mfma_f32_32x32x16_bf16 v[16:31], v[104:107], v[152:155], v[16:31]
    v_mul_u32_u24 v14, 3584, v11
    v_and_b32 v11, 1, v1
    v_lshl_add_u32 v14, v11, 4, v14
    v_and_b32 v5, 7, v1
    v_lshlrev_b32 v5, 2, v5
    v_bfe_u32 v6, v1, 3, 1
    ds_read_b64_tr_b16 v[104:105], v10 offset:10240
    ds_read_b64_tr_b16 v[106:107], v10 offset:10752
    s_waitcnt lgkmcnt(6)
    v_mfma_f32_32x32x16_bf16 v[16:31], v[108:111], v[156:159], v[16:31]
    v_lshl_add_u32 v5, v6, 7, v5
    v_bfe_u32 v6, v1, 4, 1
    v_lshl_add_u32 v5, v6, 10, v5
    v_and_b32 v6, 0x1b, v1
    v_cmp_eq_u32 vcc, 16, v6
    v_mov_b32 v15, 0x3f803f80
    ds_read_b64_tr_b16 v[108:109], v10 offset:11264
    ds_read_b64_tr_b16 v[110:111], v10 offset:11776
    s_waitcnt lgkmcnt(6)
    v_mfma_f32_32x32x16_bf16 v[16:31], v[96:99], v[160:163], v[16:31]
    s_waitcnt vmcnt(0)
    v_mov_b32 v8, s47
    s_mov_b64 exec, 1
    buffer_store_dword v8, v3, s[40:43], s51 offen sc1
    s_mov_b64 exec, -1
    ds_read_b64_tr_b16 v[96:97], v10 offset:12288
    ds_read_b64_tr_b16 v[98:99], v10 offset:12800
    s_waitcnt lgkmcnt(6)
    v_mfma_f32_32x32x16_bf16 v[16:31], v[100:103], v[164:167], v[16:31]
    s_nop 0
    v_cndmask_b32 v15, 0, v15, vcc
    v_mov_b32 v32, 0
    v_mov_b32 v33, 0
    v_mov_b32 v34, 0
    v_mov_b32 v35, 0
    ds_read_b64_tr_b16 v[100:101], v10 offset:13312
    ds_read_b64_tr_b16 v[102:103], v10 offset:13824
    s_waitcnt lgkmcnt(6)
    v_mfma_f32_32x32x16_bf16 v[16:31], v[104:107], v[168:171], v[16:31]
    v_mov_b32 v36, 0
    v_mov_b32 v37, 0
    v_mov_b32 v38, 0
    v_mov_b32 v39, 0
    v_mov_b32 v40, 0
    v_mov_b32 v41, 0
    ds_read_b64_tr_b16 v[104:105], v10 offset:14336
    ds_read_b64_tr_b16 v[106:107], v10 offset:14848
    s_waitcnt lgkmcnt(6)
    v_mfma_f32_32x32x16_bf16 v[16:31], v[108:111], v[172:175], v[16:31]
    v_mov_b32 v42, 0
    v_mov_b32 v43, 0
    v_mov_b32 v44, 0
    v_mov_b32 v45, 0
    v_mov_b32 v46, 0
    v_mov_b32 v47, 0
    ds_read_b64_tr_b16 v[108:109], v10 offset:15360
    ds_read_b64_tr_b16 v[110:111], v10 offset:15872
    s_waitcnt lgkmcnt(6)
    v_mfma_f32_32x32x16_bf16 v[16:31], v[96:99], v[176:179], v[16:31]
    v_mov_b32 v48, 0
    v_mov_b32 v49, 0
    v_mov_b32 v50, 0
    v_mov_b32 v51, 0
    v_mov_b32 v52, 0
    v_mov_b32 v53, 0
    ds_read_b64_tr_b16 v[96:97], v10 offset:16384
    ds_read_b64_tr_b16 v[98:99], v10 offset:16896
    s_waitcnt lgkmcnt(6)
    v_mfma_f32_32x32x16_bf16 v[16:31], v[100:103], v[180:183], v[16:31]
    v_mov_b32 v54, 0
    v_mov_b32 v55, 0
    v_mov_b32 v56, 0
    v_mov_b32 v57, 0
    v_mov_b32 v58, 0
    v_mov_b32 v59, 0
    ds_read_b64_tr_b16 v[100:101], v10 offset:17408
    ds_read_b64_tr_b16 v[102:103], v10 offset:17920
    s_waitcnt lgkmcnt(6)
    v_mfma_f32_32x32x16_bf16 v[16:31], v[104:107], v[184:187], v[16:31]
    v_mov_b32 v60, 0
    v_mov_b32 v61, 0
    v_mov_b32 v62, 0
    v_mov_b32 v63, 0
    v_mov_b32 v64, 0
    v_mov_b32 v65, 0
    ds_read_b64_tr_b16 v[104:105], v10 offset:18432
    ds_read_b64_tr_b16 v[106:107], v10 offset:18944
    s_waitcnt lgkmcnt(6)
    v_mfma_f32_32x32x16_bf16 v[16:31], v[108:111], v[188:191], v[16:31]
    v_mov_b32 v66, 0
    v_mov_b32 v67, 0
    v_mov_b32 v68, 0
    v_mov_b32 v69, 0
    v_mov_b32 v70, 0
    v_mov_b32 v71, 0
    ds_read_b64_tr_b16 v[108:109], v10 offset:19456
    ds_read_b64_tr_b16 v[110:111], v10 offset:19968
    s_waitcnt lgkmcnt(6)
    v_mfma_f32_32x32x16_bf16 v[16:31], v[96:99], v[192:195], v[16:31]
    v_mov_b32 v72, 0
    v_mov_b32 v73, 0
    v_mov_b32 v74, 0
    v_mov_b32 v75, 0
    v_mov_b32 v76, 0
    v_mov_b32 v77, 0
    ds_read_b64_tr_b16 v[96:97], v10 offset:20480
    ds_read_b64_tr_b16 v[98:99], v10 offset:20992
    s_waitcnt lgkmcnt(6)
    v_mfma_f32_32x32x16_bf16 v[16:31], v[100:103], v[196:199], v[16:31]
    v_mov_b32 v78, 0
    v_mov_b32 v79, 0
    v_mov_b32 v80, 0
    v_mov_b32 v81, 0
    v_mov_b32 v82, 0
    v_mov_b32 v83, 0
    ds_read_b64_tr_b16 v[100:101], v10 offset:21504
    ds_read_b64_tr_b16 v[102:103], v10 offset:22016
    s_waitcnt lgkmcnt(6)
    v_mfma_f32_32x32x16_bf16 v[16:31], v[104:107], v[200:203], v[16:31]
    v_mov_b32 v84, 0
    v_mov_b32 v85, 0
    v_mov_b32 v86, 0
    v_mov_b32 v87, 0
    v_mov_b32 v88, 0
    v_mov_b32 v89, 0
    ds_read_b64_tr_b16 v[104:105], v10 offset:22528
    ds_read_b64_tr_b16 v[106:107], v10 offset:23040
    s_waitcnt lgkmcnt(6)
    v_mfma_f32_32x32x16_bf16 v[16:31], v[108:111], v[204:207], v[16:31]
    v_mov_b32 v90, 0
    v_mov_b32 v91, 0
    v_mov_b32 v92, 0
    v_mov_b32 v93, 0
    v_mov_b32 v94, 0
    v_mov_b32 v95, 0
    ds_read_b64_tr_b16 v[108:109], v10 offset:23552
    ds_read_b64_tr_b16 v[110:111], v10 offset:24064
    s_waitcnt lgkmcnt(6)
    v_mfma_f32_32x32x16_bf16 v[16:31], v[96:99], v[208:211], v[16:31]
    v_mov_b32 v132, v15
    v_mov_b32 v133, v15
    v_mov_b32 v134, v15
    v_mov_b32 v135, v15
    v_mov_b32 v136, v15
    v_mov_b32 v137, v15
    ds_read_b64_tr_b16 v[96:97], v10 offset:24576
    ds_read_b64_tr_b16 v[98:99], v10 offset:25088
    s_waitcnt lgkmcnt(6)
    v_mfma_f32_32x32x16_bf16 v[16:31], v[100:103], v[212:215], v[16:31]
    v_mov_b32 v138, v15
    v_mov_b32 v139, v15
    v_mov_b32 v144, v15
    v_mov_b32 v145, v15
    v_mov_b32 v146, v15
    v_mov_b32 v147, v15
    ds_read_b64_tr_b16 v[100:101], v10 offset:25600
    ds_read_b64_tr_b16 v[102:103], v10 offset:26112
    s_waitcnt lgkmcnt(6)
    v_mfma_f32_32x32x16_bf16 v[16:31], v[104:107], v[216:219], v[16:31]
    v_mov_b32 v148, v15
    v_mov_b32 v149, v15
    v_mov_b32 v150, v15
    v_mov_b32 v151, v15
    v_mov_b32 v156, v15
    v_mov_b32 v157, v15
    ds_read_b64_tr_b16 v[104:105], v10 offset:26624
    ds_read_b64_tr_b16 v[106:107], v10 offset:27136
    s_waitcnt lgkmcnt(6)
    v_mfma_f32_32x32x16_bf16 v[16:31], v[108:111], v[220:223], v[16:31]
    v_mov_b32 v158, v15
    v_mov_b32 v159, v15
    v_mov_b32 v160, v15
    v_mov_b32 v161, v15
    v_mov_b32 v162, v15
    v_mov_b32 v163, v15
    ds_read_b64_tr_b16 v[108:109], v10 offset:27648
    ds_read_b64_tr_b16 v[110:111], v10 offset:28160
    s_waitcnt lgkmcnt(6)
    v_mfma_f32_32x32x16_bf16 v[16:31], v[96:99], v[224:227], v[16:31]
    v_mov_b32 v168, v15
    v_mov_b32 v169, v15
    v_mov_b32 v170, v15
    v_mov_b32 v171, v15
    v_mov_b32 v172, v15
    v_mov_b32 v173, v15
    ds_read_b64_tr_b16 v[96:97], v10 offset:28672
    ds_read_b64_tr_b16 v[98:99], v10 offset:29184
    s_waitcnt lgkmcnt(6)
    v_mfma_f32_32x32x16_bf16 v[16:31], v[100:103], v[228:231], v[16:31]
    v_mov_b32 v174, v15
    v_mov_b32 v175, v15
    v_mov_b32 v176, 0xdddddddd
    ds_read_b64_tr_b16 v[100:101], v10 offset:29696
    ds_read_b64_tr_b16 v[102:103], v10 offset:30208
    s_waitcnt lgkmcnt(6)
    v_mfma_f32_32x32x16_bf16 v[16:31], v[104:107], v[232:235], v[16:31]
    ds_read_b64_tr_b16 v[104:105], v10 offset:30720
    ds_read_b64_tr_b16 v[106:107], v10 offset:31232
    s_waitcnt lgkmcnt(6)
    v_mfma_f32_32x32x16_bf16 v[16:31], v[108:111], v[236:239], v[16:31]
    ds_read_b64_tr_b16 v[108:109], v10 offset:31744
    ds_read_b64_tr_b16 v[110:111], v10 offset:32256
    s_waitcnt lgkmcnt(6)
    v_mfma_f32_32x32x16_bf16 v[16:31], v[96:99], v[240:243], v[16:31]
    s_waitcnt lgkmcnt(4)
    v_mfma_f32_32x32x16_bf16 v[16:31], v[100:103], v[244:247], v[16:31]
    s_waitcnt lgkmcnt(2)
    v_mfma_f32_32x32x16_bf16 v[16:31], v[104:107], v[248:251], v[16:31]
    s_waitcnt lgkmcnt(0)
    v_mfma_f32_32x32x16_bf16 v[16:31], v[108:111], v[252:255], v[16:31]
    s_mov_b32 s53, 0x3eb8aa3b
    s_nop 10
    v_mul_f32 v16, s53, v16
    v_mul_f32 v17, s53, v17
    v_mul_f32 v18, s53, v18
    v_mul_f32 v19, s53, v19
    v_mul_f32 v20, s53, v20
    v_mul_f32 v21, s53, v21
    v_mul_f32 v22, s53, v22
    v_mul_f32 v23, s53, v23
    v_mul_f32 v24, s53, v24
    v_mul_f32 v25, s53, v25
    v_mul_f32 v26, s53, v26
    v_mul_f32 v27, s53, v27
    v_mul_f32 v28, s53, v28
    v_mul_f32 v29, s53, v29
    v_mul_f32 v30, s53, v30
    v_mul_f32 v31, s53, v31
    v_cvt_pk_bf16_f32 v96, v16, v17
    v_cvt_pk_bf16_f32 v97, v18, v19
    v_cvt_pk_bf16_f32 v98, v20, v21
    v_cvt_pk_bf16_f32 v99, v22, v23
    v_cvt_pk_bf16_f32 v100, v24, v25
    v_cvt_pk_bf16_f32 v101, v26, v27
    v_cvt_pk_bf16_f32 v102, v28, v29
    v_cvt_pk_bf16_f32 v103, v30, v31
    ds_write_b128 v7, v[96:99]
    ds_write_b128 v7, v[100:103] offset:4096
    v_mov_b32 v9, 160520
    v_mov_b32 v10, 1
    s_waitcnt lgkmcnt(0)
    s_mov_b64 exec, 1
    ds_add_u32 v9, v10
    s_mov_b64 exec, -1
    s_mov_b64 exec, 0xffffffff
    s_mov_b32 s50, 20000
Lpoll7:
    buffer_load_dword v6, v5, s[40:43], s62 offen sc1
    s_waitcnt vmcnt(0)
    v_cmp_ne_u32 vcc, s47, v6
    s_sub_u32 s50, s50, 1
    s_cbranch_vccz Lpolld7
    s_cmp_lg_u32 s50, 0
    s_cbranch_scc1 Lpoll7
Lpolld7:
    s_mov_b64 exec, -1
    s_mov_b32 s62, s65
    s_add_u32 s63, s56, s62
    s_add_u32 s64, s57, s62
    s_add_u32 s62, s62, 4096
    s_and_b32 s62, s62, 0x3fff
    buffer_load_dwordx4 v[128:131], v2, s[40:43], s63 offen offset:0 sc1
    s_mov_b64 exec, s[60:61]
    buffer_load_dwordx4 v[132:135], v4, s[40:43], s64 offen offset:0 sc1
    buffer_load_dwordx4 v[136:139], v4, s[40:43], s64 offen offset:512 sc1
    s_mov_b64 exec, -1
    buffer_load_dwordx4 v[140:143], v2, s[40:43], s63 offen offset:1024 sc1
    s_mov_b64 exec, s[60:61]
    buffer_load_dwordx4 v[144:147], v4, s[40:43], s64 offen offset:1024 sc1
    buffer_load_dwordx4 v[148:151], v4, s[40:43], s64 offen offset:1536 sc1
    s_mov_b64 exec, -1
    buffer_load_dwordx4 v[152:155], v2, s[40:43], s63 offen offset:2048 sc1
    s_mov_b64 exec, s[60:61]
    buffer_load_dwordx4 v[156:159], v4, s[40:43], s64 offen offset:2048 sc1
    buffer_load_dwordx4 v[160:163], v4, s[40:43], s64 offen offset:2560 sc1
    s_mov_b64 exec, -1
    v_mov_b32 v9, 160520
    s_mov_b32 s50, 400000
Lqj8:
    ds_read_b32 v10, v9
    s_sub_u32 s50, s50, 1
    s_waitcnt lgkmcnt(0)
    v_readfirstlane_b32 s52, v10
    s_nop 0
    s_cmp_eq_u32 s52, 4
    s_cbranch_scc1 Lqjd8
    s_cmp_lg_u32 s50, 0
    s_cbranch_scc1 Lqj8
Lqjd8:
    s_add_u32 s52, s55, 0
    s_and_b32 s52, s52, 3
    s_lshl_b32 s53, s54, 2
    s_add_u32 s52, s52, s53
    s_lshl_b32 s52, s52, 10
    s_add_u32 s52, s52, 147456
    v_add_u32 v9, s52, v2
    ds_read_b128 v[16:19], v9
    s_add_u32 s52, s55, 1
    s_and_b32 s52, s52, 3
    s_lshl_b32 s53, s54, 2
    s_add_u32 s52, s52, s53
    s_lshl_b32 s52, s52, 10
    s_add_u32 s52, s52, 147456
    v_add_u32 v9, s52, v2
    ds_read_b128 v[20:23], v9
    s_add_u32 s52, s55, 2
    s_and_b32 s52, s52, 3
    s_lshl_b32 s53, s54, 2
    s_add_u32 s52, s52, s53
    s_lshl_b32 s52, s52, 10
    s_add_u32 s52, s52, 147456
    v_add_u32 v9, s52, v2
    ds_read_b128 v[24:27], v9
    s_add_u32 s52, s55, 3
    s_and_b32 s52, s52, 3
    s_lshl_b32 s53, s54, 2
    s_add_u32 s52, s52, s53
    s_lshl_b32 s52, s52, 10
    s_add_u32 s52, s52, 147456
    v_add_u32 v9, s52, v2
    ds_read_b128 v[28:31], v9
    s_branch Latt
Lh_b2:
    s_waitcnt vmcnt(0) lgkmcnt(0)
    s_barrier
    s_lshl_b32 s57, s2, 2
    s_add_u32 s57, s57, s67
    s_lshl_b32 s58, s57, 9
    s_mul_i32 s57, s57, 640
    s_add_u32 s57, s57, 1179648
    s_buffer_load_dwordx2 s[0:1], s[16:19], s57 offset:60
    s_buffer_load_dwordx2 s[0:1], s[16:19], s57 offset:188
    s_buffer_load_dwordx2 s[0:1], s[16:19], s57 offset:316
    s_barrier
    v_lshrrev_b32 v4, 2, v1
    v_mul_u32_u24 v4, 3072, v4
    v_and_b32 v5, 3, v1
    v_lshl_add_u32 v4, v5, 4, v4
    s_lshl_b32 s55, s69, 2
    s_add_u32 s55, s55, s67
    s_lshl_b32 s53, s67, 10
    s_add_u32 s53, s53, 65536
    s_lshl_b32 s56, s46, 6
    s_mov_b32 s51, 8
Lh_ql:
    s_and_b32 s52, s55, 31
    s_mul_i32 s52, s52, 49152
    s_mov_b32 m0, s53
    s_add_u32 s52, s52, s56
    buffer_load_dwordx4 v4, s[8:11], s52 offen lds
    s_add_u32 s55, s55, 4
    s_add_u32 s53, s53, 4096
    s_sub_u32 s51, s51, 1
    s_cmp_lg_u32 s51, 0
    s_cbranch_scc1 Lh_ql
    s_buffer_load_dwordx2 s[0:1], s[16:19], s57 offset:444
    s_buffer_load_dwordx2 s[0:1], s[16:19], s57 offset:572
    s_buffer_load_dwordx2 s[0:1], s[12:15], s58 offset:60
    s_waitcnt vmcnt(0)
    s_barrier
    s_buffer_load_dwordx2 s[0:1], s[12:15], s58 offset:188
    s_buffer_load_dwordx2 s[0:1], s[12:15], s58 offset:316
    s_buffer_load_dwordx2 s[0:1], s[12:15], s58 offset:444
    s_and_b32 s54, s44, 1
    s_lshr_b32 s55, s44, 1
    v_and_b32 v4, 15, v1
    v_lshlrev_b32 v4, 4, v4
    v_bfe_u32 v5, v1, 5, 1
    v_lshl_add_u32 v4, v5, 8, v4
    s_lshl_b32 s58, s46, 1
    s_add_u32 s58, s58, s54
    s_lshl_b32 s59, s58, 16
    s_lshl_b32 s52, s55, 14
    s_add_u32 s52, s52, s59
    s_add_u32 s56, s52, 0x400000
    s_add_u32 s57, s52, 0x600000
    s_mov_b32 s60, 0x0000ffff
    s_mov_b32 s61, 0x0000ffff
    s_lshl_b32 s52, s55, 8
    s_lshr_b32 s53, s46, 1
    s_lshl_b32 s53, s53, 11
    s_add_u32 s52, s52, s53
    s_add_u32 s62, s52, 0x52000
    s_and_b32 s65, s45, 3
    s_lshl_b32 s65, s65, 12
    v_lshrrev_b32 v6, 2, v1
    v_and_b32 v11, 3, v1
    v_lshlrev_b32 v12, 10, v6
    v_lshl_add_u32 v12, v11, 4, v12
    v_lshrrev_b32 v6, 2, v1
    v_and_b32 v11, 3, v1
    v_mul_u32_u24 v13, 3584, v6
    v_lshl_add_u32 v13, v11, 4, v13
    v_lshrrev_b32 v6, 1, v1
    v_and_b32 v11, 0x13, v6
    v_bfe_u32 v15, v6, 2, 1
    v_lshl_add_u32 v11, v15, 3, v11
    v_bfe_u32 v15, v6, 3, 1
    v_lshl_add_u32 v11, v15, 2, v11
    v_mul_u32_u24 v14, 3584, v11
    v_and_b32 v11, 1, v1
    v_lshl_add_u32 v14, v11, 4, v14
    v_and_b32 v5, 7, v1
    v_lshlrev_b32 v5, 2, v5
    v_bfe_u32 v6, v1, 3, 1
    v_lshl_add_u32 v5, v6, 7, v5
    v_bfe_u32 v6, v1, 4, 1
    v_lshl_add_u32 v5, v6, 10, v5
    v_and_b32 v6, 0x1b, v1
    v_cmp_eq_u32 vcc, 16, v6
    v_mov_b32 v15, 0x3f803f80
    s_nop 0
    v_cndmask_b32 v15, 0, v15, vcc
    v_mov_b32 v32, 0
    v_mov_b32 v33, 0
    v_mov_b32 v34, 0
    v_mov_b32 v35, 0
    v_mov_b32 v36, 0
    v_mov_b32 v37, 0
    v_mov_b32 v38, 0
    v_mov_b32 v39, 0
    v_mov_b32 v40, 0
    v_mov_b32 v41, 0
    v_mov_b32 v42, 0
    v_mov_b32 v43, 0
    v_mov_b32 v44, 0
    v_mov_b32 v45, 0
    v_mov_b32 v46, 0
    v_mov_b32 v47, 0
    v_mov_b32 v48, 0
    v_mov_b32 v49, 0
    v_mov_b32 v50, 0
    v_mov_b32 v51, 0
    v_mov_b32 v52, 0
    v_mov_b32 v53, 0
    v_mov_b32 v54, 0
    v_mov_b32 v55, 0
    v_mov_b32 v56, 0
    v_mov_b32 v57, 0
    v_mov_b32 v58, 0
    v_mov_b32 v59, 0
    v_mov_b32 v60, 0
    v_mov_b32 v61, 0
    v_mov_b32 v62, 0
    v_mov_b32 v63, 0
    v_mov_b32 v64, 0
    v_mov_b32 v65, 0
    v_mov_b32 v66, 0
    v_mov_b32 v67, 0
    v_mov_b32 v68, 0
    v_mov_b32 v69, 0
    v_mov_b32 v70, 0
    v_mov_b32 v71, 0
    v_mov_b32 v72, 0
    v_mov_b32 v73, 0
    v_mov_b32 v74, 0
    v_mov_b32 v75, 0
    v_mov_b32 v76, 0
    v_mov_b32 v77, 0
    v_mov_b32 v78, 0
    v_mov_b32 v79, 0
    v_mov_b32 v80, 0
    v_mov_b32 v81, 0
    v_mov_b32 v82, 0
    v_mov_b32 v83, 0
    v_mov_b32 v84, 0
    v_mov_b32 v85, 0
    v_mov_b32 v86, 0
    v_mov_b32 v87, 0
    v_mov_b32 v88, 0
    v_mov_b32 v89, 0
    v_mov_b32 v90, 0
    v_mov_b32 v91, 0
    v_mov_b32 v92, 0
    v_mov_b32 v93, 0
    v_mov_b32 v94, 0
    v_mov_b32 v95, 0
    v_mov_b32 v132, v15
    v_mov_b32 v133, v15
    v_mov_b32 v134, v15
    v_mov_b32 v135, v15
    v_mov_b32 v136, v15
    v_mov_b32 v137, v15
    v_mov_b32 v138, v15
    v_mov_b32 v139, v15
    v_mov_b32 v144, v15
    v_mov_b32 v145, v15
    v_mov_b32 v146, v15
    v_mov_b32 v147, v15
    v_mov_b32 v148, v15
    v_mov_b32 v149, v15
    v_mov_b32 v150, v15
    v_mov_b32 v151, v15
    v_mov_b32 v156, v15
    v_mov_b32 v157, v15
    v_mov_b32 v158, v15
    v_mov_b32 v159, v15
    v_mov_b32 v160, v15
    v_mov_b32 v161, v15
    v_mov_b32 v162, v15
    v_mov_b32 v163, v15
    v_mov_b32 v168, v15
    v_mov_b32 v169, v15
    v_mov_b32 v170, v15
    v_mov_b32 v171, v15
    v_mov_b32 v172, v15
    v_mov_b32 v173, v15
    v_mov_b32 v174, v15
    v_mov_b32 v175, v15
    v_mov_b32 v176, 0xdddddddd
    s_mov_b64 exec, 0xffffffff
    s_mov_b32 s50, 20000
    s_sleep 24
Lpoll9:
    buffer_load_dword v6, v5, s[40:43], s62 offen sc1
    s_waitcnt vmcnt(0)
    v_cmp_ne_u32 vcc, s47, v6
    s_sub_u32 s50, s50, 1
    s_cbranch_vccz Lpolld9
    s_cmp_lg_u32 s50, 0
    s_cbranch_scc1 Lpoll9
Lpolld9:
    s_mov_b64 exec, -1
    s_mov_b32 s62, s65
    s_add_u32 s63, s56, s62
    s_add_u32 s64, s57, s62
    s_add_u32 s62, s62, 4096
    s_and_b32 s62, s62, 0x3fff
    buffer_load_dwordx4 v[128:131], v2, s[40:43], s63 offen offset:0 sc1
    s_mov_b64 exec, s[60:61]
    buffer_load_dwordx4 v[132:135], v4, s[40:43], s64 offen offset:0 sc1
    buffer_load_dwordx4 v[136:139], v4, s[40:43], s64 offen offset:512 sc1
    s_mov_b64 exec, -1
    buffer_load_dwordx4 v[140:143], v2, s[40:43], s63 offen offset:1024 sc1
    s_mov_b64 exec, s[60:61]
    buffer_load_dwordx4 v[144:147], v4, s[40:43], s64 offen offset:1024 sc1
    buffer_load_dwordx4 v[148:151], v4, s[40:43], s64 offen offset:1536 sc1
    s_mov_b64 exec, -1
    buffer_load_dwordx4 v[152:155], v2, s[40:43], s63 offen offset:2048 sc1
    s_mov_b64 exec, s[60:61]
    buffer_load_dwordx4 v[156:159], v4, s[40:43], s64 offen offset:2048 sc1
    buffer_load_dwordx4 v[160:163], v4, s[40:43], s64 offen offset:2560 sc1
    s_mov_b64 exec, -1
    v_mov_b32 v9, 160520
    s_mov_b32 s50, 400000
Lqj10:
    ds_read_b32 v10, v9
    s_sub_u32 s50, s50, 1
    s_waitcnt lgkmcnt(0)
    v_readfirstlane_b32 s52, v10
    s_nop 0
    s_cmp_eq_u32 s52, 4
    s_cbranch_scc1 Lqjd10
    s_cmp_lg_u32 s50, 0
    s_cbranch_scc1 Lqj10
Lqjd10:
    s_add_u32 s52, s55, 0
    s_and_b32 s52, s52, 3
    s_lshl_b32 s53, s54, 2
    s_add_u32 s52, s52, s53
    s_lshl_b32 s52, s52, 10
    s_add_u32 s52, s52, 147456
    v_add_u32 v9, s52, v2
    ds_read_b128 v[16:19], v9
    s_add_u32 s52, s55, 1
    s_and_b32 s52, s52, 3
    s_lshl_b32 s53, s54, 2
    s_add_u32 s52, s52, s53
    s_lshl_b32 s52, s52, 10
    s_add_u32 s52, s52, 147456
    v_add_u32 v9, s52, v2
    ds_read_b128 v[20:23], v9
    s_add_u32 s52, s55, 2
    s_and_b32 s52, s52, 3
    s_lshl_b32 s53, s54, 2
    s_add_u32 s52, s52, s53
    s_lshl_b32 s52, s52, 10
    s_add_u32 s52, s52, 147456
    v_add_u32 v9, s52, v2
    ds_read_b128 v[24:27], v9
    s_add_u32 s52, s55, 3
    s_and_b32 s52, s52, 3
    s_lshl_b32 s53, s54, 2
    s_add_u32 s52, s52, s53
    s_lshl_b32 s52, s52, 10
    s_add_u32 s52, s52, 147456
    v_add_u32 v9, s52, v2
    ds_read_b128 v[28:31], v9
Latt:
    s_setprio 1
    s_and_b32 s53, s44, 3
    s_lshl_b32 s52, s2, 2
    s_add_u32 s53, s53, s52
    s_mul_i32 s53, s53, 1152
    s_waitcnt lgkmcnt(0)
    s_waitcnt vmcnt(6)
    v_mfma_f32_32x32x16_bf16 v[96:111], v[128:131], v[16:19], 0
    s_nop 7
    s_nop 3
    v_exp_f32 v96, v96
    v_exp_f32 v97, v97
    buffer_load_dwordx4 v[164:167], v2, s[40:43], s63 offen offset:3072 sc1
    s_mov_b64 exec, s[60:61]
    buffer_load_dwordx4 v[168:171], v4, s[40:43], s64 offen offset:3072 sc1
    buffer_load_dwordx4 v[172:175], v4, s[40:43], s64 offen offset:3584 sc1
    s_mov_b64 exec, -1
    s_buffer_load_dwordx2 s[0:1], s[16:19], s53 offset:60
    v_exp_f32 v98, v98
    v_exp_f32 v99, v99
    v_exp_f32 v100, v100
    v_mfma_f32_32x32x16_bf16 v[112:127], v[128:131], v[20:23], 0
    v_exp_f32 v101, v101
    v_exp_f32 v102, v102
    v_exp_f32 v103, v103
    v_exp_f32 v104, v104
    v_exp_f32 v105, v105
    v_exp_f32 v106, v106
    v_smfmac_f32_32x32x32_bf16 v[32:47], v[132:135], v[96:103], v176
    v_exp_f32 v107, v107
    v_exp_f32 v108, v108
    v_exp_f32 v109, v109
    v_exp_f32 v110, v110
    v_exp_f32 v111, v111
    v_exp_f32 v112, v112
    v_exp_f32 v113, v113
    v_smfmac_f32_32x32x32_bf16 v[32:47], v[136:139], v[104:111], v176
    s_buffer_load_dwordx2 s[0:1], s[16:19], s53 offset:188
    v_exp_f32 v114, v114
    v_exp_f32 v115, v115
    v_exp_f32 v116, v116
    v_mfma_f32_32x32x16_bf16 v[96:111], v[128:131], v[24:27], 0
    v_exp_f32 v117, v117
    v_exp_f32 v118, v118
    v_exp_f32 v119, v119
    v_exp_f32 v120, v120
    v_exp_f32 v121, v121
    v_exp_f32 v122, v122
    v_smfmac_f32_32x32x32_bf16 v[48:63], v[132:135], v[112:119], v176
    v_exp_f32 v123, v123
    v_exp_f32 v124, v124
    v_exp_f32 v125, v125
    v_exp_f32 v126, v126
    v_exp_f32 v127, v127
    v_exp_f32 v96, v96
    v_exp_f32 v97, v97
    v_smfmac_f32_32x32x32_bf16 v[48:63], v[136:139], v[120:127], v176
    v_exp_f32 v98, v98
    v_exp_f32 v99, v99
    v_exp_f32 v100, v100
    v_mfma_f32_32x32x16_bf16 v[112:127], v[128:131], v[28:31], 0
    v_exp_f32 v101, v101
    v_exp_f32 v102, v102
    v_exp_f32 v103, v103
    v_exp_f32 v104, v104
    v_exp_f32 v105, v105
    v_exp_f32 v106, v106
    v_smfmac_f32_32x32x32_bf16 v[64:79], v[132:135], v[96:103], v176
    v_exp_f32 v107, v107
    v_exp_f32 v108, v108
    v_exp_f32 v109, v109
    v_exp_f32 v110, v110
    v_exp_f32 v111, v111
    v_exp_f32 v112, v112
    v_exp_f32 v113, v113
    v_smfmac_f32_32x32x32_bf16 v[64:79], v[136:139], v[104:111], v176
    s_buffer_load_dwordx2 s[0:1], s[16:19], s53 offset:316
    v_exp_f32 v114, v114
    v_exp_f32 v115, v115
    v_exp_f32 v116, v116
    s_waitcnt vmcnt(6)
    v_mfma_f32_32x32x16_bf16 v[96:111], v[140:143], v[16:19], 0
    v_exp_f32 v117, v117
    v_exp_f32 v118, v118
    v_exp_f32 v119, v119
    v_exp_f32 v120, v120
    v_exp_f32 v121, v121
    v_exp_f32 v122, v122
    v_smfmac_f32_32x32x32_bf16 v[80:95], v[132:135], v[112:119], v176
    v_exp_f32 v123, v123
    v_exp_f32 v124, v124
    v_exp_f32 v125, v125
    v_exp_f32 v126, v126
    v_exp_f32 v127, v127
    v_exp_f32 v96, v96
    v_exp_f32 v97, v97
    v_smfmac_f32_32x32x32_bf16 v[80:95], v[136:139], v[120:127], v176
    s_add_u32 s63, s56, s62
    s_add_u32 s64, s57, s62
    s_add_u32 s62, s62, 4096
    s_and_b32 s62, s62, 0x3fff
    buffer_load_dwordx4 v[128:131], v2, s[40:43], s63 offen offset:0 sc1
    s_mov_b64 exec, s[60:61]
    buffer_load_dwordx4 v[132:135], v4, s[40:43], s64 offen offset:0 sc1
    buffer_load_dwordx4 v[136:139], v4, s[40:43], s64 offen offset:512 sc1
    s_mov_b64 exec, -1
    s_buffer_load_dwordx2 s[0:1], s[16:19], s53 offset:444
    v_exp_f32 v98, v98
    v_exp_f32 v99, v99
    v_exp_f32 v100, v100
    v_mfma_f32_32x32x16_bf16 v[112:127], v[140:143], v[20:23], 0
    v_exp_f32 v101, v101
    v_exp_f32 v102, v102
    v_exp_f32 v103, v103
    v_exp_f32 v104, v104
    v_exp_f32 v105, v105
    v_exp_f32 v106, v106
    v_smfmac_f32_32x32x32_bf16 v[32:47], v[144:147], v[96:103], v176
    v_exp_f32 v107, v107
    v_exp_f32 v108, v108
    v_exp_f32 v109, v109
    v_exp_f32 v110, v110
    v_exp_f32 v111, v111
    v_exp_f32 v112, v112
    v_exp_f32 v113, v113
    v_smfmac_f32_32x32x32_bf16 v[32:47], v[148:151], v[104:111], v176
    s_cmp_lg_u32 s44, 0
    s_cbranch_scc1 Latt_noxc
    s_lshl_b32 s52, s49, 1
    s_lshr_b32 s50, s48, 4
    s_add_u32 s52, s52, s50
    s_lshl_b32 s52, s52, 5
    s_and_b32 s50, s48, 15
    s_add_u32 s52, s52, s50
    s_lshl_b32 s52, s52, 2
    s_add_u32 s52, s52, 0x58000
    s_getreg_b32 s50, hwreg(HW_REG_XCC_ID)
    s_and_b32 s50, s50, 15
    s_lshl_b32 s50, s50, 1
    s_add_u32 s50, s50, s47
    v_mov_b32 v5, s50
    s_mov_b64 exec, 1
    buffer_store_dword v5, v3, s[40:43], s52 offen sc1
    s_mov_b64 exec, -1
Latt_noxc:
    v_exp_f32 v114, v114
    v_exp_f32 v115, v115
    v_exp_f32 v116, v116
    v_mfma_f32_32x32x16_bf16 v[96:111], v[140:143], v[24:27], 0
    v_exp_f32 v117, v117
    v_exp_f32 v118, v118
    v_exp_f32 v119, v119
    v_exp_f32 v120, v120
    v_exp_f32 v121, v121
    v_exp_f32 v122, v122
    v_smfmac_f32_32x32x32_bf16 v[48:63], v[144:147], v[112:119], v176
    v_exp_f32 v123, v123
    v_exp_f32 v124, v124
    v_exp_f32 v125, v125
    v_exp_f32 v126, v126
    v_exp_f32 v127, v127
    v_exp_f32 v96, v96
    v_exp_f32 v97, v97
    v_smfmac_f32_32x32x32_bf16 v[48:63], v[148:151], v[120:127], v176
    s_buffer_load_dwordx2 s[0:1], s[16:19], s53 offset:572
    v_exp_f32 v98, v98
    v_exp_f32 v99, v99
    v_exp_f32 v100, v100
    v_mfma_f32_32x32x16_bf16 v[112:127], v[140:143], v[28:31], 0
    v_exp_f32 v101, v101
    v_exp_f32 v102, v102
    v_exp_f32 v103, v103
    v_exp_f32 v104, v104
    v_exp_f32 v105, v105
    v_exp_f32 v106, v106
    v_smfmac_f32_32x32x32_bf16 v[64:79], v[144:147], v[96:103], v176
    v_exp_f32 v107, v107
    v_exp_f32 v108, v108
    v_exp_f32 v109, v109
    v_exp_f32 v110, v110
    v_exp_f32 v111, v111
    v_exp_f32 v112, v112
    v_exp_f32 v113, v113
    v_smfmac_f32_32x32x32_bf16 v[64:79], v[148:151], v[104:111], v176
    s_buffer_load_dwordx2 s[0:1], s[16:19], s53 offset:700
    v_exp_f32 v114, v114
    v_exp_f32 v115, v115
    v_exp_f32 v116, v116
    s_waitcnt vmcnt(6)
    v_mfma_f32_32x32x16_bf16 v[96:111], v[152:155], v[16:19], 0
    v_exp_f32 v117, v117
    v_exp_f32 v118, v118
    v_exp_f32 v119, v119
    v_exp_f32 v120, v120
    v_exp_f32 v121, v121
    v_exp_f32 v122, v122
    v_smfmac_f32_32x32x32_bf16 v[80:95], v[144:147], v[112:119], v176
    v_exp_f32 v123, v123
    v_exp_f32 v124, v124
    v_exp_f32 v125, v125
    v_exp_f32 v126, v126
    v_exp_f32 v127, v127
    v_exp_f32 v96, v96
    v_exp_f32 v97, v97
    v_smfmac_f32_32x32x32_bf16 v[80:95], v[148:151], v[120:127], v176
    buffer_load_dwordx4 v[140:143], v2, s[40:43], s63 offen offset:1024 sc1
    s_mov_b64 exec, s[60:61]
    buffer_load_dwordx4 v[144:147], v4, s[40:43], s64 offen offset:1024 sc1
    buffer_load_dwordx4 v[148:151], v4, s[40:43], s64 offen offset:1536 sc1
    s_mov_b64 exec, -1
    v_exp_f32 v98, v98
    v_exp_f32 v99, v99
    v_exp_f32 v100, v100
    v_mfma_f32_32x32x16_bf16 v[112:127], v[152:155], v[20:23], 0
    v_exp_f32 v101, v101
    v_exp_f32 v102, v102
    v_exp_f32 v103, v103
    v_exp_f32 v104, v104
    v_exp_f32 v105, v105
    v_exp_f32 v106, v106
    v_smfmac_f32_32x32x32_bf16 v[32:47], v[156:159], v[96:103], v176
    v_exp_f32 v107, v107
    v_exp_f32 v108, v108
    v_exp_f32 v109, v109
    v_exp_f32 v110, v110
    v_exp_f32 v111, v111
    v_exp_f32 v112, v112
    v_exp_f32 v113, v113
    v_smfmac_f32_32x32x32_bf16 v[32:47], v[160:163], v[104:111], v176
    s_buffer_load_dwordx2 s[0:1], s[16:19], s53 offset:828
    v_exp_f32 v114, v114
    v_exp_f32 v115, v115
    v_exp_f32 v116, v116
    v_mfma_f32_32x32x16_bf16 v[96:111], v[152:155], v[24:27], 0
    v_exp_f32 v117, v117
    v_exp_f32 v118, v118
    v_exp_f32 v119, v119
    v_exp_f32 v120, v120
    v_exp_f32 v121, v121
    v_exp_f32 v122, v122
    v_smfmac_f32_32x32x32_bf16 v[48:63], v[156:159], v[112:119], v176
    v_exp_f32 v123, v123
    v_exp_f32 v124, v124
    v_exp_f32 v125, v125
    v_exp_f32 v126, v126
    v_exp_f32 v127, v127
    v_exp_f32 v96, v96
    v_exp_f32 v97, v97
    v_smfmac_f32_32x32x32_bf16 v[48:63], v[160:163], v[120:127], v176
    s_buffer_load_dwordx2 s[0:1], s[16:19], s53 offset:956
    v_exp_f32 v98, v98
    v_exp_f32 v99, v99
    v_exp_f32 v100, v100
    v_mfma_f32_32x32x16_bf16 v[112:127], v[152:155], v[28:31], 0
    v_exp_f32 v101, v101
    v_exp_f32 v102, v102
    v_exp_f32 v103, v103
    v_exp_f32 v104, v104
    v_exp_f32 v105, v105
    v_exp_f32 v106, v106
    v_smfmac_f32_32x32x32_bf16 v[64:79], v[156:159], v[96:103], v176
    v_exp_f32 v107, v107
    v_exp_f32 v108, v108
    v_exp_f32 v109, v109
    v_exp_f32 v110, v110
    v_exp_f32 v111, v111
    v_exp_f32 v112, v112
    v_exp_f32 v113, v113
    v_smfmac_f32_32x32x32_bf16 v[64:79], v[160:163], v[104:111], v176
    v_exp_f32 v114, v114
    v_exp_f32 v115, v115
    v_exp_f32 v116, v116
    s_waitcnt vmcnt(6)
    v_mfma_f32_32x32x16_bf16 v[96:111], v[164:167], v[16:19], 0
    v_exp_f32 v117, v117
    v_exp_f32 v118, v118
    v_exp_f32 v119, v119
    v_exp_f32 v120, v120
    v_exp_f32 v121, v121
    v_exp_f32 v122, v122
    v_smfmac_f32_32x32x32_bf16 v[80:95], v[156:159], v[112:119], v176
    v_exp_f32 v123, v123
    v_exp_f32 v124, v124
    v_exp_f32 v125, v125
    v_exp_f32 v126, v126
    v_exp_f32 v127, v127
    v_exp_f32 v96, v96
    v_exp_f32 v97, v97
    v_smfmac_f32_32x32x32_bf16 v[80:95], v[160:163], v[120:127], v176
    buffer_load_dwordx4 v[152:155], v2, s[40:43], s63 offen offset:2048 sc1
    s_mov_b64 exec, s[60:61]
    buffer_load_dwordx4 v[156:159], v4, s[40:43], s64 offen offset:2048 sc1
    buffer_load_dwordx4 v[160:163], v4, s[40:43], s64 offen offset:2560 sc1
    s_mov_b64 exec, -1
    s_buffer_load_dwordx2 s[0:1], s[16:19], s53 offset:1084
    v_exp_f32 v98, v98
    v_exp_f32 v99, v99
    v_exp_f32 v100, v100
    v_mfma_f32_32x32x16_bf16 v[112:127], v[164:167], v[20:23], 0
    v_exp_f32 v101, v101
    v_exp_f32 v102, v102
    v_exp_f32 v103, v103
    v_exp_f32 v104, v104
    v_exp_f32 v105, v105
    v_exp_f32 v106, v106
    v_smfmac_f32_32x32x32_bf16 v[32:47], v[168:171], v[96:103], v176
    v_exp_f32 v107, v107
    v_exp_f32 v108, v108
    v_exp_f32 v109, v109
    v_exp_f32 v110, v110
    v_exp_f32 v111, v111
    v_exp_f32 v112, v112
    v_exp_f32 v113, v113
    v_smfmac_f32_32x32x32_bf16 v[32:47], v[172:175], v[104:111], v176
    s_lshl_b32 s53, s2, 1
    s_bfe_u32 s52, s44, 0x10001
    s_add_u32 s53, s53, s52
    s_mul_i32 s53, s53, 6144
    s_lshl_b32 s52, s54, 11
    s_add_u32 s53, s53, s52
    s_add_u32 s53, s53, 2048
    s_buffer_load_dwordx2 s[0:1], s[28:31], s53 offset:60
    v_exp_f32 v114, v114
    v_exp_f32 v115, v115
    v_exp_f32 v116, v116
    v_mfma_f32_32x32x16_bf16 v[96:111], v[164:167], v[24:27], 0
    v_exp_f32 v117, v117
    v_exp_f32 v118, v118
    v_exp_f32 v119, v119
    v_exp_f32 v120, v120
    v_exp_f32 v121, v121
    v_exp_f32 v122, v122
    v_smfmac_f32_32x32x32_bf16 v[48:63], v[168:171], v[112:119], v176
    v_exp_f32 v123, v123
    v_exp_f32 v124, v124
    v_exp_f32 v125, v125
    v_exp_f32 v126, v126
    v_exp_f32 v127, v127
    v_exp_f32 v96, v96
    v_exp_f32 v97, v97
    v_smfmac_f32_32x32x32_bf16 v[48:63], v[172:175], v[120:127], v176
    v_exp_f32 v98, v98
    v_exp_f32 v99, v99
    v_exp_f32 v100, v100
    v_mfma_f32_32x32x16_bf16 v[112:127], v[164:167], v[28:31], 0
    v_exp_f32 v101, v101
    v_exp_f32 v102, v102
    v_exp_f32 v103, v103
    v_exp_f32 v104, v104
    v_exp_f32 v105, v105
    v_exp_f32 v106, v106
    v_smfmac_f32_32x32x32_bf16 v[64:79], v[168:171], v[96:103], v176
    v_exp_f32 v107, v107
    v_exp_f32 v108, v108
    v_exp_f32 v109, v109
    v_exp_f32 v110, v110
    v_exp_f32 v111, v111
    v_exp_f32 v112, v112
    v_exp_f32 v113, v113
    v_smfmac_f32_32x32x32_bf16 v[64:79], v[172:175], v[104:111], v176
    s_buffer_load_dwordx2 s[0:1], s[28:31], s53 offset:188
    v_exp_f32 v114, v114
    v_exp_f32 v115, v115
    v_exp_f32 v116, v116
    s_waitcnt vmcnt(6)
    v_mfma_f32_32x32x16_bf16 v[96:111], v[128:131], v[16:19], 0
    v_exp_f32 v117, v117
    v_exp_f32 v118, v118
    v_exp_f32 v119, v119
    v_exp_f32 v120, v120
    v_exp_f32 v121, v121
    v_exp_f32 v122, v122
    v_smfmac_f32_32x32x32_bf16 v[80:95], v[168:171], v[112:119], v176
    v_exp_f32 v123, v123
    v_exp_f32 v124, v124
    v_exp_f32 v125, v125
    v_exp_f32 v126, v126
    v_exp_f32 v127, v127
    v_exp_f32 v96, v96
    v_exp_f32 v97, v97
    v_smfmac_f32_32x32x32_bf16 v[80:95], v[172:175], v[120:127], v176
    buffer_load_dwordx4 v[164:167], v2, s[40:43], s63 offen offset:3072 sc1
    s_mov_b64 exec, s[60:61]
    buffer_load_dwordx4 v[168:171], v4, s[40:43], s64 offen offset:3072 sc1
    buffer_load_dwordx4 v[172:175], v4, s[40:43], s64 offen offset:3584 sc1
    s_mov_b64 exec, -1
    s_buffer_load_dwordx2 s[0:1], s[28:31], s53 offset:316
    v_exp_f32 v98, v98
    v_exp_f32 v99, v99
    v_exp_f32 v100, v100
    v_mfma_f32_32x32x16_bf16 v[112:127], v[128:131], v[20:23], 0
    v_exp_f32 v101, v101
    v_exp_f32 v102, v102
    v_exp_f32 v103, v103
    v_exp_f32 v104, v104
    v_exp_f32 v105, v105
    v_exp_f32 v106, v106
    v_smfmac_f32_32x32x32_bf16 v[32:47], v[132:135], v[96:103], v176
    v_exp_f32 v107, v107
    v_exp_f32 v108, v108
    v_exp_f32 v109, v109
    v_exp_f32 v110, v110
    v_exp_f32 v111, v111
    v_exp_f32 v112, v112
    v_exp_f32 v113, v113
    v_smfmac_f32_32x32x32_bf16 v[32:47], v[136:139], v[104:111], v176
    v_exp_f32 v114, v114
    v_exp_f32 v115, v115
    v_exp_f32 v116, v116
    v_mfma_f32_32x32x16_bf16 v[96:111], v[128:131], v[24:27], 0
    v_exp_f32 v117, v117
    v_exp_f32 v118, v118
    v_exp_f32 v119, v119
    v_exp_f32 v120, v120
    v_exp_f32 v121, v121
    v_exp_f32 v122, v122
    v_smfmac_f32_32x32x32_bf16 v[48:63], v[132:135], v[112:119], v176
    v_exp_f32 v123, v123
    v_exp_f32 v124, v124
    v_exp_f32 v125, v125
    v_exp_f32 v126, v126
    v_exp_f32 v127, v127
    v_exp_f32 v96, v96
    v_exp_f32 v97, v97
    v_smfmac_f32_32x32x32_bf16 v[48:63], v[136:139], v[120:127], v176
    s_buffer_load_dwordx2 s[0:1], s[28:31], s53 offset:444
    v_exp_f32 v98, v98
    v_exp_f32 v99, v99
    v_exp_f32 v100, v100
    v_mfma_f32_32x32x16_bf16 v[112:127], v[128:131], v[28:31], 0
    v_exp_f32 v101, v101
    v_exp_f32 v102, v102
    v_exp_f32 v103, v103
    v_exp_f32 v104, v104
    v_exp_f32 v105, v105
    v_exp_f32 v106, v106
    v_smfmac_f32_32x32x32_bf16 v[64:79], v[132:135], v[96:103], v176
    v_exp_f32 v107, v107
    v_exp_f32 v108, v108
    v_exp_f32 v109, v109
    v_exp_f32 v110, v110
    v_exp_f32 v111, v111
    v_exp_f32 v112, v112
    v_exp_f32 v113, v113
    v_smfmac_f32_32x32x32_bf16 v[64:79], v[136:139], v[104:111], v176
    s_buffer_load_dwordx2 s[0:1], s[28:31], s53 offset:572
    v_exp_f32 v114, v114
    v_exp_f32 v115, v115
    v_exp_f32 v116, v116
    s_waitcnt vmcnt(6)
    v_mfma_f32_32x32x16_bf16 v[96:111], v[140:143], v[16:19], 0
    v_exp_f32 v117, v117
    v_exp_f32 v118, v118
    v_exp_f32 v119, v119
    v_exp_f32 v120, v120
    v_exp_f32 v121, v121
    v_exp_f32 v122, v122
    v_smfmac_f32_32x32x32_bf16 v[80:95], v[132:135], v[112:119], v176
    v_exp_f32 v123, v123
    v_exp_f32 v124, v124
    v_exp_f32 v125, v125
    v_exp_f32 v126, v126
    v_exp_f32 v127, v127
    v_exp_f32 v96, v96
    v_exp_f32 v97, v97
    v_smfmac_f32_32x32x32_bf16 v[80:95], v[136:139], v[120:127], v176
    s_add_u32 s63, s56, s62
    s_add_u32 s64, s57, s62
    s_add_u32 s62, s62, 4096
    s_and_b32 s62, s62, 0x3fff
    buffer_load_dwordx4 v[128:131], v2, s[40:43], s63 offen offset:0 sc1
    s_mov_b64 exec, s[60:61]
    buffer_load_dwordx4 v[132:135], v4, s[40:43], s64 offen offset:0 sc1
    buffer_load_dwordx4 v[136:139], v4, s[40:43], s64 offen offset:512 sc1
    s_mov_b64 exec, -1
    v_exp_f32 v98, v98
    v_exp_f32 v99, v99
    v_exp_f32 v100, v100
    v_mfma_f32_32x32x16_bf16 v[112:127], v[140:143], v[20:23], 0
    v_exp_f32 v101, v101
    v_exp_f32 v102, v102
    v_exp_f32 v103, v103
    v_exp_f32 v104, v104
    v_exp_f32 v105, v105
    v_exp_f32 v106, v106
    v_smfmac_f32_32x32x32_bf16 v[32:47], v[144:147], v[96:103], v176
    v_exp_f32 v107, v107
    v_exp_f32 v108, v108
    v_exp_f32 v109, v109
    v_exp_f32 v110, v110
    v_exp_f32 v111, v111
    v_exp_f32 v112, v112
    v_exp_f32 v113, v113
    v_smfmac_f32_32x32x32_bf16 v[32:47], v[148:151], v[104:111], v176
    s_add_u32 s65, s44, s69
    s_and_b32 s65, s65, 7
    s_lshl_b32 s65, s65, 16
    s_and_b32 s52, s48, 15
    s_lshl_b32 s52, s52, 6
    s_add_u32 s65, s65, s52
    s_lshl_b32 s66, s44, 12
    s_add_u32 m0, s66, 0
    s_add_u32 s52, s65, 0
    buffer_load_dwordx4 v12, s[12:15], s52 offen lds
    s_add_u32 m0, s66, 1024
    s_add_u32 s52, s65, 16384
    buffer_load_dwordx4 v12, s[12:15], s52 offen lds
    s_buffer_load_dwordx2 s[0:1], s[28:31], s53 offset:700
    v_exp_f32 v114, v114
    v_exp_f32 v115, v115
    v_exp_f32 v116, v116
    v_mfma_f32_32x32x16_bf16 v[96:111], v[140:143], v[24:27], 0
    v_exp_f32 v117, v117
    v_exp_f32 v118, v118
    v_exp_f32 v119, v119
    v_exp_f32 v120, v120
    v_exp_f32 v121, v121
    v_exp_f32 v122, v122
    v_smfmac_f32_32x32x32_bf16 v[48:63], v[144:147], v[112:119], v176
    v_exp_f32 v123, v123
    v_exp_f32 v124, v124
    v_exp_f32 v125, v125
    v_exp_f32 v126, v126
    v_exp_f32 v127, v127
    v_exp_f32 v96, v96
    v_exp_f32 v97, v97
    v_smfmac_f32_32x32x32_bf16 v[48:63], v[148:151], v[120:127], v176
    s_buffer_load_dwordx2 s[0:1], s[28:31], s53 offset:828
    v_exp_f32 v98, v98
    v_exp_f32 v99, v99
    v_exp_f32 v100, v100
    v_mfma_f32_32x32x16_bf16 v[112:127], v[140:143], v[28:31], 0
    v_exp_f32 v101, v101
    v_exp_f32 v102, v102
    v_exp_f32 v103, v103
    v_exp_f32 v104, v104
    v_exp_f32 v105, v105
    v_exp_f32 v106, v106
    v_smfmac_f32_32x32x32_bf16 v[64:79], v[144:147], v[96:103], v176
    v_exp_f32 v107, v107
    v_exp_f32 v108, v108
    v_exp_f32 v109, v109
    v_exp_f32 v110, v110
    v_exp_f32 v111, v111
    v_exp_f32 v112, v112
    v_exp_f32 v113, v113
    v_smfmac_f32_32x32x32_bf16 v[64:79], v[148:151], v[104:111], v176
    v_exp_f32 v114, v114
    v_exp_f32 v115, v115
    v_exp_f32 v116, v116
    s_waitcnt vmcnt(8)
    v_mfma_f32_32x32x16_bf16 v[96:111], v[152:155], v[16:19], 0
    v_exp_f32 v117, v117
    v_exp_f32 v118, v118
    v_exp_f32 v119, v119
    v_exp_f32 v120, v120
    v_exp_f32 v121, v121
    v_exp_f32 v122, v122
    v_smfmac_f32_32x32x32_bf16 v[80:95], v[144:147], v[112:119], v176
    v_exp_f32 v123, v123
    v_exp_f32 v124, v124
    v_exp_f32 v125, v125
    v_exp_f32 v126, v126
    v_exp_f32 v127, v127
    v_exp_f32 v96, v96
    v_exp_f32 v97, v97
    v_smfmac_f32_32x32x32_bf16 v[80:95], v[148:151], v[120:127], v176
    buffer_load_dwordx4 v[140:143], v2, s[40:43], s63 offen offset:1024 sc1
    s_mov_b64 exec, s[60:61]
    buffer_load_dwordx4 v[144:147], v4, s[40:43], s64 offen offset:1024 sc1
    buffer_load_dwordx4 v[148:151], v4, s[40:43], s64 offen offset:1536 sc1
    s_mov_b64 exec, -1
    s_buffer_load_dwordx2 s[0:1], s[28:31], s53 offset:956
    v_exp_f32 v98, v98
    v_exp_f32 v99, v99
    v_exp_f32 v100, v100
    v_mfma_f32_32x32x16_bf16 v[112:127], v[152:155], v[20:23], 0
    v_exp_f32 v101, v101
    v_exp_f32 v102, v102
    v_exp_f32 v103, v103
    v_exp_f32 v104, v104
    v_exp_f32 v105, v105
    v_exp_f32 v106, v106
    v_smfmac_f32_32x32x32_bf16 v[32:47], v[156:159], v[96:103], v176
    v_exp_f32 v107, v107
    v_exp_f32 v108, v108
    v_exp_f32 v109, v109
    v_exp_f32 v110, v110
    v_exp_f32 v111, v111
    v_exp_f32 v112, v112
    v_exp_f32 v113, v113
    v_smfmac_f32_32x32x32_bf16 v[32:47], v[160:163], v[104:111], v176
    s_add_u32 m0, s66, 2048
    s_add_u32 s52, s65, 32768
    buffer_load_dwordx4 v12, s[12:15], s52 offen lds
    s_add_u32 m0, s66, 3072
    s_add_u32 s52, s65, 49152
    buffer_load_dwordx4 v12, s[12:15], s52 offen lds
    s_buffer_load_dwordx2 s[0:1], s[28:31], s53 offset:1084
    v_exp_f32 v114, v114
    v_exp_f32 v115, v115
    v_exp_f32 v116, v116
    v_mfma_f32_32x32x16_bf16 v[96:111], v[152:155], v[24:27], 0
    v_exp_f32 v117, v117
    v_exp_f32 v118, v118
    v_exp_f32 v119, v119
    v_exp_f32 v120, v120
    v_exp_f32 v121, v121
    v_exp_f32 v122, v122
    v_smfmac_f32_32x32x32_bf16 v[48:63], v[156:159], v[112:119], v176
    v_exp_f32 v123, v123
    v_exp_f32 v124, v124
    v_exp_f32 v125, v125
    v_exp_f32 v126, v126
    v_exp_f32 v127, v127
    v_exp_f32 v96, v96
    v_exp_f32 v97, v97
    v_smfmac_f32_32x32x32_bf16 v[48:63], v[160:163], v[120:127], v176
    v_exp_f32 v98, v98
    v_exp_f32 v99, v99
    v_exp_f32 v100, v100
    v_mfma_f32_32x32x16_bf16 v[112:127], v[152:155], v[28:31], 0
    v_exp_f32 v101, v101
    v_exp_f32 v102, v102
    v_exp_f32 v103, v103
    v_exp_f32 v104, v104
    v_exp_f32 v105, v105
    v_exp_f32 v106, v106
    v_smfmac_f32_32x32x32_bf16 v[64:79], v[156:159], v[96:103], v176
    v_exp_f32 v107, v107
    v_exp_f32 v108, v108
    v_exp_f32 v109, v109
    v_exp_f32 v110, v110
    v_exp_f32 v111, v111
    v_exp_f32 v112, v112
    v_exp_f32 v113, v113
    v_smfmac_f32_32x32x32_bf16 v[64:79], v[160:163], v[104:111], v176
    s_buffer_load_dwordx2 s[0:1], s[28:31], s53 offset:1212
    v_exp_f32 v114, v114
    v_exp_f32 v115, v115
    v_exp_f32 v116, v116
    s_waitcnt vmcnt(10)
    v_mfma_f32_32x32x16_bf16 v[96:111], v[164:167], v[16:19], 0
    v_exp_f32 v117, v117
    v_exp_f32 v118, v118
    v_exp_f32 v119, v119
    v_exp_f32 v120, v120
    v_exp_f32 v121, v121
    v_exp_f32 v122, v122
    v_smfmac_f32_32x32x32_bf16 v[80:95], v[156:159], v[112:119], v176
    v_exp_f32 v123, v123
    v_exp_f32 v124, v124
    v_exp_f32 v125, v125
    v_exp_f32 v126, v126
    v_exp_f32 v127, v127
    v_exp_f32 v96, v96
    v_exp_f32 v97, v97
    v_smfmac_f32_32x32x32_bf16 v[80:95], v[160:163], v[120:127], v176
    buffer_load_dwordx4 v[152:155], v2, s[40:43], s63 offen offset:2048 sc1
    s_mov_b64 exec, s[60:61]
    buffer_load_dwordx4 v[156:159], v4, s[40:43], s64 offen offset:2048 sc1
    buffer_load_dwordx4 v[160:163], v4, s[40:43], s64 offen offset:2560 sc1
    s_mov_b64 exec, -1
    s_buffer_load_dwordx2 s[0:1], s[28:31], s53 offset:1340
    v_exp_f32 v98, v98
    v_exp_f32 v99, v99
    v_exp_f32 v100, v100
    v_mfma_f32_32x32x16_bf16 v[112:127], v[164:167], v[20:23], 0
    v_exp_f32 v101, v101
    v_exp_f32 v102, v102
    v_exp_f32 v103, v103
    v_exp_f32 v104, v104
    v_exp_f32 v105, v105
    v_exp_f32 v106, v106
    v_smfmac_f32_32x32x32_bf16 v[32:47], v[168:171], v[96:103], v176
    v_exp_f32 v107, v107
    v_exp_f32 v108, v108
    v_exp_f32 v109, v109
    v_exp_f32 v110, v110
    v_exp_f32 v111, v111
    v_exp_f32 v112, v112
    v_exp_f32 v113, v113
    v_smfmac_f32_32x32x32_bf16 v[32:47], v[172:175], v[104:111], v176
    s_lshl_b32 s65, s69, 1
    s_add_u32 s65, s65, s44
    s_add_u32 s65, s65, 0
    s_and_b32 s65, s65, 15
    s_mul_i32 s65, s65, 114688
    s_and_b32 s52, s48, 15
    s_mul_i32 s52, s52, 224
    s_add_u32 s65, s65, s52
    s_mul_i32 s66, s44, 7168
    s_add_u32 s66, s66, 32768
    s_add_u32 m0, s66, 0
    s_add_u32 s52, s65, 0
    buffer_load_dwordx4 v13, s[16:19], s52 offen lds
    s_add_u32 m0, s66, 1024
    s_add_u32 s52, s65, 64
    buffer_load_dwordx4 v13, s[16:19], s52 offen lds
    s_add_u32 m0, s66, 2048
    s_add_u32 s52, s65, 128
    buffer_load_dwordx4 v13, s[16:19], s52 offen lds
    v_exp_f32 v114, v114
    v_exp_f32 v115, v115
    v_exp_f32 v116, v116
    v_mfma_f32_32x32x16_bf16 v[96:111], v[164:167], v[24:27], 0
    v_exp_f32 v117, v117
    v_exp_f32 v118, v118
    v_exp_f32 v119, v119
    v_exp_f32 v120, v120
    v_exp_f32 v121, v121
    v_exp_f32 v122, v122
    v_smfmac_f32_32x32x32_bf16 v[48:63], v[168:171], v[112:119], v176
    v_exp_f32 v123, v123
    v_exp_f32 v124, v124
    v_exp_f32 v125, v125
    v_exp_f32 v126, v126
    v_exp_f32 v127, v127
    v_exp_f32 v96, v96
    v_exp_f32 v97, v97
    v_smfmac_f32_32x32x32_bf16 v[48:63], v[172:175], v[120:127], v176
    s_buffer_load_dwordx2 s[0:1], s[28:31], s53 offset:1468
    v_exp_f32 v98, v98
    v_exp_f32 v99, v99
    v_exp_f32 v100, v100
    v_mfma_f32_32x32x16_bf16 v[112:127], v[164:167], v[28:31], 0
    v_exp_f32 v101, v101
    v_exp_f32 v102, v102
    v_exp_f32 v103, v103
    v_exp_f32 v104, v104
    v_exp_f32 v105, v105
    v_exp_f32 v106, v106
    v_smfmac_f32_32x32x32_bf16 v[64:79], v[168:171], v[96:103], v176
    v_exp_f32 v107, v107
    v_exp_f32 v108, v108
    v_exp_f32 v109, v109
    v_exp_f32 v110, v110
    v_exp_f32 v111, v111
    v_exp_f32 v112, v112
    v_exp_f32 v113, v113
    v_smfmac_f32_32x32x32_bf16 v[64:79], v[172:175], v[104:111], v176
    s_buffer_load_dwordx2 s[0:1], s[28:31], s53 offset:1596
    v_exp_f32 v114, v114
    v_exp_f32 v115, v115
    v_exp_f32 v116, v116
    s_waitcnt vmcnt(13)
    v_mfma_f32_32x32x16_bf16 v[96:111], v[128:131], v[16:19], 0
    v_exp_f32 v117, v117
    v_exp_f32 v118, v118
    v_exp_f32 v119, v119
    v_exp_f32 v120, v120
    v_exp_f32 v121, v121
    v_exp_f32 v122, v122
    v_smfmac_f32_32x32x32_bf16 v[80:95], v[168:171], v[112:119], v176
    v_exp_f32 v123, v123
    v_exp_f32 v124, v124
    v_exp_f32 v125, v125
    v_exp_f32 v126, v126
    v_exp_f32 v127, v127
    v_exp_f32 v96, v96
    v_exp_f32 v97, v97
    v_smfmac_f32_32x32x32_bf16 v[80:95], v[172:175], v[120:127], v176
    buffer_load_dwordx4 v[164:167], v2, s[40:43], s63 offen offset:3072 sc1
    s_mov_b64 exec, s[60:61]
    buffer_load_dwordx4 v[168:171], v4, s[40:43], s64 offen offset:3072 sc1
    buffer_load_dwordx4 v[172:175], v4, s[40:43], s64 offen offset:3584 sc1
    s_mov_b64 exec, -1
    v_exp_f32 v98, v98
    v_exp_f32 v99, v99
    v_exp_f32 v100, v100
    v_mfma_f32_32x32x16_bf16 v[112:127], v[128:131], v[20:23], 0
    v_exp_f32 v101, v101
    v_exp_f32 v102, v102
    v_exp_f32 v103, v103
    v_exp_f32 v104, v104
    v_exp_f32 v105, v105
    v_exp_f32 v106, v106
    v_smfmac_f32_32x32x32_bf16 v[32:47], v[132:135], v[96:103], v176
    v_exp_f32 v107, v107
    v_exp_f32 v108, v108
    v_exp_f32 v109, v109
    v_exp_f32 v110, v110
    v_exp_f32 v111, v111
    v_exp_f32 v112, v112
    v_exp_f32 v113, v113
    v_smfmac_f32_32x32x32_bf16 v[32:47], v[136:139], v[104:111], v176
    s_add_u32 m0, s66, 3072
    s_add_u32 s52, s65, 57344
    buffer_load_dwordx4 v13, s[16:19], s52 offen lds
    s_add_u32 m0, s66, 4096
    s_add_u32 s52, s65, 57408
    buffer_load_dwordx4 v13, s[16:19], s52 offen lds
    s_add_u32 m0, s66, 5120
    s_add_u32 s52, s65, 57472
    buffer_load_dwordx4 v13, s[16:19], s52 offen lds
    s_add_u32 m0, s66, 6144
    s_add_u32 s52, s65, 192
    buffer_load_dwordx4 v14, s[16:19], s52 offen lds
    s_buffer_load_dwordx2 s[0:1], s[28:31], s53 offset:1724
    v_exp_f32 v114, v114
    v_exp_f32 v115, v115
    v_exp_f32 v116, v116
    v_mfma_f32_32x32x16_bf16 v[96:111], v[128:131], v[24:27], 0
    v_exp_f32 v117, v117
    v_exp_f32 v118, v118
    v_exp_f32 v119, v119
    v_exp_f32 v120, v120
    v_exp_f32 v121, v121
    v_exp_f32 v122, v122
    v_smfmac_f32_32x32x32_bf16 v[48:63], v[132:135], v[112:119], v176
    v_exp_f32 v123, v123
    v_exp_f32 v124, v124
    v_exp_f32 v125, v125
    v_exp_f32 v126, v126
    v_exp_f32 v127, v127
    v_exp_f32 v96, v96
    v_exp_f32 v97, v97
    v_smfmac_f32_32x32x32_bf16 v[48:63], v[136:139], v[120:127], v176
    s_buffer_load_dwordx2 s[0:1], s[28:31], s53 offset:1852
    v_exp_f32 v98, v98
    v_exp_f32 v99, v99
    v_exp_f32 v100, v100
    v_mfma_f32_32x32x16_bf16 v[112:127], v[128:131], v[28:31], 0
    v_exp_f32 v101, v101
    v_exp_f32 v102, v102
    v_exp_f32 v103, v103
    v_exp_f32 v104, v104
    v_exp_f32 v105, v105
    v_exp_f32 v106, v106
    v_smfmac_f32_32x32x32_bf16 v[64:79], v[132:135], v[96:103], v176
    v_exp_f32 v107, v107
    v_exp_f32 v108, v108
    v_exp_f32 v109, v109
    v_exp_f32 v110, v110
    v_exp_f32 v111, v111
    v_exp_f32 v112, v112
    v_exp_f32 v113, v113
    v_smfmac_f32_32x32x32_bf16 v[64:79], v[136:139], v[104:111], v176
    v_exp_f32 v114, v114
    v_exp_f32 v115, v115
    v_exp_f32 v116, v116
    s_waitcnt vmcnt(15)
    v_mfma_f32_32x32x16_bf16 v[96:111], v[140:143], v[16:19], 0
    v_exp_f32 v117, v117
    v_exp_f32 v118, v118
    v_exp_f32 v119, v119
    v_exp_f32 v120, v120
    v_exp_f32 v121, v121
    v_exp_f32 v122, v122
    v_smfmac_f32_32x32x32_bf16 v[80:95], v[132:135], v[112:119], v176
    v_exp_f32 v123, v123
    v_exp_f32 v124, v124
    v_exp_f32 v125, v125
    v_exp_f32 v126, v126
    v_exp_f32 v127, v127
    v_exp_f32 v96, v96
    v_exp_f32 v97, v97
    v_smfmac_f32_32x32x32_bf16 v[80:95], v[136:139], v[120:127], v176
    s_add_u32 s63, s56, s62
    s_add_u32 s64, s57, s62
    s_add_u32 s62, s62, 4096
    s_and_b32 s62, s62, 0x3fff
    buffer_load_dwordx4 v[128:131], v2, s[40:43], s63 offen offset:0 sc1
    s_mov_b64 exec, s[60:61]
    buffer_load_dwordx4 v[132:135], v4, s[40:43], s64 offen offset:0 sc1
    buffer_load_dwordx4 v[136:139], v4, s[40:43], s64 offen offset:512 sc1
    s_mov_b64 exec, -1
    s_buffer_load_dwordx2 s[0:1], s[28:31], s53 offset:1980
    v_exp_f32 v98, v98
    v_exp_f32 v99, v99
    v_exp_f32 v100, v100
    v_mfma_f32_32x32x16_bf16 v[112:127], v[140:143], v[20:23], 0
    v_exp_f32 v101, v101
    v_exp_f32 v102, v102
    v_exp_f32 v103, v103
    v_exp_f32 v104, v104
    v_exp_f32 v105, v105
    v_exp_f32 v106, v106
    v_smfmac_f32_32x32x32_bf16 v[32:47], v[144:147], v[96:103], v176
    v_exp_f32 v107, v107
    v_exp_f32 v108, v108
    v_exp_f32 v109, v109
    v_exp_f32 v110, v110
    v_exp_f32 v111, v111
    v_exp_f32 v112, v112
    v_exp_f32 v113, v113
    v_smfmac_f32_32x32x32_bf16 v[32:47], v[148:151], v[104:111], v176
    s_lshl_b32 s65, s69, 1
    s_add_u32 s65, s65, s44
    s_add_u32 s65, s65, 8
    s_and_b32 s65, s65, 15
    s_mul_i32 s65, s65, 114688
    s_and_b32 s52, s48, 15
    s_mul_i32 s52, s52, 224
    s_add_u32 s65, s65, s52
    s_add_u32 s52, s65, 0
    buffer_load_dwordx4 v[180:183], v13, s[16:19], s52 offen
    s_add_u32 s52, s65, 64
    buffer_load_dwordx4 v[184:187], v13, s[16:19], s52 offen
    s_add_u32 s52, s65, 128
    buffer_load_dwordx4 v[188:191], v13, s[16:19], s52 offen
    s_and_b32 s53, s44, 3
    s_lshl_b32 s52, s2, 2
    s_add_u32 s53, s53, s52
    s_mul_i32 s53, s53, 1792
    s_buffer_load_dwordx2 s[0:1], s[20:23], s53 offset:60
    v_exp_f32 v114, v114
    v_exp_f32 v115, v115
    v_exp_f32 v116, v116
    v_mfma_f32_32x32x16_bf16 v[96:111], v[140:143], v[24:27], 0
    v_exp_f32 v117, v117
    v_exp_f32 v118, v118
    v_exp_f32 v119, v119
    v_exp_f32 v120, v120
    v_exp_f32 v121, v121
    v_exp_f32 v122, v122
    v_smfmac_f32_32x32x32_bf16 v[48:63], v[144:147], v[112:119], v176
    v_exp_f32 v123, v123
    v_exp_f32 v124, v124
    v_exp_f32 v125, v125
    v_exp_f32 v126, v126
    v_exp_f32 v127, v127
    v_exp_f32 v96, v96
    v_exp_f32 v97, v97
    v_smfmac_f32_32x32x32_bf16 v[48:63], v[148:151], v[120:127], v176
    v_exp_f32 v98, v98
    v_exp_f32 v99, v99
    v_exp_f32 v100, v100
    v_mfma_f32_32x32x16_bf16 v[112:127], v[140:143], v[28:31], 0
    v_exp_f32 v101, v101
    v_exp_f32 v102, v102
    v_exp_f32 v103, v103
    v_exp_f32 v104, v104
    v_exp_f32 v105, v105
    v_exp_f32 v106, v106
    v_smfmac_f32_32x32x32_bf16 v[64:79], v[144:147], v[96:103], v176
    v_exp_f32 v107, v107
    v_exp_f32 v108, v108
    v_exp_f32 v109, v109
    v_exp_f32 v110, v110
    v_exp_f32 v111, v111
    v_exp_f32 v112, v112
    v_exp_f32 v113, v113
    v_smfmac_f32_32x32x32_bf16 v[64:79], v[148:151], v[104:111], v176
    s_buffer_load_dwordx2 s[0:1], s[20:23], s53 offset:188
    v_exp_f32 v114, v114
    v_exp_f32 v115, v115
    v_exp_f32 v116, v116
    s_waitcnt vmcnt(16)
    v_mfma_f32_32x32x16_bf16 v[96:111], v[152:155], v[16:19], 0
    v_exp_f32 v117, v117
    v_exp_f32 v118, v118
    v_exp_f32 v119, v119
    v_exp_f32 v120, v120
    v_exp_f32 v121, v121
    v_exp_f32 v122, v122
    v_smfmac_f32_32x32x32_bf16 v[80:95], v[144:147], v[112:119], v176
    v_exp_f32 v123, v123
    v_exp_f32 v124, v124
    v_exp_f32 v125, v125
    v_exp_f32 v126, v126
    v_exp_f32 v127, v127
    v_exp_f32 v96, v96
    v_exp_f32 v97, v97
    v_smfmac_f32_32x32x32_bf16 v[80:95], v[148:151], v[120:127], v176
    buffer_load_dwordx4 v[140:143], v2, s[40:43], s63 offen offset:1024 sc1
    s_mov_b64 exec, s[60:61]
    buffer_load_dwordx4 v[144:147], v4, s[40:43], s64 offen offset:1024 sc1
    buffer_load_dwordx4 v[148:151], v4, s[40:43], s64 offen offset:1536 sc1
    s_mov_b64 exec, -1
    s_buffer_load_dwordx2 s[0:1], s[20:23], s53 offset:316
    v_exp_f32 v98, v98
    v_exp_f32 v99, v99
    v_exp_f32 v100, v100
    v_mfma_f32_32x32x16_bf16 v[112:127], v[152:155], v[20:23], 0
    v_exp_f32 v101, v101
    v_exp_f32 v102, v102
    v_exp_f32 v103, v103
    v_exp_f32 v104, v104
    v_exp_f32 v105, v105
    v_exp_f32 v106, v106
    v_smfmac_f32_32x32x32_bf16 v[32:47], v[156:159], v[96:103], v176
    v_exp_f32 v107, v107
    v_exp_f32 v108, v108
    v_exp_f32 v109, v109
    v_exp_f32 v110, v110
    v_exp_f32 v111, v111
    v_exp_f32 v112, v112
    v_exp_f32 v113, v113
    v_smfmac_f32_32x32x32_bf16 v[32:47], v[160:163], v[104:111], v176
    s_add_u32 s52, s65, 57344
    buffer_load_dwordx4 v[192:195], v13, s[16:19], s52 offen
    s_add_u32 s52, s65, 57408
    buffer_load_dwordx4 v[196:199], v13, s[16:19], s52 offen
    s_add_u32 s52, s65, 57472
    buffer_load_dwordx4 v[200:203], v13, s[16:19], s52 offen
    s_add_u32 s52, s65, 192
    buffer_load_dwordx4 v[204:207], v14, s[16:19], s52 offen
    v_exp_f32 v114, v114
    v_exp_f32 v115, v115
    v_exp_f32 v116, v116
    v_mfma_f32_32x32x16_bf16 v[96:111], v[152:155], v[24:27], 0
    v_exp_f32 v117, v117
    v_exp_f32 v118, v118
    v_exp_f32 v119, v119
    v_exp_f32 v120, v120
    v_exp_f32 v121, v121
    v_exp_f32 v122, v122
    v_smfmac_f32_32x32x32_bf16 v[48:63], v[156:159], v[112:119], v176
    v_exp_f32 v123, v123
    v_exp_f32 v124, v124
    v_exp_f32 v125, v125
    v_exp_f32 v126, v126
    v_exp_f32 v127, v127
    v_exp_f32 v96, v96
    v_exp_f32 v97, v97
    v_smfmac_f32_32x32x32_bf16 v[48:63], v[160:163], v[120:127], v176
    s_buffer_load_dwordx2 s[0:1], s[20:23], s53 offset:444
    v_exp_f32 v98, v98
    v_exp_f32 v99, v99
    v_exp_f32 v100, v100
    v_mfma_f32_32x32x16_bf16 v[112:127], v[152:155], v[28:31], 0
    v_exp_f32 v101, v101
    v_exp_f32 v102, v102
    v_exp_f32 v103, v103
    v_exp_f32 v104, v104
    v_exp_f32 v105, v105
    v_exp_f32 v106, v106
    v_smfmac_f32_32x32x32_bf16 v[64:79], v[156:159], v[96:103], v176
    v_exp_f32 v107, v107
    v_exp_f32 v108, v108
    v_exp_f32 v109, v109
    v_exp_f32 v110, v110
    v_exp_f32 v111, v111
    v_exp_f32 v112, v112
    v_exp_f32 v113, v113
    v_smfmac_f32_32x32x32_bf16 v[64:79], v[160:163], v[104:111], v176
    s_buffer_load_dwordx2 s[0:1], s[20:23], s53 offset:572
    v_exp_f32 v114, v114
    v_exp_f32 v115, v115
    v_exp_f32 v116, v116
    s_waitcnt vmcnt(17)
    v_mfma_f32_32x32x16_bf16 v[96:111], v[164:167], v[16:19], 0
    v_exp_f32 v117, v117
    v_exp_f32 v118, v118
    v_exp_f32 v119, v119
    v_exp_f32 v120, v120
    v_exp_f32 v121, v121
    v_exp_f32 v122, v122
    v_smfmac_f32_32x32x32_bf16 v[80:95], v[156:159], v[112:119], v176
    v_exp_f32 v123, v123
    v_exp_f32 v124, v124
    v_exp_f32 v125, v125
    v_exp_f32 v126, v126
    v_exp_f32 v127, v127
    v_exp_f32 v96, v96
    v_exp_f32 v97, v97
    v_smfmac_f32_32x32x32_bf16 v[80:95], v[160:163], v[120:127], v176
    buffer_load_dwordx4 v[152:155], v2, s[40:43], s63 offen offset:2048 sc1
    s_mov_b64 exec, s[60:61]
    buffer_load_dwordx4 v[156:159], v4, s[40:43], s64 offen offset:2048 sc1
    buffer_load_dwordx4 v[160:163], v4, s[40:43], s64 offen offset:2560 sc1
    s_mov_b64 exec, -1
    v_exp_f32 v98, v98
    v_exp_f32 v99, v99
    v_exp_f32 v100, v100
    v_mfma_f32_32x32x16_bf16 v[112:127], v[164:167], v[20:23], 0
    v_exp_f32 v101, v101
    v_exp_f32 v102, v102
    v_exp_f32 v103, v103
    v_exp_f32 v104, v104
    v_exp_f32 v105, v105
    v_exp_f32 v106, v106
    v_smfmac_f32_32x32x32_bf16 v[32:47], v[168:171], v[96:103], v176
    v_exp_f32 v107, v107
    v_exp_f32 v108, v108
    v_exp_f32 v109, v109
    v_exp_f32 v110, v110
    v_exp_f32 v111, v111
    v_exp_f32 v112, v112
    v_exp_f32 v113, v113
    v_smfmac_f32_32x32x32_bf16 v[32:47], v[172:175], v[104:111], v176
    s_buffer_load_dwordx2 s[0:1], s[20:23], s53 offset:700
    v_exp_f32 v114, v114
    v_exp_f32 v115, v115
    v_exp_f32 v116, v116
    v_mfma_f32_32x32x16_bf16 v[96:111], v[164:167], v[24:27], 0
    v_exp_f32 v117, v117
    v_exp_f32 v118, v118
    v_exp_f32 v119, v119
    v_exp_f32 v120, v120
    v_exp_f32 v121, v121
    v_exp_f32 v122, v122
    v_smfmac_f32_32x32x32_bf16 v[48:63], v[168:171], v[112:119], v176
    v_exp_f32 v123, v123
    v_exp_f32 v124, v124
    v_exp_f32 v125, v125
    v_exp_f32 v126, v126
    v_exp_f32 v127, v127
    v_exp_f32 v96, v96
    v_exp_f32 v97, v97
    v_smfmac_f32_32x32x32_bf16 v[48:63], v[172:175], v[120:127], v176
    s_buffer_load_dwordx2 s[0:1], s[20:23], s53 offset:828
    v_exp_f32 v98, v98
    v_exp_f32 v99, v99
    v_exp_f32 v100, v100
    v_mfma_f32_32x32x16_bf16 v[112:127], v[164:167], v[28:31], 0
    v_exp_f32 v101, v101
    v_exp_f32 v102, v102
    v_exp_f32 v103, v103
    v_exp_f32 v104, v104
    v_exp_f32 v105, v105
    v_exp_f32 v106, v106
    v_smfmac_f32_32x32x32_bf16 v[64:79], v[168:171], v[96:103], v176
    v_exp_f32 v107, v107
    v_exp_f32 v108, v108
    v_exp_f32 v109, v109
    v_exp_f32 v110, v110
    v_exp_f32 v111, v111
    v_exp_f32 v112, v112
    v_exp_f32 v113, v113
    v_smfmac_f32_32x32x32_bf16 v[64:79], v[172:175], v[104:111], v176
    v_exp_f32 v114, v114
    v_exp_f32 v115, v115
    v_exp_f32 v116, v116
    s_waitcnt vmcnt(13)
    v_mfma_f32_32x32x16_bf16 v[96:111], v[128:131], v[16:19], 0
    v_exp_f32 v117, v117
    v_exp_f32 v118, v118
    v_exp_f32 v119, v119
    v_exp_f32 v120, v120
    v_exp_f32 v121, v121
    v_exp_f32 v122, v122
    v_smfmac_f32_32x32x32_bf16 v[80:95], v[168:171], v[112:119], v176
    v_exp_f32 v123, v123
    v_exp_f32 v124, v124
    v_exp_f32 v125, v125
    v_exp_f32 v126, v126
    v_exp_f32 v127, v127
    v_exp_f32 v96, v96
    v_exp_f32 v97, v97
    v_smfmac_f32_32x32x32_bf16 v[80:95], v[172:175], v[120:127], v176
    buffer_load_dwordx4 v[164:167], v2, s[40:43], s63 offen offset:3072 sc1
    s_mov_b64 exec, s[60:61]
    buffer_load_dwordx4 v[168:171], v4, s[40:43], s64 offen offset:3072 sc1
    buffer_load_dwordx4 v[172:175], v4, s[40:43], s64 offen offset:3584 sc1
    s_mov_b64 exec, -1
    s_buffer_load_dwordx2 s[0:1], s[20:23], s53 offset:956
    v_exp_f32 v98, v98
    v_exp_f32 v99, v99
    v_exp_f32 v100, v100
    v_mfma_f32_32x32x16_bf16 v[112:127], v[128:131], v[20:23], 0
    v_exp_f32 v101, v101
    v_exp_f32 v102, v102
    v_exp_f32 v103, v103
    v_exp_f32 v104, v104
    v_exp_f32 v105, v105
    v_exp_f32 v106, v106
    v_smfmac_f32_32x32x32_bf16 v[32:47], v[132:135], v[96:103], v176
    v_exp_f32 v107, v107
    v_exp_f32 v108, v108
    v_exp_f32 v109, v109
    v_exp_f32 v110, v110
    v_exp_f32 v111, v111
    v_exp_f32 v112, v112
    v_exp_f32 v113, v113
    v_smfmac_f32_32x32x32_bf16 v[32:47], v[136:139], v[104:111], v176
    s_buffer_load_dwordx2 s[0:1], s[20:23], s53 offset:1084
    v_exp_f32 v114, v114
    v_exp_f32 v115, v115
    v_exp_f32 v116, v116
    v_mfma_f32_32x32x16_bf16 v[96:111], v[128:131], v[24:27], 0
    v_exp_f32 v117, v117
    v_exp_f32 v118, v118
    v_exp_f32 v119, v119
    v_exp_f32 v120, v120
    v_exp_f32 v121, v121
    v_exp_f32 v122, v122
    v_smfmac_f32_32x32x32_bf16 v[48:63], v[132:135], v[112:119], v176
    v_exp_f32 v123, v123
    v_exp_f32 v124, v124
    v_exp_f32 v125, v125
    v_exp_f32 v126, v126
    v_exp_f32 v127, v127
    v_exp_f32 v96, v96
    v_exp_f32 v97, v97
    v_smfmac_f32_32x32x32_bf16 v[48:63], v[136:139], v[120:127], v176
    s_cmp_lt_u32 s44, 4
    s_cbranch_scc1 Latt_nomod
    s_sub_u32 s52, s48, 8
    s_cmp_ge_u32 s52, 16
    s_cbranch_scc1 Latt_nomod
    s_lshl_b32 s66, s49, 2
    s_lshr_b32 s52, s52, 2
    s_add_u32 s66, s66, s52
    s_lshl_b32 s66, s66, 6
    s_and_b32 s52, s48, 3
    s_lshl_b32 s52, s52, 4
    s_add_u32 s66, s66, s52
    s_add_u32 s66, s66, 1024
    v_bfe_u32 v244, v0, 1, 7
    v_and_b32 v245, 1, v0
    v_mul_u32_u24 v246, 6144, v244
    v_lshl_add_u32 v246, v245, 4, v246
    v_lshlrev_b32 v247, 1, v244
    s_lshl_b32 s52, s66, 1
    buffer_load_dwordx4 v[208:211], v246, s[28:31], s52 offen
    s_add_u32 s52, s52, 786432
    buffer_load_dwordx4 v[212:215], v246, s[28:31], s52 offen
    s_add_u32 s52, s52, 786432
    buffer_load_dwordx4 v[216:219], v246, s[28:31], s52 offen
    s_add_u32 s52, s52, 786432
    buffer_load_dwordx4 v[220:223], v246, s[28:31], s52 offen
    buffer_load_ushort v224, v247, s[24:27], 0 offen offset:0
    buffer_load_ushort v225, v247, s[24:27], 0 offen offset:256
    buffer_load_ushort v226, v247, s[24:27], 0 offen offset:512
    buffer_load_ushort v227, v247, s[24:27], 0 offen offset:768
Latt_nomod:
    v_exp_f32 v98, v98
    v_exp_f32 v99, v99
    v_exp_f32 v100, v100
    v_mfma_f32_32x32x16_bf16 v[112:127], v[128:131], v[28:31], 0
    v_exp_f32 v101, v101
    v_exp_f32 v102, v102
    v_exp_f32 v103, v103
    v_exp_f32 v104, v104
    v_exp_f32 v105, v105
    v_exp_f32 v106, v106
    v_smfmac_f32_32x32x32_bf16 v[64:79], v[132:135], v[96:103], v176
    v_exp_f32 v107, v107
    v_exp_f32 v108, v108
    v_exp_f32 v109, v109
    v_exp_f32 v110, v110
    v_exp_f32 v111, v111
    v_exp_f32 v112, v112
    v_exp_f32 v113, v113
    v_smfmac_f32_32x32x32_bf16 v[64:79], v[136:139], v[104:111], v176
    s_buffer_load_dwordx2 s[0:1], s[20:23], s53 offset:1212
    v_exp_f32 v114, v114
    v_exp_f32 v115, v115
    v_exp_f32 v116, v116
    s_waitcnt vmcnt(10)
    v_mfma_f32_32x32x16_bf16 v[96:111], v[140:143], v[16:19], 0
    v_exp_f32 v117, v117
    v_exp_f32 v118, v118
    v_exp_f32 v119, v119
    v_exp_f32 v120, v120
    v_exp_f32 v121, v121
    v_exp_f32 v122, v122
    v_smfmac_f32_32x32x32_bf16 v[80:95], v[132:135], v[112:119], v176
    v_exp_f32 v123, v123
    v_exp_f32 v124, v124
    v_exp_f32 v125, v125
    v_exp_f32 v126, v126
    v_exp_f32 v127, v127
    v_exp_f32 v96, v96
    v_exp_f32 v97, v97
    v_smfmac_f32_32x32x32_bf16 v[80:95], v[136:139], v[120:127], v176
    s_buffer_load_dwordx2 s[0:1], s[20:23], s53 offset:1340
    v_exp_f32 v98, v98
    v_exp_f32 v99, v99
    v_exp_f32 v100, v100
    v_mfma_f32_32x32x16_bf16 v[112:127], v[140:143], v[20:23], 0
    v_exp_f32 v101, v101
    v_exp_f32 v102, v102
    v_exp_f32 v103, v103
    v_exp_f32 v104, v104
    v_exp_f32 v105, v105
    v_exp_f32 v106, v106
    v_smfmac_f32_32x32x32_bf16 v[32:47], v[144:147], v[96:103], v176
    v_exp_f32 v107, v107
    v_exp_f32 v108, v108
    v_exp_f32 v109, v109
    v_exp_f32 v110, v110
    v_exp_f32 v111, v111
    s_cmp_ge_u32 s44, 4
    s_cbranch_scc1 Latt_prio
    s_setprio 0
Latt_prio:
    v_exp_f32 v112, v112
    v_exp_f32 v113, v113
    v_smfmac_f32_32x32x32_bf16 v[32:47], v[148:151], v[104:111], v176
    v_exp_f32 v114, v114
    v_exp_f32 v115, v115
    v_exp_f32 v116, v116
    v_mfma_f32_32x32x16_bf16 v[96:111], v[140:143], v[24:27], 0
    v_exp_f32 v117, v117
    v_exp_f32 v118, v118
    v_exp_f32 v119, v119
    v_exp_f32 v120, v120
    v_exp_f32 v121, v121
    v_exp_f32 v122, v122
    v_smfmac_f32_32x32x32_bf16 v[48:63], v[144:147], v[112:119], v176
    v_exp_f32 v123, v123
    v_exp_f32 v124, v124
    v_exp_f32 v125, v125
    v_exp_f32 v126, v126
    v_exp_f32 v127, v127
    v_exp_f32 v96, v96
    v_exp_f32 v97, v97
    v_smfmac_f32_32x32x32_bf16 v[48:63], v[148:151], v[120:127], v176
    s_buffer_load_dwordx2 s[0:1], s[20:23], s53 offset:1468
    v_exp_f32 v98, v98
    v_exp_f32 v99, v99
    v_exp_f32 v100, v100
    v_mfma_f32_32x32x16_bf16 v[112:127], v[140:143], v[28:31], 0
    v_exp_f32 v101, v101
    v_exp_f32 v102, v102
    v_exp_f32 v103, v103
    v_exp_f32 v104, v104
    v_exp_f32 v105, v105
    v_exp_f32 v106, v106
    v_smfmac_f32_32x32x32_bf16 v[64:79], v[144:147], v[96:103], v176
    v_exp_f32 v107, v107
    v_exp_f32 v108, v108
    v_exp_f32 v109, v109
    v_exp_f32 v110, v110
    v_exp_f32 v111, v111
    v_exp_f32 v112, v112
    v_exp_f32 v113, v113
    v_smfmac_f32_32x32x32_bf16 v[64:79], v[148:151], v[104:111], v176
    s_buffer_load_dwordx2 s[0:1], s[20:23], s53 offset:1596
    v_exp_f32 v114, v114
    v_exp_f32 v115, v115
    v_exp_f32 v116, v116
    s_waitcnt vmcnt(3)
    v_mfma_f32_32x32x16_bf16 v[96:111], v[152:155], v[16:19], 0
    v_exp_f32 v117, v117
    v_exp_f32 v118, v118
    v_exp_f32 v119, v119
    v_exp_f32 v120, v120
    v_exp_f32 v121, v121
    v_exp_f32 v122, v122
    v_smfmac_f32_32x32x32_bf16 v[80:95], v[144:147], v[112:119], v176
    v_exp_f32 v123, v123
    v_exp_f32 v124, v124
    v_exp_f32 v125, v125
    v_exp_f32 v126, v126
    v_exp_f32 v127, v127
    v_exp_f32 v96, v96
    v_exp_f32 v97, v97
    v_smfmac_f32_32x32x32_bf16 v[80:95], v[148:151], v[120:127], v176
    v_exp_f32 v98, v98
    v_exp_f32 v99, v99
    v_exp_f32 v100, v100
    v_mfma_f32_32x32x16_bf16 v[112:127], v[152:155], v[20:23], 0
    v_exp_f32 v101, v101
    v_exp_f32 v102, v102
    v_exp_f32 v103, v103
    v_exp_f32 v104, v104
    v_exp_f32 v105, v105
    v_exp_f32 v106, v106
    v_smfmac_f32_32x32x32_bf16 v[32:47], v[156:159], v[96:103], v176
    v_exp_f32 v107, v107
    v_exp_f32 v108, v108
    v_exp_f32 v109, v109
    v_exp_f32 v110, v110
    v_exp_f32 v111, v111
    v_exp_f32 v112, v112
    v_exp_f32 v113, v113
    v_smfmac_f32_32x32x32_bf16 v[32:47], v[160:163], v[104:111], v176
    s_cmp_ge_u32 s44, 4
    s_cbranch_scc1 Latt_nox
    v_bfe_u32 v5, v1, 5, 1
    v_and_b32 v6, 31, v1
    v_lshlrev_b32 v6, 10, v6
    v_lshl_add_u32 v6, v5, 3, v6
    s_lshl_b32 s52, s49, 1
    s_lshr_b32 s50, s48, 4
    s_add_u32 s52, s52, s50
    s_lshl_b32 s52, s52, 2
    s_add_u32 s67, s52, s44
    s_lshl_b32 s52, s67, 15
    s_and_b32 s50, s48, 15
    s_lshl_b32 s50, s50, 6
    s_add_u32 s52, s52, s50
    buffer_load_dwordx2 v[208:209], v6, s[4:7], s52 offen offset:0
    buffer_load_dwordx2 v[210:211], v6, s[4:7], s52 offen offset:16
    buffer_load_dwordx2 v[212:213], v6, s[4:7], s52 offen offset:32
    buffer_load_dwordx2 v[214:215], v6, s[4:7], s52 offen offset:48
    s_lshr_b32 s52, s67, 2
    s_lshl_b32 s52, s52, 7
    s_add_u32 s52, s52, 0x58000
    v_and_b32 v5, 15, v1
    v_lshlrev_b32 v5, 2, v5
    buffer_load_dword v216, v5, s[40:43], s52 offen sc1
Latt_nox:
    s_buffer_load_dwordx2 s[0:1], s[20:23], s53 offset:1724
    v_exp_f32 v114, v114
    v_exp_f32 v115, v115
    v_exp_f32 v116, v116
    v_mfma_f32_32x32x16_bf16 v[96:111], v[152:155], v[24:27], 0
    v_exp_f32 v117, v117
    v_exp_f32 v118, v118
    v_exp_f32 v119, v119
    v_exp_f32 v120, v120
    v_exp_f32 v121, v121
    v_exp_f32 v122, v122
    v_smfmac_f32_32x32x32_bf16 v[48:63], v[156:159], v[112:119], v176
    v_exp_f32 v123, v123
    v_exp_f32 v124, v124
    v_exp_f32 v125, v125
    v_exp_f32 v126, v126
    v_exp_f32 v127, v127
    v_exp_f32 v96, v96
    v_exp_f32 v97, v97
    v_smfmac_f32_32x32x32_bf16 v[48:63], v[160:163], v[120:127], v176
    v_exp_f32 v98, v98
    v_exp_f32 v99, v99
    v_exp_f32 v100, v100
    v_mfma_f32_32x32x16_bf16 v[112:127], v[152:155], v[28:31], 0
    v_exp_f32 v101, v101
    v_exp_f32 v102, v102
    v_exp_f32 v103, v103
    v_exp_f32 v104, v104
    v_exp_f32 v105, v105
    v_exp_f32 v106, v106
    v_smfmac_f32_32x32x32_bf16 v[64:79], v[156:159], v[96:103], v176
    v_exp_f32 v107, v107
    v_exp_f32 v108, v108
    v_exp_f32 v109, v109
    v_exp_f32 v110, v110
    v_exp_f32 v111, v111
    v_exp_f32 v112, v112
    v_exp_f32 v113, v113
    v_smfmac_f32_32x32x32_bf16 v[64:79], v[160:163], v[104:111], v176
    s_mul_i32 s63, s54, 12
    v_lshlrev_b32 v15, 2, v1
    v_exp_f32 v114, v114
    v_exp_f32 v115, v115
    v_exp_f32 v116, v116
    s_waitcnt vmcnt(0)
    v_mfma_f32_32x32x16_bf16 v[96:111], v[164:167], v[20:23], 0
    v_exp_f32 v117, v117
    v_exp_f32 v118, v118
    v_exp_f32 v119, v119
    v_exp_f32 v120, v120
    v_exp_f32 v121, v121
    v_exp_f32 v122, v122
    v_smfmac_f32_32x32x32_bf16 v[80:95], v[156:159], v[112:119], v176
    v_exp_f32 v123, v123
    v_exp_f32 v124, v124
    v_exp_f32 v125, v125
    v_exp_f32 v126, v126
    v_exp_f32 v127, v127
    v_exp_f32 v96, v96
    v_exp_f32 v97, v97
    v_smfmac_f32_32x32x32_bf16 v[80:95], v[160:163], v[120:127], v176
    v_exp_f32 v98, v98
    v_exp_f32 v99, v99
    v_exp_f32 v100, v100
    v_mfma_f32_32x32x16_bf16 v[112:127], v[164:167], v[24:27], 0
    v_exp_f32 v101, v101
    v_exp_f32 v102, v102
    v_exp_f32 v103, v103
    v_exp_f32 v104, v104
    v_exp_f32 v105, v105
    v_exp_f32 v106, v106
    v_smfmac_f32_32x32x32_bf16 v[48:63], v[168:171], v[96:103], v176
    v_exp_f32 v107, v107
    v_exp_f32 v108, v108
    v_exp_f32 v109, v109
    v_exp_f32 v110, v110
    v_exp_f32 v111, v111
    v_exp_f32 v112, v112
    v_exp_f32 v113, v113
    v_smfmac_f32_32x32x32_bf16 v[48:63], v[172:175], v[104:111], v176
    v_exp_f32 v114, v114
    v_exp_f32 v115, v115
    v_exp_f32 v116, v116
    v_mfma_f32_32x32x16_bf16 v[96:111], v[164:167], v[28:31], 0
    v_exp_f32 v117, v117
    v_exp_f32 v118, v118
    v_exp_f32 v119, v119
    v_exp_f32 v120, v120
    v_exp_f32 v121, v121
    v_exp_f32 v122, v122
    v_smfmac_f32_32x32x32_bf16 v[64:79], v[168:171], v[112:119], v176
    v_exp_f32 v123, v123
    s_add_u32 s52, s55, 1
    s_and_b32 s52, s52, 3
    s_mul_i32 s52, s52, 3
    s_add_u32 s52, s52, s63
    s_add_u32 s52, s52, 0
    s_mul_i32 s52, s52, 2304
    s_add_u32 s52, s52, 90112
    v_exp_f32 v124, v124
    v_add_u32 v6, s52, v2
    v_add_u32 v7, s52, v15
    v_exp_f32 v125, v125
    ds_write_b128 v6, v[48:51]
    v_exp_f32 v126, v126
    ds_write_b128 v6, v[52:55] offset:1024
    v_exp_f32 v127, v127
    ds_write_b32 v7, v56 offset:2048
    v_exp_f32 v96, v96
    v_exp_f32 v97, v97
    v_smfmac_f32_32x32x32_bf16 v[64:79], v[172:175], v[120:127], v176
    s_mul_i32 s52, s48, 7
    s_min_u32 s50, s44, 6
    s_add_u32 s52, s52, s50
    s_lshl_b32 s52, s52, 13
    v_lshlrev_b32 v5, 7, v1
    buffer_load_dword v248, v5, s[20:23], s52 offen
    v_exp_f32 v98, v98
    v_exp_f32 v99, v99
    v_exp_f32 v100, v100
    v_mfma_f32_32x32x16_bf16 v[112:127], v[164:167], v[16:19], 0
    v_exp_f32 v101, v101
    v_exp_f32 v102, v102
    v_exp_f32 v103, v103
    v_exp_f32 v104, v104
    v_exp_f32 v105, v105
    v_exp_f32 v106, v106
    v_smfmac_f32_32x32x32_bf16 v[80:95], v[168:171], v[96:103], v176
    v_exp_f32 v107, v107
    s_add_u32 s52, s55, 2
    s_and_b32 s52, s52, 3
    s_mul_i32 s52, s52, 3
    s_add_u32 s52, s52, s63
    s_add_u32 s52, s52, 1
    s_mul_i32 s52, s52, 2304
    s_add_u32 s52, s52, 90112
    v_exp_f32 v108, v108
    v_add_u32 v6, s52, v2
    v_add_u32 v7, s52, v15
    v_exp_f32 v109, v109
    ds_write_b128 v6, v[64:67]
    v_exp_f32 v110, v110
    ds_write_b128 v6, v[68:71] offset:1024
    v_exp_f32 v111, v111
    ds_write_b32 v7, v72 offset:2048
    v_exp_f32 v112, v112
    v_exp_f32 v113, v113
    v_smfmac_f32_32x32x32_bf16 v[80:95], v[172:175], v[104:111], v176
    v_exp_f32 v114, v114
    v_exp_f32 v115, v115
    v_exp_f32 v116, v116
    v_exp_f32 v117, v117
    v_exp_f32 v118, v118
    v_exp_f32 v119, v119
    v_exp_f32 v120, v120
    v_exp_f32 v121, v121
    v_exp_f32 v122, v122
    v_smfmac_f32_32x32x32_bf16 v[32:47], v[168:171], v[112:119], v176
    v_exp_f32 v123, v123
    s_add_u32 s52, s55, 3
    s_and_b32 s52, s52, 3
    s_mul_i32 s52, s52, 3
    s_add_u32 s52, s52, s63
    s_add_u32 s52, s52, 2
    s_mul_i32 s52, s52, 2304
    s_add_u32 s52, s52, 90112
    v_exp_f32 v124, v124
    v_add_u32 v6, s52, v2
    v_add_u32 v7, s52, v15
    v_exp_f32 v125, v125
    ds_write_b128 v6, v[80:83]
    v_exp_f32 v126, v126
    ds_write_b128 v6, v[84:87] offset:1024
    v_exp_f32 v127, v127
    ds_write_b32 v7, v88 offset:2048
    s_nop 1
    v_smfmac_f32_32x32x32_bf16 v[32:47], v[172:175], v[120:127], v176
    s_setprio 0
    s_mul_i32 s52, s55, 3
    s_add_u32 s52, s52, s63
    s_mul_i32 s52, s52, 2304
    s_add_u32 s52, s52, 90112
    v_add_u32 v6, s52, v2
    v_add_u32 v7, s52, v15
    s_lshl_b32 s52, s45, 2
    s_add_u32 s52, s52, s55
    s_lshl_b32 s52, s52, 5
    s_add_u32 s52, s52, s58
    s_lshl_b32 s63, s52, 10
    s_add_u32 s63, s63, 0x800000
    s_lshr_b32 s50, s52, 3
    s_lshl_b32 s50, s50, 7
    s_and_b32 s64, s52, 7
    s_lshl_b32 s64, s64, 2
    s_add_u32 s64, s64, s50
    s_add_u32 s64, s64, 0x80000
    s_lshl_b32 s45, s49, 1
    s_lshr_b32 s50, s48, 4
    s_add_u32 s45, s45, s50
    s_and_b32 s46, s48, 15
    s_waitcnt vmcnt(1)
    s_waitcnt lgkmcnt(0)
    s_barrier
    ds_read_b128 v[96:99], v6 offset:0
    ds_read_b128 v[100:103], v6 offset:1024
    ds_read_b32 v104, v7 offset:2048
    ds_read_b128 v[108:111], v6 offset:2304
    ds_read_b128 v[112:115], v6 offset:3328
    ds_read_b32 v116, v7 offset:4352
    ds_read_b128 v[120:123], v6 offset:4608
    ds_read_b128 v[124:127], v6 offset:5632
    ds_read_b32 v128, v7 offset:6656
    s_mov_b32 s52, 0x21800000
    s_mov_b32 s53, 0x5d800000
    s_movk_i32 s65, 0x207
    s_waitcnt lgkmcnt(6)
    v_add_f32 v32, v32, v96
    v_add_f32 v33, v33, v97
    v_add_f32 v34, v34, v98
    v_add_f32 v35, v35, v99
    v_add_f32 v36, v36, v100
    v_add_f32 v37, v37, v101
    v_add_f32 v38, v38, v102
    v_add_f32 v39, v39, v103
    v_add_f32 v40, v40, v104
    s_waitcnt lgkmcnt(3)
    v_add_f32 v32, v32, v108
    v_add_f32 v33, v33, v109
    v_add_f32 v34, v34, v110
    v_add_f32 v35, v35, v111
    v_add_f32 v36, v36, v112
    v_add_f32 v37, v37, v113
    v_add_f32 v38, v38, v114
    v_add_f32 v39, v39, v115
    v_add_f32 v40, v40, v116
    s_waitcnt lgkmcnt(0)
    v_add_f32 v32, v32, v120
    v_add_f32 v33, v33, v121
    v_add_f32 v34, v34, v122
    v_add_f32 v35, v35, v123
    v_add_f32 v36, v36, v124
    v_add_f32 v37, v37, v125
    v_add_f32 v38, v38, v126
    v_add_f32 v39, v39, v127
    v_add_f32 v40, v40, v128
    v_add_f32 v8, v32, v33
    v_add_f32 v9, v34, v35
    v_add_f32 v10, v36, v37
    v_add_f32 v11, v38, v39
    v_add_f32 v8, v8, v9
    v_add_f32 v10, v10, v11
    v_add_f32 v8, v8, v10
    v_cmp_nge_f32 vcc, v40, s52
    v_cmp_nle_f32 s[54:55], v40, s53
    v_cmp_class_f32 s[56:57], v8, s65
    v_rcp_f32 v8, v40
    s_or_b64 vcc, vcc, s[54:55]
    s_or_b64 vcc, vcc, s[56:57]
    s_cbranch_vccnz Lslow
Lnorm:
    v_mul_f32 v32, v32, v8
    v_mul_f32 v33, v33, v8
    v_mul_f32 v34, v34, v8
    v_mul_f32 v35, v35, v8
    v_mul_f32 v36, v36, v8
    v_mul_f32 v37, v37, v8
    v_mul_f32 v38, v38, v8
    v_mul_f32 v39, v39, v8
    v_cvt_pk_bf16_f32 v8, v32, v33
    v_cvt_pk_bf16_f32 v9, v34, v35
    v_cvt_pk_bf16_f32 v10, v36, v37
    v_cvt_pk_bf16_f32 v11, v38, v39
    buffer_store_dwordx4 v[8:11], v2, s[40:43], s63 offen sc1
    s_barrier
    s_mul_i32 s52, s44, 7168
    s_add_u32 s52, s52, 90112
    v_add_u32 v5, s52, v2
    ds_write_b128 v5, v[180:183] offset:0
    ds_write_b128 v5, v[184:187] offset:1024
    ds_write_b128 v5, v[188:191] offset:2048
    ds_write_b128 v5, v[192:195] offset:3072
    ds_write_b128 v5, v[196:199] offset:4096
    ds_write_b128 v5, v[200:203] offset:5120
    ds_write_b128 v5, v[204:207] offset:6144
    s_cmp_ge_u32 s44, 4
    s_cbranch_scc1 Lhelper2
    s_setprio 1
    s_getreg_b32 s50, hwreg(HW_REG_XCC_ID)
    s_and_b32 s50, s50, 15
    s_lshl_b32 s50, s50, 1
    s_add_u32 s50, s50, s47
    v_cmp_ne_u32 vcc, s50, v216
    v_bfe_u32 v9, v1, 5, 1
    s_cmp_eq_u64 vcc, 0
    s_cselect_b32 s66, 1, 0
    v_lshlrev_b32 v80, 16, v208
    v_and_b32 v81, 0xffff0000, v208
    v_lshlrev_b32 v82, 16, v209
    v_and_b32 v83, 0xffff0000, v209
    v_lshlrev_b32 v84, 16, v210
    v_and_b32 v85, 0xffff0000, v210
    v_lshlrev_b32 v86, 16, v211
    v_and_b32 v87, 0xffff0000, v211
    v_lshlrev_b32 v88, 16, v212
    v_and_b32 v89, 0xffff0000, v212
    v_lshlrev_b32 v90, 16, v213
    v_and_b32 v91, 0xffff0000, v213
    v_lshlrev_b32 v92, 16, v214
    v_and_b32 v93, 0xffff0000, v214
    v_lshlrev_b32 v94, 16, v215
    v_and_b32 v95, 0xffff0000, v215
    s_lshl_b32 s57, s67, 15
    s_lshl_b32 s58, s46, 11
    s_add_u32 s57, s57, s58
    s_add_u32 s58, s57, 0xc00000
    s_add_u32 s57, s57, 0xa00000
    s_lshl_b32 s54, s46, 14
    s_lshl_b32 s55, s67, 8
    s_add_u32 s54, s54, s55
    s_add_u32 s54, s54, 0x10000
    s_lshl_b32 s55, s67, 4
    s_add_u32 s55, s55, s46
    s_lshr_b32 s50, s55, 3
    s_lshl_b32 s50, s50, 7
    s_and_b32 s56, s55, 7
    s_lshl_b32 s56, s56, 2
    s_add_u32 s56, s56, s50
    s_add_u32 s56, s56, 0xc0000
    s_lshl_b32 s55, s67, 8
    s_add_u32 s55, s55, 0xc0000
    v_bfe_u32 v10, v0, 2, 2
    v_bfe_u32 v11, v0, 5, 1
    v_lshl_add_u32 v10, v11, 2, v10
    v_lshlrev_b32 v10, 6, v10
    v_bfe_u32 v11, v0, 4, 1
    v_lshl_add_u32 v10, v11, 5, v10
    v_and_b32 v11, 3, v0
    v_lshl_add_u32 v10, v11, 3, v10
    v_mov_b32 v16, 0
    v_mov_b32 v17, 0
    v_mov_b32 v18, 0
    v_mov_b32 v19, 0
    v_mov_b32 v20, 0
    v_mov_b32 v21, 0
    v_mov_b32 v22, 0
    v_mov_b32 v23, 0
    v_mov_b32 v24, 0
    v_mov_b32 v25, 0
    v_mov_b32 v26, 0
    v_mov_b32 v27, 0
    v_mov_b32 v28, 0
    v_mov_b32 v29, 0
    v_mov_b32 v30, 0
    v_mov_b32 v31, 0
    v_lshrrev_b32 v5, 3, v1
    v_lshlrev_b32 v5, 5, v5
    v_and_or_b32 v5, v1, 7, v5
    v_lshlrev_b32 v5, 2, v5
    s_lshl_b32 s52, s67, 9
    s_add_u32 s52, s52, 0x80000
    s_waitcnt vmcnt(0)
    v_mov_b32 v8, s47
    s_mov_b64 exec, 1
    buffer_store_dword v8, v3, s[40:43], s64 offen sc1
    s_mov_b64 exec, -1
    s_cmp_eq_u32 s66, 0
    s_cbranch_scc1 La_noft
    v_and_b32 v12, 1, v1
    v_lshlrev_b32 v12, 7, v12
    s_mov_b64 exec, 3
    buffer_load_dword v13, v12, s[40:43], s55 offen sc1
    s_add_u32 s53, s55, 0x20000
    buffer_load_dword v13, v12, s[40:43], s53 offen sc1
    s_mov_b64 exec, -1
La_noft:
    s_mov_b64 exec, 0xffffffff
    s_mov_b32 s50, 20000
    s_sleep 25
Lpoll11:
    buffer_load_dword v11, v5, s[40:43], s52 offen sc1
    s_waitcnt vmcnt(0)
    v_cmp_ne_u32 vcc, s47, v11
    s_sub_u32 s50, s50, 1
    s_cbranch_vccz Lpolld11
    s_cmp_lg_u32 s50, 0
    s_cbranch_scc1 Lpoll11
Lpolld11:
    s_mov_b64 exec, -1
    s_lshl_b32 s52, s67, 15
    s_add_u32 s52, s52, 0x800000
    s_add_u32 s53, s69, 0
    s_and_b32 s53, s53, 7
    s_lshl_b32 s53, s53, 12
    s_add_u32 s53, s53, s52
    buffer_load_dwordx4 v[128:131], v2, s[40:43], s53 offen offset:0 sc1
    buffer_load_dwordx4 v[132:135], v2, s[40:43], s53 offen offset:1024 sc1
    buffer_load_dwordx4 v[136:139], v2, s[40:43], s53 offen offset:2048 sc1
    buffer_load_dwordx4 v[140:143], v2, s[40:43], s53 offen offset:3072 sc1
    s_add_u32 s53, s69, 1
    s_and_b32 s53, s53, 7
    s_lshl_b32 s53, s53, 12
    s_add_u32 s53, s53, s52
    buffer_load_dwordx4 v[144:147], v2, s[40:43], s53 offen offset:0 sc1
    buffer_load_dwordx4 v[148:151], v2, s[40:43], s53 offen offset:1024 sc1
    buffer_load_dwordx4 v[152:155], v2, s[40:43], s53 offen offset:2048 sc1
    buffer_load_dwordx4 v[156:159], v2, s[40:43], s53 offen offset:3072 sc1
    s_add_u32 s53, s69, 2
    s_and_b32 s53, s53, 7
    s_lshl_b32 s53, s53, 12
    s_add_u32 s53, s53, s52
    buffer_load_dwordx4 v[160:163], v2, s[40:43], s53 offen offset:0 sc1
    buffer_load_dwordx4 v[164:167], v2, s[40:43], s53 offen offset:1024 sc1
    buffer_load_dwordx4 v[168:171], v2, s[40:43], s53 offen offset:2048 sc1
    buffer_load_dwordx4 v[172:175], v2, s[40:43], s53 offen offset:3072 sc1
    v_mov_b32 v126, 160512
    v_mov_b32 v127, 1
    s_mov_b64 exec, 1
    ds_add_u32 v126, v127 offset:12
    s_mov_b64 exec, -1
    v_lshlrev_b32 v6, 2, v1
    v_lshlrev_b32 v5, 4, v9
    v_add_u32 v5, 159744, v5
    ds_read_b64_tr_b16 v[96:97], v10 offset:0
    ds_read_b64_tr_b16 v[98:99], v10 offset:512
    ds_read_b64_tr_b16 v[100:101], v10 offset:1024
    ds_read_b64_tr_b16 v[102:103], v10 offset:1536
    ds_read_b64_tr_b16 v[104:105], v10 offset:2048
    ds_read_b64_tr_b16 v[106:107], v10 offset:2560
    ds_read_b64_tr_b16 v[108:109], v10 offset:3072
    ds_read_b64_tr_b16 v[110:111], v10 offset:3584
    s_waitcnt lgkmcnt(6)
    s_waitcnt vmcnt(11)
    v_mfma_f32_32x32x16_bf16 v[16:31], v[96:99], v[128:131], v[16:31]
    s_add_u32 s53, s69, 3
    s_and_b32 s53, s53, 7
    s_lshl_b32 s53, s53, 12
    s_add_u32 s53, s53, s52
    buffer_load_dwordx4 v[176:179], v2, s[40:43], s53 offen offset:0 sc1
    ds_read_b64_tr_b16 v[96:97], v10 offset:4096
    ds_read_b64_tr_b16 v[98:99], v10 offset:4608
    s_waitcnt lgkmcnt(6)
    s_waitcnt vmcnt(11)
    v_mfma_f32_32x32x16_bf16 v[16:31], v[100:103], v[132:135], v[16:31]
    buffer_load_dwordx4 v[180:183], v2, s[40:43], s53 offen offset:1024 sc1
    ds_read_b64_tr_b16 v[100:101], v10 offset:5120
    ds_read_b64_tr_b16 v[102:103], v10 offset:5632
    s_waitcnt lgkmcnt(6)
    s_waitcnt vmcnt(11)
    v_mfma_f32_32x32x16_bf16 v[16:31], v[104:107], v[136:139], v[16:31]
    buffer_load_dwordx4 v[184:187], v2, s[40:43], s53 offen offset:2048 sc1
    ds_read_b64_tr_b16 v[104:105], v10 offset:6144
    ds_read_b64_tr_b16 v[106:107], v10 offset:6656
    s_waitcnt lgkmcnt(6)
    s_waitcnt vmcnt(11)
    v_mfma_f32_32x32x16_bf16 v[16:31], v[108:111], v[140:143], v[16:31]
    buffer_load_dwordx4 v[188:191], v2, s[40:43], s53 offen offset:3072 sc1
    ds_read_b64_tr_b16 v[108:109], v10 offset:7168
    ds_read_b64_tr_b16 v[110:111], v10 offset:7680
    s_waitcnt lgkmcnt(6)
    s_waitcnt vmcnt(11)
    v_mfma_f32_32x32x16_bf16 v[16:31], v[96:99], v[144:147], v[16:31]
    s_add_u32 s53, s69, 4
    s_and_b32 s53, s53, 7
    s_lshl_b32 s53, s53, 12
    s_add_u32 s53, s53, s52
    buffer_load_dwordx4 v[192:195], v2, s[40:43], s53 offen offset:0 sc1
    ds_read_b64_tr_b16 v[96:97], v10 offset:8192
    ds_read_b64_tr_b16 v[98:99], v10 offset:8704
    s_waitcnt lgkmcnt(6)
    s_waitcnt vmcnt(11)
    v_mfma_f32_32x32x16_bf16 v[16:31], v[100:103], v[148:151], v[16:31]
    buffer_load_dwordx4 v[196:199], v2, s[40:43], s53 offen offset:1024 sc1
    ds_read_b64_tr_b16 v[100:101], v10 offset:9216
    ds_read_b64_tr_b16 v[102:103], v10 offset:9728
    s_waitcnt lgkmcnt(6)
    s_waitcnt vmcnt(11)
    v_mfma_f32_32x32x16_bf16 v[16:31], v[104:107], v[152:155], v[16:31]
    buffer_load_dwordx4 v[200:203], v2, s[40:43], s53 offen offset:2048 sc1
    ds_read_b64_tr_b16 v[104:105], v10 offset:10240
    ds_read_b64_tr_b16 v[106:107], v10 offset:10752
    s_waitcnt lgkmcnt(6)
    s_waitcnt vmcnt(11)
    v_mfma_f32_32x32x16_bf16 v[16:31], v[108:111], v[156:159], v[16:31]
    buffer_load_dwordx4 v[204:207], v2, s[40:43], s53 offen offset:3072 sc1
    ds_read_b64_tr_b16 v[108:109], v10 offset:11264
    ds_read_b64_tr_b16 v[110:111], v10 offset:11776
    s_waitcnt lgkmcnt(6)
    s_waitcnt vmcnt(11)
    v_mfma_f32_32x32x16_bf16 v[16:31], v[96:99], v[160:163], v[16:31]
    s_add_u32 s53, s69, 5
    s_and_b32 s53, s53, 7
    s_lshl_b32 s53, s53, 12
    s_add_u32 s53, s53, s52
    buffer_load_dwordx4 v[208:211], v2, s[40:43], s53 offen offset:0 sc1
    ds_read_b64_tr_b16 v[96:97], v10 offset:12288
    ds_read_b64_tr_b16 v[98:99], v10 offset:12800
    s_waitcnt lgkmcnt(6)
    s_waitcnt vmcnt(11)
    v_mfma_f32_32x32x16_bf16 v[16:31], v[100:103], v[164:167], v[16:31]
    buffer_load_dwordx4 v[212:215], v2, s[40:43], s53 offen offset:1024 sc1
    ds_read_b64_tr_b16 v[100:101], v10 offset:13312
    ds_read_b64_tr_b16 v[102:103], v10 offset:13824
    s_waitcnt lgkmcnt(6)
    s_waitcnt vmcnt(11)
    v_mfma_f32_32x32x16_bf16 v[16:31], v[104:107], v[168:171], v[16:31]
    buffer_load_dwordx4 v[216:219], v2, s[40:43], s53 offen offset:2048 sc1
    ds_read_b64_tr_b16 v[104:105], v10 offset:14336
    ds_read_b64_tr_b16 v[106:107], v10 offset:14848
    s_waitcnt lgkmcnt(6)
    s_waitcnt vmcnt(11)
    v_mfma_f32_32x32x16_bf16 v[16:31], v[108:111], v[172:175], v[16:31]
    buffer_load_dwordx4 v[220:223], v2, s[40:43], s53 offen offset:3072 sc1
    ds_read_b64_tr_b16 v[108:109], v10 offset:15360
    ds_read_b64_tr_b16 v[110:111], v10 offset:15872
    s_waitcnt lgkmcnt(6)
    s_waitcnt vmcnt(11)
    v_mfma_f32_32x32x16_bf16 v[16:31], v[96:99], v[176:179], v[16:31]
    s_add_u32 s53, s69, 6
    s_and_b32 s53, s53, 7
    s_lshl_b32 s53, s53, 12
    s_add_u32 s53, s53, s52
    buffer_load_dwordx4 v[224:227], v2, s[40:43], s53 offen offset:0 sc1
    ds_read_b64_tr_b16 v[96:97], v10 offset:16384
    ds_read_b64_tr_b16 v[98:99], v10 offset:16896
    s_waitcnt lgkmcnt(6)
    s_waitcnt vmcnt(11)
    v_mfma_f32_32x32x16_bf16 v[16:31], v[100:103], v[180:183], v[16:31]
    buffer_load_dwordx4 v[228:231], v2, s[40:43], s53 offen offset:1024 sc1
    ds_read_b64_tr_b16 v[100:101], v10 offset:17408
    ds_read_b64_tr_b16 v[102:103], v10 offset:17920
    s_waitcnt lgkmcnt(6)
    s_waitcnt vmcnt(11)
    v_mfma_f32_32x32x16_bf16 v[16:31], v[104:107], v[184:187], v[16:31]
    buffer_load_dwordx4 v[232:235], v2, s[40:43], s53 offen offset:2048 sc1
    ds_read_b64_tr_b16 v[104:105], v10 offset:18432
    ds_read_b64_tr_b16 v[106:107], v10 offset:18944
    s_waitcnt lgkmcnt(6)
    s_waitcnt vmcnt(11)
    v_mfma_f32_32x32x16_bf16 v[16:31], v[108:111], v[188:191], v[16:31]
    buffer_load_dwordx4 v[236:239], v2, s[40:43], s53 offen offset:3072 sc1
    ds_read_b64_tr_b16 v[108:109], v10 offset:19456
    ds_read_b64_tr_b16 v[110:111], v10 offset:19968
    s_waitcnt lgkmcnt(6)
    s_waitcnt vmcnt(11)
    v_mfma_f32_32x32x16_bf16 v[16:31], v[96:99], v[192:195], v[16:31]
    s_add_u32 s53, s69, 7
    s_and_b32 s53, s53, 7
    s_lshl_b32 s53, s53, 12
    s_add_u32 s53, s53, s52
    buffer_load_dwordx4 v[240:243], v2, s[40:43], s53 offen offset:0 sc1
    ds_read_b64_tr_b16 v[96:97], v10 offset:20480
    ds_read_b64_tr_b16 v[98:99], v10 offset:20992
    s_waitcnt lgkmcnt(6)
    s_waitcnt vmcnt(11)
    v_mfma_f32_32x32x16_bf16 v[16:31], v[100:103], v[196:199], v[16:31]
    buffer_load_dwordx4 v[244:247], v2, s[40:43], s53 offen offset:1024 sc1
    ds_read_b64_tr_b16 v[100:101], v10 offset:21504
    ds_read_b64_tr_b16 v[102:103], v10 offset:22016
    s_waitcnt lgkmcnt(6)
    s_waitcnt vmcnt(11)
    v_mfma_f32_32x32x16_bf16 v[16:31], v[104:107], v[200:203], v[16:31]
    buffer_load_dwordx4 v[248:251], v2, s[40:43], s53 offen offset:2048 sc1
    ds_read_b64_tr_b16 v[104:105], v10 offset:22528
    ds_read_b64_tr_b16 v[106:107], v10 offset:23040
    s_waitcnt lgkmcnt(6)
    s_waitcnt vmcnt(11)
    v_mfma_f32_32x32x16_bf16 v[16:31], v[108:111], v[204:207], v[16:31]
    buffer_load_dwordx4 v[252:255], v2, s[40:43], s53 offen offset:3072 sc1
    ds_read_b64_tr_b16 v[108:109], v10 offset:23552
    ds_read_b64_tr_b16 v[110:111], v10 offset:24064
    s_waitcnt lgkmcnt(6)
    s_waitcnt vmcnt(11)
    v_mfma_f32_32x32x16_bf16 v[16:31], v[96:99], v[208:211], v[16:31]
    ds_read_b64_tr_b16 v[96:97], v10 offset:24576
    ds_read_b64_tr_b16 v[98:99], v10 offset:25088
    s_waitcnt lgkmcnt(6)
    s_waitcnt vmcnt(10)
    v_mfma_f32_32x32x16_bf16 v[16:31], v[100:103], v[212:215], v[16:31]
    ds_read_b64_tr_b16 v[100:101], v10 offset:25600
    ds_read_b64_tr_b16 v[102:103], v10 offset:26112
    s_waitcnt lgkmcnt(6)
    s_waitcnt vmcnt(9)
    v_mfma_f32_32x32x16_bf16 v[16:31], v[104:107], v[216:219], v[16:31]
    ds_read_b64_tr_b16 v[104:105], v10 offset:26624
    ds_read_b64_tr_b16 v[106:107], v10 offset:27136
    s_waitcnt lgkmcnt(6)
    s_waitcnt vmcnt(8)
    v_mfma_f32_32x32x16_bf16 v[16:31], v[108:111], v[220:223], v[16:31]
    ds_read_b64_tr_b16 v[108:109], v10 offset:27648
    ds_read_b64_tr_b16 v[110:111], v10 offset:28160
    s_waitcnt lgkmcnt(6)
    s_waitcnt vmcnt(7)
    v_mfma_f32_32x32x16_bf16 v[16:31], v[96:99], v[224:227], v[16:31]
    ds_read_b64_tr_b16 v[96:97], v10 offset:28672
    ds_read_b64_tr_b16 v[98:99], v10 offset:29184
    s_waitcnt lgkmcnt(6)
    s_waitcnt vmcnt(6)
    v_mfma_f32_32x32x16_bf16 v[16:31], v[100:103], v[228:231], v[16:31]
    ds_read_b64_tr_b16 v[100:101], v10 offset:29696
    ds_read_b64_tr_b16 v[102:103], v10 offset:30208
    s_waitcnt lgkmcnt(6)
    s_waitcnt vmcnt(5)
    v_mfma_f32_32x32x16_bf16 v[16:31], v[104:107], v[232:235], v[16:31]
    ds_read_b64_tr_b16 v[104:105], v10 offset:30720
    ds_read_b64_tr_b16 v[106:107], v10 offset:31232
    s_waitcnt lgkmcnt(6)
    s_waitcnt vmcnt(4)
    v_mfma_f32_32x32x16_bf16 v[16:31], v[108:111], v[236:239], v[16:31]
    ds_read_b64_tr_b16 v[108:109], v10 offset:31744
    ds_read_b64_tr_b16 v[110:111], v10 offset:32256
    s_waitcnt lgkmcnt(0)
    s_barrier
    ds_read_b128 v[48:51], v5 offset:0
    ds_read_b128 v[52:55], v5 offset:32
    ds_read_b128 v[56:59], v5 offset:64
    ds_read_b128 v[60:63], v5 offset:96
    ds_read_b128 v[64:67], v5 offset:128
    ds_read_b128 v[68:71], v5 offset:160
    ds_read_b128 v[72:75], v5 offset:192
    ds_read_b128 v[76:79], v5 offset:224
    s_waitcnt vmcnt(3)
    v_mfma_f32_32x32x16_bf16 v[16:31], v[96:99], v[240:243], v[16:31]
    s_waitcnt vmcnt(2)
    v_mfma_f32_32x32x16_bf16 v[16:31], v[100:103], v[244:247], v[16:31]
    s_waitcnt vmcnt(1)
    v_mfma_f32_32x32x16_bf16 v[16:31], v[104:107], v[248:251], v[16:31]
    s_waitcnt vmcnt(0)
    v_mfma_f32_32x32x16_bf16 v[16:31], v[108:111], v[252:255], v[16:31]
    s_waitcnt lgkmcnt(4)
    s_nop 10
    v_fmac_f32 v80, v16, v48
    v_fmac_f32 v81, v17, v49
    v_fmac_f32 v82, v18, v50
    v_fmac_f32 v83, v19, v51
    v_fmac_f32 v84, v20, v52
    v_fmac_f32 v85, v21, v53
    v_fmac_f32 v86, v22, v54
    v_fmac_f32 v87, v23, v55
    v_fmac_f32 v88, v24, v56
    v_fmac_f32 v89, v25, v57
    v_fmac_f32 v90, v26, v58
    v_fmac_f32 v91, v27, v59
    v_fmac_f32 v92, v28, v60
    v_fmac_f32 v93, v29, v61
    v_fmac_f32 v94, v30, v62
    v_fmac_f32 v95, v31, v63
    s_waitcnt lgkmcnt(0)
    v_mul_f32 v16, v80, v64
    v_mul_f32 v17, v81, v65
    v_mul_f32 v18, v82, v66
    v_mul_f32 v19, v83, v67
    v_mul_f32 v20, v84, v68
    v_mul_f32 v21, v85, v69
    v_mul_f32 v22, v86, v70
    v_mul_f32 v23, v87, v71
    v_mul_f32 v24, v88, v72
    v_mul_f32 v25, v89, v73
    v_mul_f32 v26, v90, v74
    v_mul_f32 v27, v91, v75
    v_mul_f32 v28, v92, v76
    v_mul_f32 v29, v93, v77
    v_mul_f32 v30, v94, v78
    v_mul_f32 v31, v95, v79
    v_cvt_pk_bf16_f32 v32, v16, v17
    v_cvt_pk_bf16_f32 v33, v18, v19
    v_cvt_pk_bf16_f32 v34, v20, v21
    v_cvt_pk_bf16_f32 v35, v22, v23
    v_cvt_pk_bf16_f32 v36, v24, v25
    v_cvt_pk_bf16_f32 v37, v26, v27
    v_cvt_pk_bf16_f32 v38, v28, v29
    v_cvt_pk_bf16_f32 v39, v30, v31
    buffer_store_dwordx4 v[32:35], v2, s[40:43], s58 offen sc1
    buffer_store_dwordx4 v[36:39], v2, s[40:43], s58 offen offset:1024 sc1
    v_pk_add_f32 v[48:49], v[80:81], v[82:83]
    v_pk_mul_f32 v[50:51], v[80:81], v[80:81]
    v_pk_fma_f32 v[50:51], v[82:83], v[82:83], v[50:51]
    v_pk_add_f32 v[48:49], v[48:49], v[84:85]
    v_pk_fma_f32 v[50:51], v[84:85], v[84:85], v[50:51]
    v_pk_add_f32 v[48:49], v[48:49], v[86:87]
    v_pk_fma_f32 v[50:51], v[86:87], v[86:87], v[50:51]
    v_pk_add_f32 v[48:49], v[48:49], v[88:89]
    v_pk_fma_f32 v[50:51], v[88:89], v[88:89], v[50:51]
    v_pk_add_f32 v[48:49], v[48:49], v[90:91]
    v_pk_fma_f32 v[50:51], v[90:91], v[90:91], v[50:51]
    v_pk_add_f32 v[48:49], v[48:49], v[92:93]
    v_pk_fma_f32 v[50:51], v[92:93], v[92:93], v[50:51]
    v_pk_add_f32 v[48:49], v[48:49], v[94:95]
    v_pk_fma_f32 v[50:51], v[94:95], v[94:95], v[50:51]
    v_add_f32 v48, v48, v49
    v_add_f32 v49, v50, v51
    v_cvt_pk_bf16_f32 v40, v80, v81
    v_cvt_pk_bf16_f32 v41, v82, v83
    v_cvt_pk_bf16_f32 v42, v84, v85
    v_cvt_pk_bf16_f32 v43, v86, v87
    v_cvt_pk_bf16_f32 v44, v88, v89
    v_cvt_pk_bf16_f32 v45, v90, v91
    v_cvt_pk_bf16_f32 v46, v92, v93
    v_cvt_pk_bf16_f32 v47, v94, v95
    v_permlane32_swap_b32 v48, v49
    v_add_f32 v48, v48, v49
    buffer_store_dword v48, v6, s[40:43], s54 offen sc1
    buffer_store_dwordx4 v[40:43], v2, s[40:43], s57 offen sc1
    buffer_store_dwordx4 v[44:47], v2, s[40:43], s57 offen offset:1024 sc1
    v_bfe_u32 v10, v0, 2, 2
    v_bfe_u32 v11, v0, 5, 1
    v_lshl_add_u32 v10, v11, 2, v10
    v_lshlrev_b32 v10, 6, v10
    v_bfe_u32 v11, v0, 4, 1
    v_lshl_add_u32 v10, v11, 5, v10
    v_and_b32 v11, 3, v0
    v_lshl_add_u32 v10, v11, 3, v10
    v_add_u32 v10, 32768, v10
    v_add_u32 v11, 0x8000, v10
    v_add_u32 v12, 0x10000, v10
    v_add_u32 v13, 0x18000, v10
    v_bfe_u32 v4, v0, 2, 1
    v_bfe_u32 v7, v0, 4, 1
    v_lshl_add_u32 v4, v7, 1, v4
    v_bfe_u32 v7, v0, 3, 1
    v_lshl_add_u32 v4, v7, 2, v4
    v_bfe_u32 v7, v0, 5, 1
    v_lshl_add_u32 v4, v7, 4, v4
    v_lshlrev_b32 v4, 5, v4
    v_and_b32 v7, 3, v0
    v_lshl_add_u32 v4, v7, 3, v4
    v_add_u32 v4, 32768, v4
    v_add_u32 v7, 0x8000, v4
    v_add_u32 v14, 0x10000, v4
    v_add_u32 v15, 0x18000, v4
    v_and_b32 v8, 16, v0
    v_cmp_eq_u32 vcc, 0, v8
    v_mov_b32 v8, 0xeeeeeeee
    v_mov_b32 v5, 0x44444444
    v_cndmask_b32 v8, v8, v5, vcc
    v_mov_b32 v16, 0
    v_mov_b32 v17, 0
    v_mov_b32 v18, 0
    v_mov_b32 v19, 0
    v_mov_b32 v20, 0
    v_mov_b32 v21, 0
    v_mov_b32 v22, 0
    v_mov_b32 v23, 0
    v_mov_b32 v24, 0
    v_mov_b32 v25, 0
    v_mov_b32 v26, 0
    v_mov_b32 v27, 0
    v_mov_b32 v28, 0
    v_mov_b32 v29, 0
    v_mov_b32 v30, 0
    v_mov_b32 v31, 0
    v_mov_b32 v32, 0
    v_mov_b32 v33, 0
    v_mov_b32 v34, 0
    v_mov_b32 v35, 0
    v_mov_b32 v36, 0
    v_mov_b32 v37, 0
    v_mov_b32 v38, 0
    v_mov_b32 v39, 0
    v_mov_b32 v40, 0
    v_mov_b32 v41, 0
    v_mov_b32 v42, 0
    v_mov_b32 v43, 0
    v_mov_b32 v44, 0
    v_mov_b32 v45, 0
    v_mov_b32 v46, 0
    v_mov_b32 v47, 0
    v_mov_b32 v48, 0
    v_mov_b32 v49, 0
    v_mov_b32 v50, 0
    v_mov_b32 v51, 0
    v_mov_b32 v52, 0
    v_mov_b32 v53, 0
    v_mov_b32 v54, 0
    v_mov_b32 v55, 0
    v_mov_b32 v56, 0
    v_mov_b32 v57, 0
    v_mov_b32 v58, 0
    v_mov_b32 v59, 0
    v_mov_b32 v60, 0
    v_mov_b32 v61, 0
    v_mov_b32 v62, 0
    v_mov_b32 v63, 0
    v_mov_b32 v64, 0
    v_mov_b32 v65, 0
    v_mov_b32 v66, 0
    v_mov_b32 v67, 0
    v_mov_b32 v68, 0
    v_mov_b32 v69, 0
    v_mov_b32 v70, 0
    v_mov_b32 v71, 0
    v_mov_b32 v72, 0
    v_mov_b32 v73, 0
    v_mov_b32 v74, 0
    v_mov_b32 v75, 0
    v_mov_b32 v76, 0
    v_mov_b32 v77, 0
    v_mov_b32 v78, 0
    v_mov_b32 v79, 0
    v_lshrrev_b32 v5, 3, v1
    v_lshlrev_b32 v5, 5, v5
    v_and_or_b32 v5, v1, 7, v5
    v_lshlrev_b32 v5, 2, v5
    s_waitcnt vmcnt(0)
    v_mov_b32 v9, s47
    s_mov_b64 exec, 1
    s_cmp_lg_u32 s66, 0
    s_cbranch_scc1 Lfl12
    buffer_store_dword v9, v3, s[40:43], s56 offen sc1
    s_mov_b64 exec, -1
    s_sleep 16
    s_branch Lfl12d
Lfl12:
    buffer_store_dword v9, v3, s[40:43], s56 offen
    s_mov_b64 exec, -1
Lfl12d:
    s_mov_b64 exec, 0xffff
    s_mov_b32 s50, 20000
    s_sleep 2
Lpoll13:
    buffer_load_dword v125, v5, s[40:43], s55 offen sc1
    s_waitcnt vmcnt(0)
    v_cmp_ne_u32 vcc, s47, v125
    s_sub_u32 s50, s50, 1
    s_cbranch_vccz Lpolld13
    s_cmp_lg_u32 s50, 0
    s_cbranch_scc1 Lpoll13
Lpolld13:
    s_mov_b64 exec, -1
    s_lshl_b32 s52, s67, 15
    s_add_u32 s52, s52, 0xc00000
    s_lshl_b32 s54, s67, 8
    s_add_u32 s54, s54, 0x10000
    s_add_u32 s53, s69, 0
    s_and_b32 s53, s53, 7
    s_lshl_b32 s53, s53, 12
    s_add_u32 s53, s53, s52
    buffer_load_dwordx4 v[128:131], v2, s[40:43], s53 offen offset:0 sc1
    buffer_load_dwordx4 v[132:135], v2, s[40:43], s53 offen offset:1024 sc1
    buffer_load_dwordx4 v[136:139], v2, s[40:43], s53 offen offset:2048 sc1
    buffer_load_dwordx4 v[140:143], v2, s[40:43], s53 offen offset:3072 sc1
    buffer_load_dword v240, v6, s[40:43], s54 offen sc1
    s_add_u32 s54, s54, 16384
    buffer_load_dword v241, v6, s[40:43], s54 offen sc1
    s_add_u32 s54, s54, 16384
    buffer_load_dword v242, v6, s[40:43], s54 offen sc1
    s_add_u32 s54, s54, 16384
    buffer_load_dword v243, v6, s[40:43], s54 offen sc1
    s_add_u32 s54, s54, 16384
    buffer_load_dword v244, v6, s[40:43], s54 offen sc1
    s_add_u32 s54, s54, 16384
    buffer_load_dword v245, v6, s[40:43], s54 offen sc1
    s_add_u32 s54, s54, 16384
    buffer_load_dword v246, v6, s[40:43], s54 offen sc1
    s_add_u32 s54, s54, 16384
    buffer_load_dword v247, v6, s[40:43], s54 offen sc1
    s_add_u32 s54, s54, 16384
    buffer_load_dword v248, v6, s[40:43], s54 offen sc1
    s_add_u32 s54, s54, 16384
    buffer_load_dword v249, v6, s[40:43], s54 offen sc1
    s_add_u32 s54, s54, 16384
    buffer_load_dword v250, v6, s[40:43], s54 offen sc1
    s_add_u32 s54, s54, 16384
    buffer_load_dword v251, v6, s[40:43], s54 offen sc1
    s_add_u32 s54, s54, 16384
    buffer_load_dword v252, v6, s[40:43], s54 offen sc1
    s_add_u32 s54, s54, 16384
    buffer_load_dword v253, v6, s[40:43], s54 offen sc1
    s_add_u32 s54, s54, 16384
    buffer_load_dword v254, v6, s[40:43], s54 offen sc1
    s_add_u32 s54, s54, 16384
    buffer_load_dword v255, v6, s[40:43], s54 offen sc1
    s_add_u32 s54, s54, 16384
    s_add_u32 s53, s69, 1
    s_and_b32 s53, s53, 7
    s_lshl_b32 s53, s53, 12
    s_add_u32 s53, s53, s52
    buffer_load_dwordx4 v[144:147], v2, s[40:43], s53 offen offset:0 sc1
    buffer_load_dwordx4 v[148:151], v2, s[40:43], s53 offen offset:1024 sc1
    buffer_load_dwordx4 v[152:155], v2, s[40:43], s53 offen offset:2048 sc1
    buffer_load_dwordx4 v[156:159], v2, s[40:43], s53 offen offset:3072 sc1
    s_add_u32 s53, s69, 2
    s_and_b32 s53, s53, 7
    s_lshl_b32 s53, s53, 12
    s_add_u32 s53, s53, s52
    buffer_load_dwordx4 v[160:163], v2, s[40:43], s53 offen offset:0 sc1
    buffer_load_dwordx4 v[164:167], v2, s[40:43], s53 offen offset:1024 sc1
    buffer_load_dwordx4 v[168:171], v2, s[40:43], s53 offen offset:2048 sc1
    buffer_load_dwordx4 v[172:175], v2, s[40:43], s53 offen offset:3072 sc1
    ds_read_b64_tr_b16 v[80:81], v10 offset:0
    ds_read_b64_tr_b16 v[82:83], v10 offset:512
    ds_read_b64_tr_b16 v[84:85], v10 offset:1024
    ds_read_b64_tr_b16 v[86:87], v10 offset:1536
    ds_read_b64_tr_b16 v[88:89], v10 offset:2048
    ds_read_b64_tr_b16 v[90:91], v10 offset:2560
    ds_read_b64_tr_b16 v[92:93], v10 offset:3072
    ds_read_b64_tr_b16 v[94:95], v10 offset:3584
    ds_read_b64_tr_b16 v[96:97], v10 offset:4096
    ds_read_b64_tr_b16 v[98:99], v10 offset:4608
    ds_read_b64_tr_b16 v[100:101], v10 offset:5120
    ds_read_b64_tr_b16 v[102:103], v10 offset:5632
    s_waitcnt lgkmcnt(6)
    s_waitcnt vmcnt(27)
    v_mfma_f32_32x32x16_bf16 v[16:31], v[80:83], v[128:131], v[16:31]
    ds_read_b64_tr_b16 v[116:117], v4 offset:6144
    ds_read_b64_tr_b16 v[118:119], v4 offset:6400
    ds_read_b64_tr_b16 v[104:105], v10 offset:7168
    v_mfma_f32_32x32x16_bf16 v[32:47], v[84:87], v[128:131], v[32:47]
    ds_read_b64_tr_b16 v[106:107], v10 offset:7680
    ds_read_b64_tr_b16 v[108:109], v10 offset:8192
    ds_read_b64_tr_b16 v[110:111], v10 offset:8704
    s_add_u32 s53, s69, 3
    s_and_b32 s53, s53, 7
    s_lshl_b32 s53, s53, 12
    s_add_u32 s53, s53, s52
    buffer_load_dwordx4 v[176:179], v2, s[40:43], s53 offen offset:0 sc1
    v_mfma_f32_32x32x16_bf16 v[48:63], v[88:91], v[128:131], v[48:63]
    ds_read_b64_tr_b16 v[112:113], v10 offset:9216
    ds_read_b64_tr_b16 v[114:115], v10 offset:9728
    buffer_load_dwordx4 v[180:183], v2, s[40:43], s53 offen offset:1024 sc1
    s_waitcnt lgkmcnt(8)
    s_waitcnt vmcnt(28)
    v_mfma_f32_32x32x16_bf16 v[16:31], v[92:95], v[132:135], v[16:31]
    ds_read_b64_tr_b16 v[80:81], v10 offset:10240
    ds_read_b64_tr_b16 v[82:83], v10 offset:10752
    ds_read_b64_tr_b16 v[84:85], v10 offset:11264
    v_mfma_f32_32x32x16_bf16 v[32:47], v[96:99], v[132:135], v[32:47]
    ds_read_b64_tr_b16 v[86:87], v10 offset:11776
    ds_read_b64_tr_b16 v[88:89], v10 offset:12288
    ds_read_b64_tr_b16 v[90:91], v10 offset:12800
    buffer_load_dwordx4 v[184:187], v2, s[40:43], s53 offen offset:2048 sc1
    v_mfma_f32_32x32x16_bf16 v[48:63], v[100:103], v[132:135], v[48:63]
    buffer_load_dwordx4 v[188:191], v2, s[40:43], s53 offen offset:3072 sc1
    s_waitcnt lgkmcnt(12)
    v_smfmac_f32_32x32x32_bf16 v[64:79], v[116:119], v[128:135], v8
    s_waitcnt lgkmcnt(6)
    s_waitcnt vmcnt(29)
    v_mfma_f32_32x32x16_bf16 v[16:31], v[104:107], v[136:139], v[16:31]
    ds_read_b64_tr_b16 v[120:121], v4 offset:13312
    ds_read_b64_tr_b16 v[122:123], v4 offset:13568
    ds_read_b64_tr_b16 v[92:93], v10 offset:14336
    v_mfma_f32_32x32x16_bf16 v[32:47], v[108:111], v[136:139], v[32:47]
    ds_read_b64_tr_b16 v[94:95], v10 offset:14848
    ds_read_b64_tr_b16 v[96:97], v10 offset:15360
    ds_read_b64_tr_b16 v[98:99], v10 offset:15872
    s_add_u32 s53, s69, 4
    s_and_b32 s53, s53, 7
    s_lshl_b32 s53, s53, 12
    s_add_u32 s53, s53, s52
    buffer_load_dwordx4 v[192:195], v2, s[40:43], s53 offen offset:0 sc1
    v_mfma_f32_32x32x16_bf16 v[48:63], v[112:115], v[136:139], v[48:63]
    ds_read_b64_tr_b16 v[100:101], v10 offset:16384
    ds_read_b64_tr_b16 v[102:103], v10 offset:16896
    buffer_load_dwordx4 v[196:199], v2, s[40:43], s53 offen offset:1024 sc1
    s_waitcnt lgkmcnt(8)
    s_waitcnt vmcnt(30)
    v_mfma_f32_32x32x16_bf16 v[16:31], v[80:83], v[140:143], v[16:31]
    ds_read_b64_tr_b16 v[104:105], v10 offset:17408
    ds_read_b64_tr_b16 v[106:107], v10 offset:17920
    ds_read_b64_tr_b16 v[108:109], v10 offset:18432
    v_mfma_f32_32x32x16_bf16 v[32:47], v[84:87], v[140:143], v[32:47]
    ds_read_b64_tr_b16 v[110:111], v10 offset:18944
    ds_read_b64_tr_b16 v[112:113], v10 offset:19456
    ds_read_b64_tr_b16 v[114:115], v10 offset:19968
    buffer_load_dwordx4 v[200:203], v2, s[40:43], s53 offen offset:2048 sc1
    v_mfma_f32_32x32x16_bf16 v[48:63], v[88:91], v[140:143], v[48:63]
    buffer_load_dwordx4 v[204:207], v2, s[40:43], s53 offen offset:3072 sc1
    s_waitcnt lgkmcnt(12)
    v_smfmac_f32_32x32x32_bf16 v[64:79], v[120:123], v[136:143], v8
    s_waitcnt lgkmcnt(6)
    s_waitcnt vmcnt(15)
    v_mfma_f32_32x32x16_bf16 v[16:31], v[92:95], v[144:147], v[16:31]
    ds_read_b64_tr_b16 v[116:117], v4 offset:20480
    ds_read_b64_tr_b16 v[118:119], v4 offset:20736
    ds_read_b64_tr_b16 v[80:81], v10 offset:21504
    v_add_f32 v240, v240, v248
    v_add_f32 v241, v241, v249
    v_add_f32 v242, v242, v250
    v_mfma_f32_32x32x16_bf16 v[32:47], v[96:99], v[144:147], v[32:47]
    ds_read_b64_tr_b16 v[82:83], v10 offset:22016
    ds_read_b64_tr_b16 v[84:85], v10 offset:22528
    ds_read_b64_tr_b16 v[86:87], v10 offset:23040
    s_add_u32 s53, s69, 5
    s_and_b32 s53, s53, 7
    s_lshl_b32 s53, s53, 12
    s_add_u32 s53, s53, s52
    buffer_load_dwordx4 v[208:211], v2, s[40:43], s53 offen offset:0 sc1
    v_add_f32 v243, v243, v251
    v_add_f32 v244, v244, v252
    v_add_f32 v245, v245, v253
    v_mfma_f32_32x32x16_bf16 v[48:63], v[100:103], v[144:147], v[48:63]
    ds_read_b64_tr_b16 v[88:89], v10 offset:23552
    ds_read_b64_tr_b16 v[90:91], v10 offset:24064
    buffer_load_dwordx4 v[212:215], v2, s[40:43], s53 offen offset:1024 sc1
    v_add_f32 v246, v246, v254
    v_add_f32 v247, v247, v255
    s_waitcnt lgkmcnt(8)
    s_waitcnt vmcnt(16)
    v_mfma_f32_32x32x16_bf16 v[16:31], v[104:107], v[148:151], v[16:31]
    ds_read_b64_tr_b16 v[92:93], v10 offset:24576
    ds_read_b64_tr_b16 v[94:95], v10 offset:25088
    ds_read_b64_tr_b16 v[96:97], v10 offset:25600
    v_add_f32 v240, v240, v244
    v_add_f32 v241, v241, v245
    v_add_f32 v242, v242, v246
    v_add_f32 v243, v243, v247
    v_mfma_f32_32x32x16_bf16 v[32:47], v[108:111], v[148:151], v[32:47]
    ds_read_b64_tr_b16 v[98:99], v10 offset:26112
    ds_read_b64_tr_b16 v[100:101], v10 offset:26624
    ds_read_b64_tr_b16 v[102:103], v10 offset:27136
    buffer_load_dwordx4 v[216:219], v2, s[40:43], s53 offen offset:2048 sc1
    v_add_f32 v240, v240, v242
    v_add_f32 v241, v241, v243
    v_mfma_f32_32x32x16_bf16 v[48:63], v[112:115], v[148:151], v[48:63]
    buffer_load_dwordx4 v[220:223], v2, s[40:43], s53 offen offset:3072 sc1
    v_add_f32 v124, v240, v241
    s_waitcnt lgkmcnt(12)
    v_smfmac_f32_32x32x32_bf16 v[64:79], v[116:119], v[144:151], v8
    s_waitcnt lgkmcnt(6)
    s_waitcnt vmcnt(17)
    v_mfma_f32_32x32x16_bf16 v[16:31], v[80:83], v[152:155], v[16:31]
    ds_read_b64_tr_b16 v[120:121], v4 offset:27648
    ds_read_b64_tr_b16 v[122:123], v4 offset:27904
    ds_read_b64_tr_b16 v[104:105], v10 offset:28672
    v_mov_b32 v125, v124
    v_bfe_u32 v5, v1, 5, 1
    v_lshlrev_b32 v9, 7, v5
    v_permlane32_swap_b32 v124, v125
    v_mfma_f32_32x32x16_bf16 v[32:47], v[84:87], v[152:155], v[32:47]
    ds_read_b64_tr_b16 v[106:107], v10 offset:29184
    ds_read_b64_tr_b16 v[108:109], v10 offset:29696
    ds_read_b64_tr_b16 v[110:111], v10 offset:30208
    s_add_u32 s53, s69, 6
    s_and_b32 s53, s53, 7
    s_lshl_b32 s53, s53, 12
    s_add_u32 s53, s53, s52
    buffer_load_dwordx4 v[224:227], v2, s[40:43], s53 offen offset:0 sc1
    v_add_u32 v9, 160768, v9
    v_mul_f32 v124, 0x3b000000, v124
    v_mul_f32 v125, 0x3b000000, v125
    v_fma_f32 v125, -v124, v124, v125
    v_mfma_f32_32x32x16_bf16 v[48:63], v[88:91], v[152:155], v[48:63]
    ds_read_b64_tr_b16 v[112:113], v10 offset:30720
    ds_read_b64_tr_b16 v[114:115], v10 offset:31232
    buffer_load_dwordx4 v[228:231], v2, s[40:43], s53 offen offset:1024 sc1
    v_max_f32 v125, 0, v125
    v_add_f32 v125, 0x3727c5ac, v125
    v_rsq_f32 v125, v125
    s_waitcnt lgkmcnt(8)
    s_waitcnt vmcnt(18)
    v_mfma_f32_32x32x16_bf16 v[16:31], v[92:95], v[156:159], v[16:31]
    ds_read_b64_tr_b16 v[80:81], v10 offset:31744
    ds_read_b64_tr_b16 v[82:83], v10 offset:32256
    ds_read_b64_tr_b16 v[84:85], v10 offset:32768
    v_mul_f32 v5, 0xbfb8aa3b, v125
    v_mul_f32 v125, v5, v124
    v_sub_f32 v125, 0, v125
    v_mov_b32 v124, v5
    v_mfma_f32_32x32x16_bf16 v[32:47], v[96:99], v[156:159], v[32:47]
    ds_read_b64_tr_b16 v[86:87], v10 offset:33280
    ds_read_b64_tr_b16 v[88:89], v10 offset:33792
    ds_read_b64_tr_b16 v[90:91], v10 offset:34304
    buffer_load_dwordx4 v[232:235], v2, s[40:43], s53 offen offset:2048 sc1
    s_lshl_b32 s55, s67, 4
    s_add_u32 s55, s55, s46
    s_lshr_b32 s50, s55, 3
    s_lshl_b32 s50, s50, 7
    s_and_b32 s56, s55, 7
    v_mfma_f32_32x32x16_bf16 v[48:63], v[100:103], v[156:159], v[48:63]
    buffer_load_dwordx4 v[236:239], v2, s[40:43], s53 offen offset:3072 sc1
    s_lshl_b32 s56, s56, 2
    s_add_u32 s56, s56, s50
    s_add_u32 s56, s56, 0xe0000
    s_waitcnt lgkmcnt(12)
    v_smfmac_f32_32x32x32_bf16 v[64:79], v[120:123], v[152:159], v8
    s_waitcnt lgkmcnt(6)
    s_waitcnt vmcnt(19)
    v_mfma_f32_32x32x16_bf16 v[16:31], v[104:107], v[160:163], v[16:31]
    ds_read_b64_tr_b16 v[116:117], v7 offset:2048
    ds_read_b64_tr_b16 v[118:119], v7 offset:2304
    ds_read_b64_tr_b16 v[92:93], v11 offset:3072
    v_mfma_f32_32x32x16_bf16 v[32:47], v[108:111], v[160:163], v[32:47]
    ds_read_b64_tr_b16 v[94:95], v11 offset:3584
    ds_read_b64_tr_b16 v[96:97], v11 offset:4096
    ds_read_b64_tr_b16 v[98:99], v11 offset:4608
    s_add_u32 s53, s69, 7
    s_and_b32 s53, s53, 7
    s_lshl_b32 s53, s53, 12
    s_add_u32 s53, s53, s52
    buffer_load_dwordx4 v[240:243], v2, s[40:43], s53 offen offset:0 sc1
    v_mfma_f32_32x32x16_bf16 v[48:63], v[112:115], v[160:163], v[48:63]
    ds_read_b64_tr_b16 v[100:101], v11 offset:5120
    ds_read_b64_tr_b16 v[102:103], v11 offset:5632
    buffer_load_dwordx4 v[244:247], v2, s[40:43], s53 offen offset:1024 sc1
    s_waitcnt lgkmcnt(8)
    s_waitcnt vmcnt(20)
    v_mfma_f32_32x32x16_bf16 v[16:31], v[80:83], v[164:167], v[16:31]
    ds_read_b64_tr_b16 v[104:105], v11 offset:6144
    ds_read_b64_tr_b16 v[106:107], v11 offset:6656
    ds_read_b64_tr_b16 v[108:109], v11 offset:7168
    v_mfma_f32_32x32x16_bf16 v[32:47], v[84:87], v[164:167], v[32:47]
    ds_read_b64_tr_b16 v[110:111], v11 offset:7680
    ds_read_b64_tr_b16 v[112:113], v11 offset:8192
    ds_read_b64_tr_b16 v[114:115], v11 offset:8704
    buffer_load_dwordx4 v[248:251], v2, s[40:43], s53 offen offset:2048 sc1
    v_mfma_f32_32x32x16_bf16 v[48:63], v[88:91], v[164:167], v[48:63]
    buffer_load_dwordx4 v[252:255], v2, s[40:43], s53 offen offset:3072 sc1
    s_waitcnt lgkmcnt(12)
    v_smfmac_f32_32x32x32_bf16 v[64:79], v[116:119], v[160:167], v8
    s_mov_b64 exec, 1
    ds_add_u32 v126, v127 offset:16
    s_mov_b64 exec, -1
    s_waitcnt lgkmcnt(7)
    s_waitcnt vmcnt(21)
    v_mfma_f32_32x32x16_bf16 v[16:31], v[92:95], v[168:171], v[16:31]
    ds_read_b64_tr_b16 v[120:121], v7 offset:9216
    ds_read_b64_tr_b16 v[122:123], v7 offset:9472
    ds_read_b64_tr_b16 v[80:81], v11 offset:10240
    v_mfma_f32_32x32x16_bf16 v[32:47], v[96:99], v[168:171], v[32:47]
    ds_read_b64_tr_b16 v[82:83], v11 offset:10752
    ds_read_b64_tr_b16 v[84:85], v11 offset:11264
    ds_read_b64_tr_b16 v[86:87], v11 offset:11776
    v_mfma_f32_32x32x16_bf16 v[48:63], v[100:103], v[168:171], v[48:63]
    ds_read_b64_tr_b16 v[88:89], v11 offset:12288
    ds_read_b64_tr_b16 v[90:91], v11 offset:12800
    s_waitcnt lgkmcnt(9)
    s_waitcnt vmcnt(20)
    v_mfma_f32_32x32x16_bf16 v[16:31], v[104:107], v[172:175], v[16:31]
    ds_read_b64_tr_b16 v[92:93], v11 offset:13312
    ds_read_b64_tr_b16 v[94:95], v11 offset:13824
    ds_read_b64_tr_b16 v[96:97], v11 offset:14336
    v_mfma_f32_32x32x16_bf16 v[32:47], v[108:111], v[172:175], v[32:47]
    ds_read_b64_tr_b16 v[98:99], v11 offset:14848
    ds_read_b64_tr_b16 v[100:101], v11 offset:15360
    ds_read_b64_tr_b16 v[102:103], v11 offset:15872
    v_mfma_f32_32x32x16_bf16 v[48:63], v[112:115], v[172:175], v[48:63]
    s_waitcnt lgkmcnt(12)
    v_smfmac_f32_32x32x32_bf16 v[64:79], v[120:123], v[168:175], v8
    s_waitcnt lgkmcnt(6)
    s_waitcnt vmcnt(19)
    v_mfma_f32_32x32x16_bf16 v[16:31], v[80:83], v[176:179], v[16:31]
    ds_read_b64_tr_b16 v[116:117], v7 offset:16384
    ds_read_b64_tr_b16 v[118:119], v7 offset:16640
    ds_read_b64_tr_b16 v[104:105], v11 offset:17408
    s_mul_i32 s52, s67, 114688
    s_mul_i32 s53, s46, 7168
    s_add_u32 s52, s52, s53
    s_add_u32 s52, s52, 0xe00000
    v_mfma_f32_32x32x16_bf16 v[32:47], v[84:87], v[176:179], v[32:47]
    ds_read_b64_tr_b16 v[106:107], v11 offset:17920
    ds_read_b64_tr_b16 v[108:109], v11 offset:18432
    ds_read_b64_tr_b16 v[110:111], v11 offset:18944
    v_mfma_f32_32x32x16_bf16 v[48:63], v[88:91], v[176:179], v[48:63]
    ds_read_b64_tr_b16 v[112:113], v11 offset:19456
    ds_read_b64_tr_b16 v[114:115], v11 offset:19968
    s_waitcnt lgkmcnt(8)
    s_waitcnt vmcnt(18)
    v_mfma_f32_32x32x16_bf16 v[16:31], v[92:95], v[180:183], v[16:31]
    ds_read_b64_tr_b16 v[80:81], v11 offset:20480
    ds_read_b64_tr_b16 v[82:83], v11 offset:20992
    ds_read_b64_tr_b16 v[84:85], v11 offset:21504
    v_mfma_f32_32x32x16_bf16 v[32:47], v[96:99], v[180:183], v[32:47]
    ds_read_b64_tr_b16 v[86:87], v11 offset:22016
    ds_read_b64_tr_b16 v[88:89], v11 offset:22528
    ds_read_b64_tr_b16 v[90:91], v11 offset:23040
    v_mfma_f32_32x32x16_bf16 v[48:63], v[100:103], v[180:183], v[48:63]
    ds_read_b32 v5, v126 offset:40
    s_waitcnt lgkmcnt(13)
    v_smfmac_f32_32x32x32_bf16 v[64:79], v[116:119], v[176:183], v8
    s_waitcnt lgkmcnt(7)
    s_waitcnt vmcnt(17)
    v_mfma_f32_32x32x16_bf16 v[16:31], v[104:107], v[184:187], v[16:31]
    ds_read_b64_tr_b16 v[120:121], v7 offset:23552
    ds_read_b64_tr_b16 v[122:123], v7 offset:23808
    ds_read_b64_tr_b16 v[92:93], v11 offset:24576
    v_mfma_f32_32x32x16_bf16 v[32:47], v[108:111], v[184:187], v[32:47]
    ds_read_b64_tr_b16 v[94:95], v11 offset:25088
    ds_read_b64_tr_b16 v[96:97], v11 offset:25600
    ds_read_b64_tr_b16 v[98:99], v11 offset:26112
    v_mfma_f32_32x32x16_bf16 v[48:63], v[112:115], v[184:187], v[48:63]
    ds_read_b64_tr_b16 v[100:101], v11 offset:26624
    ds_read_b64_tr_b16 v[102:103], v11 offset:27136
    s_waitcnt lgkmcnt(9)
    s_waitcnt vmcnt(16)
    v_mfma_f32_32x32x16_bf16 v[16:31], v[80:83], v[188:191], v[16:31]
    ds_read_b64_tr_b16 v[104:105], v11 offset:27648
    ds_read_b64_tr_b16 v[106:107], v11 offset:28160
    ds_read_b64_tr_b16 v[108:109], v11 offset:28672
    v_mfma_f32_32x32x16_bf16 v[32:47], v[84:87], v[188:191], v[32:47]
    ds_read_b64_tr_b16 v[110:111], v11 offset:29184
    ds_read_b64_tr_b16 v[112:113], v11 offset:29696
    ds_read_b64_tr_b16 v[114:115], v11 offset:30208
    s_waitcnt lgkmcnt(14)
    v_readfirstlane_b32 s50, v5
    s_nop 0
    s_cmp_eq_u32 s50, 4
    s_cbranch_scc1 Law14d
    s_mov_b32 s63, 400000
Law14:
    ds_read_b32 v5, v126 offset:40
    s_sub_u32 s63, s63, 1
    s_waitcnt lgkmcnt(0)
    v_readfirstlane_b32 s50, v5
    s_nop 0
    s_cmp_eq_u32 s50, 4
    s_cbranch_scc1 Law14d
    s_sleep 1
    s_cmp_lg_u32 s63, 0
    s_cbranch_scc1 Law14
Law14d:
    v_mfma_f32_32x32x16_bf16 v[48:63], v[88:91], v[188:191], v[48:63]
    s_waitcnt lgkmcnt(12)
    v_smfmac_f32_32x32x32_bf16 v[64:79], v[120:123], v[184:191], v8
    s_waitcnt lgkmcnt(6)
    s_waitcnt vmcnt(15)
    v_mfma_f32_32x32x16_bf16 v[16:31], v[92:95], v[192:195], v[16:31]
    ds_read_b64_tr_b16 v[116:117], v7 offset:30720
    ds_read_b64_tr_b16 v[118:119], v7 offset:30976
    ds_read_b64_tr_b16 v[80:81], v11 offset:31744
    v_mfma_f32_32x32x16_bf16 v[32:47], v[96:99], v[192:195], v[32:47]
    ds_read_b64_tr_b16 v[82:83], v11 offset:32256
    ds_read_b64_tr_b16 v[84:85], v11 offset:32768
    ds_read_b64_tr_b16 v[86:87], v11 offset:33280
    v_mfma_f32_32x32x16_bf16 v[48:63], v[100:103], v[192:195], v[48:63]
    ds_read_b64_tr_b16 v[88:89], v11 offset:33792
    ds_read_b64_tr_b16 v[90:91], v11 offset:34304
    ds_read_b128 v[128:131], v9 offset:64
    s_waitcnt lgkmcnt(9)
    s_waitcnt vmcnt(14)
    v_mfma_f32_32x32x16_bf16 v[16:31], v[104:107], v[196:199], v[16:31]
    ds_read_b64_tr_b16 v[92:93], v12 offset:2048
    ds_read_b64_tr_b16 v[94:95], v12 offset:2560
    ds_read_b64_tr_b16 v[96:97], v12 offset:3072
    v_mfma_f32_32x32x16_bf16 v[32:47], v[108:111], v[196:199], v[32:47]
    ds_read_b64_tr_b16 v[98:99], v12 offset:3584
    ds_read_b64_tr_b16 v[100:101], v12 offset:4096
    ds_read_b64_tr_b16 v[102:103], v12 offset:4608
    v_mfma_f32_32x32x16_bf16 v[48:63], v[112:115], v[196:199], v[48:63]
    s_waitcnt lgkmcnt(12)
    ds_read_b128 v[184:187], v9 offset:0
    ds_read_b128 v[132:135], v9 offset:80
    ds_read_b128 v[188:191], v9 offset:16
    v_smfmac_f32_32x32x32_bf16 v[64:79], v[116:119], v[192:199], v8
    s_waitcnt lgkmcnt(10)
    s_waitcnt vmcnt(13)
    v_mfma_f32_32x32x16_bf16 v[16:31], v[80:83], v[200:203], v[16:31]
    ds_read_b64_tr_b16 v[120:121], v14 offset:5120
    ds_read_b64_tr_b16 v[122:123], v14 offset:5376
    ds_read_b64_tr_b16 v[104:105], v12 offset:6144
    v_mfma_f32_32x32x16_bf16 v[32:47], v[84:87], v[200:203], v[32:47]
    ds_read_b64_tr_b16 v[106:107], v12 offset:6656
    ds_read_b64_tr_b16 v[108:109], v12 offset:7168
    s_waitcnt lgkmcnt(12)
    ds_read_b64_tr_b16 v[110:111], v12 offset:7680
    s_waitcnt lgkmcnt(6)
    v_fmac_f32 v128, v125, v184
    v_fmac_f32 v129, v125, v185
    v_fmac_f32 v130, v125, v186
    v_fmac_f32 v131, v125, v187
    v_mfma_f32_32x32x16_bf16 v[48:63], v[88:91], v[200:203], v[48:63]
    ds_read_b64_tr_b16 v[112:113], v12 offset:8192
    ds_read_b64_tr_b16 v[114:115], v12 offset:8704
    v_fmac_f32 v132, v125, v188
    v_fmac_f32 v133, v125, v189
    v_fmac_f32 v134, v125, v190
    v_fmac_f32 v135, v125, v191
    ds_read_b128 v[136:139], v9 offset:96
    s_waitcnt vmcnt(12)
    v_mfma_f32_32x32x16_bf16 v[16:31], v[92:95], v[204:207], v[16:31]
    ds_read_b64_tr_b16 v[80:81], v12 offset:9216
    ds_read_b64_tr_b16 v[82:83], v12 offset:9728
    ds_read_b64_tr_b16 v[84:85], v12 offset:10240
    v_mfma_f32_32x32x16_bf16 v[32:47], v[96:99], v[204:207], v[32:47]
    ds_read_b64_tr_b16 v[86:87], v12 offset:10752
    ds_read_b64_tr_b16 v[88:89], v12 offset:11264
    ds_read_b64_tr_b16 v[90:91], v12 offset:11776
    v_mfma_f32_32x32x16_bf16 v[48:63], v[100:103], v[204:207], v[48:63]
    s_waitcnt lgkmcnt(12)
    ds_read_b128 v[184:187], v9 offset:32
    ds_read_b128 v[140:143], v9 offset:112
    ds_read_b128 v[188:191], v9 offset:48
    v_smfmac_f32_32x32x32_bf16 v[64:79], v[120:123], v[200:207], v8
    s_waitcnt lgkmcnt(10)
    s_waitcnt vmcnt(11)
    v_mfma_f32_32x32x16_bf16 v[16:31], v[104:107], v[208:211], v[16:31]
    ds_read_b64_tr_b16 v[116:117], v14 offset:12288
    ds_read_b64_tr_b16 v[118:119], v14 offset:12544
    ds_read_b64_tr_b16 v[92:93], v12 offset:13312
    v_mfma_f32_32x32x16_bf16 v[32:47], v[108:111], v[208:211], v[32:47]
    ds_read_b64_tr_b16 v[94:95], v12 offset:13824
    ds_read_b64_tr_b16 v[96:97], v12 offset:14336
    s_waitcnt lgkmcnt(12)
    ds_read_b64_tr_b16 v[98:99], v12 offset:14848
    s_waitcnt lgkmcnt(6)
    v_fmac_f32 v136, v125, v184
    v_fmac_f32 v137, v125, v185
    v_fmac_f32 v138, v125, v186
    v_fmac_f32 v139, v125, v187
    v_mfma_f32_32x32x16_bf16 v[48:63], v[112:115], v[208:211], v[48:63]
    ds_read_b64_tr_b16 v[100:101], v12 offset:15360
    ds_read_b64_tr_b16 v[102:103], v12 offset:15872
    v_fmac_f32 v140, v125, v188
    v_fmac_f32 v141, v125, v189
    v_fmac_f32 v142, v125, v190
    v_fmac_f32 v143, v125, v191
    ds_read_b128 v[144:147], v9 offset:320
    s_waitcnt vmcnt(10)
    v_mfma_f32_32x32x16_bf16 v[16:31], v[80:83], v[212:215], v[16:31]
    ds_read_b64_tr_b16 v[104:105], v12 offset:16384
    ds_read_b64_tr_b16 v[106:107], v12 offset:16896
    ds_read_b64_tr_b16 v[108:109], v12 offset:17408
    v_mfma_f32_32x32x16_bf16 v[32:47], v[84:87], v[212:215], v[32:47]
    ds_read_b64_tr_b16 v[110:111], v12 offset:17920
    ds_read_b64_tr_b16 v[112:113], v12 offset:18432
    ds_read_b64_tr_b16 v[114:115], v12 offset:18944
    v_mfma_f32_32x32x16_bf16 v[48:63], v[88:91], v[212:215], v[48:63]
    s_waitcnt lgkmcnt(12)
    ds_read_b128 v[184:187], v9 offset:256
    ds_read_b128 v[148:151], v9 offset:336
    ds_read_b128 v[188:191], v9 offset:272
    v_smfmac_f32_32x32x32_bf16 v[64:79], v[116:119], v[208:215], v8
    s_waitcnt lgkmcnt(10)
    s_waitcnt vmcnt(9)
    v_mfma_f32_32x32x16_bf16 v[16:31], v[92:95], v[216:219], v[16:31]
    ds_read_b64_tr_b16 v[120:121], v14 offset:19456
    ds_read_b64_tr_b16 v[122:123], v14 offset:19712
    ds_read_b64_tr_b16 v[80:81], v12 offset:20480
    v_mfma_f32_32x32x16_bf16 v[32:47], v[96:99], v[216:219], v[32:47]
    ds_read_b64_tr_b16 v[82:83], v12 offset:20992
    ds_read_b64_tr_b16 v[84:85], v12 offset:21504
    s_waitcnt lgkmcnt(12)
    ds_read_b64_tr_b16 v[86:87], v12 offset:22016
    s_waitcnt lgkmcnt(6)
    v_fmac_f32 v144, v125, v184
    v_fmac_f32 v145, v125, v185
    v_fmac_f32 v146, v125, v186
    v_fmac_f32 v147, v125, v187
    v_mfma_f32_32x32x16_bf16 v[48:63], v[100:103], v[216:219], v[48:63]
    ds_read_b64_tr_b16 v[88:89], v12 offset:22528
    ds_read_b64_tr_b16 v[90:91], v12 offset:23040
    v_fmac_f32 v148, v125, v188
    v_fmac_f32 v149, v125, v189
    v_fmac_f32 v150, v125, v190
    v_fmac_f32 v151, v125, v191
    ds_read_b128 v[152:155], v9 offset:352
    s_waitcnt vmcnt(8)
    v_mfma_f32_32x32x16_bf16 v[16:31], v[104:107], v[220:223], v[16:31]
    ds_read_b64_tr_b16 v[92:93], v12 offset:23552
    ds_read_b64_tr_b16 v[94:95], v12 offset:24064
    ds_read_b64_tr_b16 v[96:97], v12 offset:24576
    v_mfma_f32_32x32x16_bf16 v[32:47], v[108:111], v[220:223], v[32:47]
    ds_read_b64_tr_b16 v[98:99], v12 offset:25088
    ds_read_b64_tr_b16 v[100:101], v12 offset:25600
    ds_read_b64_tr_b16 v[102:103], v12 offset:26112
    v_mfma_f32_32x32x16_bf16 v[48:63], v[112:115], v[220:223], v[48:63]
    s_waitcnt lgkmcnt(12)
    ds_read_b128 v[184:187], v9 offset:288
    ds_read_b128 v[156:159], v9 offset:368
    ds_read_b128 v[188:191], v9 offset:304
    v_smfmac_f32_32x32x32_bf16 v[64:79], v[120:123], v[216:223], v8
    s_waitcnt lgkmcnt(10)
    s_waitcnt vmcnt(7)
    v_mfma_f32_32x32x16_bf16 v[16:31], v[80:83], v[224:227], v[16:31]
    ds_read_b64_tr_b16 v[116:117], v14 offset:26624
    ds_read_b64_tr_b16 v[118:119], v14 offset:26880
    ds_read_b64_tr_b16 v[104:105], v12 offset:27648
    v_mfma_f32_32x32x16_bf16 v[32:47], v[84:87], v[224:227], v[32:47]
    ds_read_b64_tr_b16 v[106:107], v12 offset:28160
    ds_read_b64_tr_b16 v[108:109], v12 offset:28672
    s_waitcnt lgkmcnt(12)
    ds_read_b64_tr_b16 v[110:111], v12 offset:29184
    s_waitcnt lgkmcnt(6)
    v_fmac_f32 v152, v125, v184
    v_fmac_f32 v153, v125, v185
    v_fmac_f32 v154, v125, v186
    v_fmac_f32 v155, v125, v187
    v_mfma_f32_32x32x16_bf16 v[48:63], v[88:91], v[224:227], v[48:63]
    ds_read_b64_tr_b16 v[112:113], v12 offset:29696
    ds_read_b64_tr_b16 v[114:115], v12 offset:30208
    v_fmac_f32 v156, v125, v188
    v_fmac_f32 v157, v125, v189
    v_fmac_f32 v158, v125, v190
    v_fmac_f32 v159, v125, v191
    ds_read_b128 v[160:163], v9 offset:576
    s_waitcnt vmcnt(6)
    v_mfma_f32_32x32x16_bf16 v[16:31], v[92:95], v[228:231], v[16:31]
    ds_read_b64_tr_b16 v[80:81], v12 offset:30720
    ds_read_b64_tr_b16 v[82:83], v12 offset:31232
    ds_read_b64_tr_b16 v[84:85], v12 offset:31744
    v_mfma_f32_32x32x16_bf16 v[32:47], v[96:99], v[228:231], v[32:47]
    ds_read_b64_tr_b16 v[86:87], v12 offset:32256
    ds_read_b64_tr_b16 v[88:89], v12 offset:32768
    ds_read_b64_tr_b16 v[90:91], v12 offset:33280
    v_mfma_f32_32x32x16_bf16 v[48:63], v[100:103], v[228:231], v[48:63]
    s_waitcnt lgkmcnt(12)
    ds_read_b128 v[184:187], v9 offset:512
    ds_read_b128 v[164:167], v9 offset:592
    ds_read_b128 v[188:191], v9 offset:528
    v_smfmac_f32_32x32x32_bf16 v[64:79], v[116:119], v[224:231], v8
    s_waitcnt lgkmcnt(10)
    s_waitcnt vmcnt(5)
    v_mfma_f32_32x32x16_bf16 v[16:31], v[104:107], v[232:235], v[16:31]
    ds_read_b64_tr_b16 v[120:121], v15 offset:1024
    ds_read_b64_tr_b16 v[122:123], v15 offset:1280
    ds_read_b64_tr_b16 v[92:93], v13 offset:2048
    v_mfma_f32_32x32x16_bf16 v[32:47], v[108:111], v[232:235], v[32:47]
    ds_read_b64_tr_b16 v[94:95], v13 offset:2560
    ds_read_b64_tr_b16 v[96:97], v13 offset:3072
    s_waitcnt lgkmcnt(12)
    ds_read_b64_tr_b16 v[98:99], v13 offset:3584
    s_waitcnt lgkmcnt(6)
    v_fmac_f32 v160, v125, v184
    v_fmac_f32 v161, v125, v185
    v_fmac_f32 v162, v125, v186
    v_fmac_f32 v163, v125, v187
    v_mfma_f32_32x32x16_bf16 v[48:63], v[112:115], v[232:235], v[48:63]
    ds_read_b64_tr_b16 v[100:101], v13 offset:4096
    ds_read_b64_tr_b16 v[102:103], v13 offset:4608
    v_fmac_f32 v164, v125, v188
    v_fmac_f32 v165, v125, v189
    v_fmac_f32 v166, v125, v190
    v_fmac_f32 v167, v125, v191
    ds_read_b128 v[168:171], v9 offset:608
    s_waitcnt vmcnt(4)
    v_mfma_f32_32x32x16_bf16 v[16:31], v[80:83], v[236:239], v[16:31]
    ds_read_b64_tr_b16 v[104:105], v13 offset:5120
    ds_read_b64_tr_b16 v[106:107], v13 offset:5632
    ds_read_b64_tr_b16 v[108:109], v13 offset:6144
    v_mfma_f32_32x32x16_bf16 v[32:47], v[84:87], v[236:239], v[32:47]
    ds_read_b64_tr_b16 v[110:111], v13 offset:6656
    ds_read_b64_tr_b16 v[112:113], v13 offset:7168
    ds_read_b64_tr_b16 v[114:115], v13 offset:7680
    v_mfma_f32_32x32x16_bf16 v[48:63], v[88:91], v[236:239], v[48:63]
    s_waitcnt lgkmcnt(12)
    ds_read_b128 v[184:187], v9 offset:544
    ds_read_b128 v[172:175], v9 offset:624
    ds_read_b128 v[188:191], v9 offset:560
    v_smfmac_f32_32x32x32_bf16 v[64:79], v[120:123], v[232:239], v8
    s_waitcnt lgkmcnt(10)
    s_waitcnt vmcnt(3)
    v_mfma_f32_32x32x16_bf16 v[16:31], v[92:95], v[240:243], v[16:31]
    ds_read_b64_tr_b16 v[116:117], v15 offset:8192
    ds_read_b64_tr_b16 v[118:119], v15 offset:8448
    ds_read_b64_tr_b16 v[80:81], v13 offset:9216
    v_mfma_f32_32x32x16_bf16 v[32:47], v[96:99], v[240:243], v[32:47]
    ds_read_b64_tr_b16 v[82:83], v13 offset:9728
    ds_read_b64_tr_b16 v[84:85], v13 offset:10240
    s_waitcnt lgkmcnt(12)
    ds_read_b64_tr_b16 v[86:87], v13 offset:10752
    s_waitcnt lgkmcnt(6)
    v_fmac_f32 v168, v125, v184
    v_fmac_f32 v169, v125, v185
    v_fmac_f32 v170, v125, v186
    v_fmac_f32 v171, v125, v187
    v_mfma_f32_32x32x16_bf16 v[48:63], v[100:103], v[240:243], v[48:63]
    ds_read_b64_tr_b16 v[88:89], v13 offset:11264
    ds_read_b64_tr_b16 v[90:91], v13 offset:11776
    v_fmac_f32 v172, v125, v188
    v_fmac_f32 v173, v125, v189
    v_fmac_f32 v174, v125, v190
    v_fmac_f32 v175, v125, v191
    ds_read_b128 v[176:179], v9 offset:832
    s_waitcnt vmcnt(2)
    v_mfma_f32_32x32x16_bf16 v[16:31], v[104:107], v[244:247], v[16:31]
    ds_read_b64_tr_b16 v[92:93], v13 offset:12288
    ds_read_b64_tr_b16 v[94:95], v13 offset:12800
    ds_read_b64_tr_b16 v[96:97], v13 offset:13312
    v_mfma_f32_32x32x16_bf16 v[32:47], v[108:111], v[244:247], v[32:47]
    ds_read_b64_tr_b16 v[98:99], v13 offset:13824
    ds_read_b64_tr_b16 v[100:101], v13 offset:14336
    ds_read_b64_tr_b16 v[102:103], v13 offset:14848
    v_mfma_f32_32x32x16_bf16 v[48:63], v[112:115], v[244:247], v[48:63]
    s_waitcnt lgkmcnt(12)
    ds_read_b128 v[184:187], v9 offset:768
    ds_read_b128 v[180:183], v9 offset:848
    ds_read_b128 v[188:191], v9 offset:784
    v_smfmac_f32_32x32x32_bf16 v[64:79], v[116:119], v[240:247], v8
    s_waitcnt lgkmcnt(10)
    s_waitcnt vmcnt(1)
    v_mfma_f32_32x32x16_bf16 v[16:31], v[80:83], v[248:251], v[16:31]
    ds_read_b64_tr_b16 v[120:121], v15 offset:15360
    ds_read_b64_tr_b16 v[122:123], v15 offset:15616
    v_mfma_f32_32x32x16_bf16 v[32:47], v[84:87], v[248:251], v[32:47]
    s_waitcnt lgkmcnt(2)
    v_fmac_f32 v176, v125, v184
    v_fmac_f32 v177, v125, v185
    v_fmac_f32 v178, v125, v186
    v_fmac_f32 v179, v125, v187
    v_mfma_f32_32x32x16_bf16 v[48:63], v[88:91], v[248:251], v[48:63]
    v_fmac_f32 v180, v125, v188
    v_fmac_f32 v181, v125, v189
    v_fmac_f32 v182, v125, v190
    v_fmac_f32 v183, v125, v191
    s_waitcnt vmcnt(0)
    v_mfma_f32_32x32x16_bf16 v[16:31], v[92:95], v[252:255], v[16:31]
    v_mfma_f32_32x32x16_bf16 v[32:47], v[96:99], v[252:255], v[32:47]
    v_mfma_f32_32x32x16_bf16 v[48:63], v[100:103], v[252:255], v[48:63]
    s_waitcnt lgkmcnt(0)
    v_smfmac_f32_32x32x32_bf16 v[64:79], v[120:123], v[248:255], v8
    s_mov_b64 exec, 1
    ds_add_u32 v126, v127 offset:20
    s_mov_b64 exec, -1
    s_nop 8
    v_add_f32 v64, v64, v72
    v_add_f32 v65, v65, v73
    v_add_f32 v66, v66, v74
    v_add_f32 v67, v67, v75
    v_add_f32 v68, v68, v76
    v_add_f32 v69, v69, v77
    v_add_f32 v70, v70, v78
    v_add_f32 v71, v71, v79
    v_pk_fma_f32 v[16:17], v[16:17], v[124:125], v[128:129] op_sel:[0,0,0] op_sel_hi:[1,0,1]
    v_pk_fma_f32 v[18:19], v[18:19], v[124:125], v[130:131] op_sel:[0,0,0] op_sel_hi:[1,0,1]
    v_pk_fma_f32 v[20:21], v[20:21], v[124:125], v[132:133] op_sel:[0,0,0] op_sel_hi:[1,0,1]
    v_pk_fma_f32 v[22:23], v[22:23], v[124:125], v[134:135] op_sel:[0,0,0] op_sel_hi:[1,0,1]
    v_pk_fma_f32 v[24:25], v[24:25], v[124:125], v[136:137] op_sel:[0,0,0] op_sel_hi:[1,0,1]
    v_pk_fma_f32 v[26:27], v[26:27], v[124:125], v[138:139] op_sel:[0,0,0] op_sel_hi:[1,0,1]
    v_pk_fma_f32 v[28:29], v[28:29], v[124:125], v[140:141] op_sel:[0,0,0] op_sel_hi:[1,0,1]
    v_pk_fma_f32 v[30:31], v[30:31], v[124:125], v[142:143] op_sel:[0,0,0] op_sel_hi:[1,0,1]
    v_exp_f32 v80, v16
    v_exp_f32 v81, v17
    v_exp_f32 v82, v18
    v_exp_f32 v83, v19
    v_exp_f32 v84, v20
    v_exp_f32 v85, v21
    v_exp_f32 v86, v22
    v_exp_f32 v87, v23
    v_exp_f32 v88, v24
    v_exp_f32 v89, v25
    v_exp_f32 v90, v26
    v_exp_f32 v91, v27
    v_exp_f32 v92, v28
    v_exp_f32 v93, v29
    v_exp_f32 v94, v30
    v_exp_f32 v95, v31
    v_pk_add_f32 v[80:81], v[80:81], 1.0 op_sel_hi:[1,0]
    v_pk_add_f32 v[82:83], v[82:83], 1.0 op_sel_hi:[1,0]
    v_pk_add_f32 v[84:85], v[84:85], 1.0 op_sel_hi:[1,0]
    v_pk_add_f32 v[86:87], v[86:87], 1.0 op_sel_hi:[1,0]
    v_pk_add_f32 v[88:89], v[88:89], 1.0 op_sel_hi:[1,0]
    v_pk_add_f32 v[90:91], v[90:91], 1.0 op_sel_hi:[1,0]
    v_pk_add_f32 v[92:93], v[92:93], 1.0 op_sel_hi:[1,0]
    v_pk_add_f32 v[94:95], v[94:95], 1.0 op_sel_hi:[1,0]
    v_rcp_f32 v80, v80
    v_rcp_f32 v81, v81
    v_rcp_f32 v82, v82
    v_rcp_f32 v83, v83
    v_rcp_f32 v84, v84
    v_rcp_f32 v85, v85
    v_rcp_f32 v86, v86
    v_rcp_f32 v87, v87
    v_rcp_f32 v88, v88
    v_rcp_f32 v89, v89
    v_rcp_f32 v90, v90
    v_rcp_f32 v91, v91
    v_rcp_f32 v92, v92
    v_rcp_f32 v93, v93
    v_rcp_f32 v94, v94
    v_rcp_f32 v95, v95
    v_pk_mul_f32 v[16:17], v[16:17], v[80:81]
    v_pk_mul_f32 v[18:19], v[18:19], v[82:83]
    v_pk_mul_f32 v[20:21], v[20:21], v[84:85]
    v_pk_mul_f32 v[22:23], v[22:23], v[86:87]
    v_pk_mul_f32 v[24:25], v[24:25], v[88:89]
    v_pk_mul_f32 v[26:27], v[26:27], v[90:91]
    v_pk_mul_f32 v[28:29], v[28:29], v[92:93]
    v_pk_mul_f32 v[30:31], v[30:31], v[94:95]
    v_cvt_pk_bf16_f32 v208, v16, v17
    v_cvt_pk_bf16_f32 v209, v18, v19
    v_cvt_pk_bf16_f32 v210, v20, v21
    v_cvt_pk_bf16_f32 v211, v22, v23
    v_cvt_pk_bf16_f32 v212, v24, v25
    v_cvt_pk_bf16_f32 v213, v26, v27
    v_cvt_pk_bf16_f32 v214, v28, v29
    v_cvt_pk_bf16_f32 v215, v30, v31
    buffer_store_dwordx4 v[208:211], v2, s[40:43], s52 offen offset:0 sc1
    buffer_store_dwordx4 v[212:215], v2, s[40:43], s52 offen offset:1024 sc1
    v_pk_fma_f32 v[32:33], v[32:33], v[124:125], v[144:145] op_sel:[0,0,0] op_sel_hi:[1,0,1]
    v_pk_fma_f32 v[34:35], v[34:35], v[124:125], v[146:147] op_sel:[0,0,0] op_sel_hi:[1,0,1]
    v_pk_fma_f32 v[36:37], v[36:37], v[124:125], v[148:149] op_sel:[0,0,0] op_sel_hi:[1,0,1]
    v_pk_fma_f32 v[38:39], v[38:39], v[124:125], v[150:151] op_sel:[0,0,0] op_sel_hi:[1,0,1]
    v_pk_fma_f32 v[40:41], v[40:41], v[124:125], v[152:153] op_sel:[0,0,0] op_sel_hi:[1,0,1]
    v_pk_fma_f32 v[42:43], v[42:43], v[124:125], v[154:155] op_sel:[0,0,0] op_sel_hi:[1,0,1]
    v_pk_fma_f32 v[44:45], v[44:45], v[124:125], v[156:157] op_sel:[0,0,0] op_sel_hi:[1,0,1]
    v_pk_fma_f32 v[46:47], v[46:47], v[124:125], v[158:159] op_sel:[0,0,0] op_sel_hi:[1,0,1]
    v_exp_f32 v80, v32
    v_exp_f32 v81, v33
    v_exp_f32 v82, v34
    v_exp_f32 v83, v35
    v_exp_f32 v84, v36
    v_exp_f32 v85, v37
    v_exp_f32 v86, v38
    v_exp_f32 v87, v39
    v_exp_f32 v88, v40
    v_exp_f32 v89, v41
    v_exp_f32 v90, v42
    v_exp_f32 v91, v43
    v_exp_f32 v92, v44
    v_exp_f32 v93, v45
    v_exp_f32 v94, v46
    v_exp_f32 v95, v47
    v_pk_add_f32 v[80:81], v[80:81], 1.0 op_sel_hi:[1,0]
    v_pk_add_f32 v[82:83], v[82:83], 1.0 op_sel_hi:[1,0]
    v_pk_add_f32 v[84:85], v[84:85], 1.0 op_sel_hi:[1,0]
    v_pk_add_f32 v[86:87], v[86:87], 1.0 op_sel_hi:[1,0]
    v_pk_add_f32 v[88:89], v[88:89], 1.0 op_sel_hi:[1,0]
    v_pk_add_f32 v[90:91], v[90:91], 1.0 op_sel_hi:[1,0]
    v_pk_add_f32 v[92:93], v[92:93], 1.0 op_sel_hi:[1,0]
    v_pk_add_f32 v[94:95], v[94:95], 1.0 op_sel_hi:[1,0]
    v_rcp_f32 v80, v80
    v_rcp_f32 v81, v81
    v_rcp_f32 v82, v82
    v_rcp_f32 v83, v83
    v_rcp_f32 v84, v84
    v_rcp_f32 v85, v85
    v_rcp_f32 v86, v86
    v_rcp_f32 v87, v87
    v_rcp_f32 v88, v88
    v_rcp_f32 v89, v89
    v_rcp_f32 v90, v90
    v_rcp_f32 v91, v91
    v_rcp_f32 v92, v92
    v_rcp_f32 v93, v93
    v_rcp_f32 v94, v94
    v_rcp_f32 v95, v95
    v_pk_mul_f32 v[32:33], v[32:33], v[80:81]
    v_pk_mul_f32 v[34:35], v[34:35], v[82:83]
    v_pk_mul_f32 v[36:37], v[36:37], v[84:85]
    v_pk_mul_f32 v[38:39], v[38:39], v[86:87]
    v_pk_mul_f32 v[40:41], v[40:41], v[88:89]
    v_pk_mul_f32 v[42:43], v[42:43], v[90:91]
    v_pk_mul_f32 v[44:45], v[44:45], v[92:93]
    v_pk_mul_f32 v[46:47], v[46:47], v[94:95]
    v_cvt_pk_bf16_f32 v216, v32, v33
    v_cvt_pk_bf16_f32 v217, v34, v35
    v_cvt_pk_bf16_f32 v218, v36, v37
    v_cvt_pk_bf16_f32 v219, v38, v39
    v_cvt_pk_bf16_f32 v220, v40, v41
    v_cvt_pk_bf16_f32 v221, v42, v43
    v_cvt_pk_bf16_f32 v222, v44, v45
    v_cvt_pk_bf16_f32 v223, v46, v47
    buffer_store_dwordx4 v[216:219], v2, s[40:43], s52 offen offset:2048 sc1
    buffer_store_dwordx4 v[220:223], v2, s[40:43], s52 offen offset:3072 sc1
    v_pk_fma_f32 v[48:49], v[48:49], v[124:125], v[160:161] op_sel:[0,0,0] op_sel_hi:[1,0,1]
    v_pk_fma_f32 v[50:51], v[50:51], v[124:125], v[162:163] op_sel:[0,0,0] op_sel_hi:[1,0,1]
    v_pk_fma_f32 v[52:53], v[52:53], v[124:125], v[164:165] op_sel:[0,0,0] op_sel_hi:[1,0,1]
    v_pk_fma_f32 v[54:55], v[54:55], v[124:125], v[166:167] op_sel:[0,0,0] op_sel_hi:[1,0,1]
    v_pk_fma_f32 v[56:57], v[56:57], v[124:125], v[168:169] op_sel:[0,0,0] op_sel_hi:[1,0,1]
    v_pk_fma_f32 v[58:59], v[58:59], v[124:125], v[170:171] op_sel:[0,0,0] op_sel_hi:[1,0,1]
    v_pk_fma_f32 v[60:61], v[60:61], v[124:125], v[172:173] op_sel:[0,0,0] op_sel_hi:[1,0,1]
    v_pk_fma_f32 v[62:63], v[62:63], v[124:125], v[174:175] op_sel:[0,0,0] op_sel_hi:[1,0,1]
    v_exp_f32 v80, v48
    v_exp_f32 v81, v49
    v_exp_f32 v82, v50
    v_exp_f32 v83, v51
    v_exp_f32 v84, v52
    v_exp_f32 v85, v53
    v_exp_f32 v86, v54
    v_exp_f32 v87, v55
    v_exp_f32 v88, v56
    v_exp_f32 v89, v57
    v_exp_f32 v90, v58
    v_exp_f32 v91, v59
    v_exp_f32 v92, v60
    v_exp_f32 v93, v61
    v_exp_f32 v94, v62
    v_exp_f32 v95, v63
    v_pk_add_f32 v[80:81], v[80:81], 1.0 op_sel_hi:[1,0]
    v_pk_add_f32 v[82:83], v[82:83], 1.0 op_sel_hi:[1,0]
    v_pk_add_f32 v[84:85], v[84:85], 1.0 op_sel_hi:[1,0]
    v_pk_add_f32 v[86:87], v[86:87], 1.0 op_sel_hi:[1,0]
    v_pk_add_f32 v[88:89], v[88:89], 1.0 op_sel_hi:[1,0]
    v_pk_add_f32 v[90:91], v[90:91], 1.0 op_sel_hi:[1,0]
    v_pk_add_f32 v[92:93], v[92:93], 1.0 op_sel_hi:[1,0]
    v_pk_add_f32 v[94:95], v[94:95], 1.0 op_sel_hi:[1,0]
    v_rcp_f32 v80, v80
    v_rcp_f32 v81, v81
    v_rcp_f32 v82, v82
    v_rcp_f32 v83, v83
    v_rcp_f32 v84, v84
    v_rcp_f32 v85, v85
    v_rcp_f32 v86, v86
    v_rcp_f32 v87, v87
    v_rcp_f32 v88, v88
    v_rcp_f32 v89, v89
    v_rcp_f32 v90, v90
    v_rcp_f32 v91, v91
    v_rcp_f32 v92, v92
    v_rcp_f32 v93, v93
    v_rcp_f32 v94, v94
    v_rcp_f32 v95, v95
    v_pk_mul_f32 v[48:49], v[48:49], v[80:81]
    v_pk_mul_f32 v[50:51], v[50:51], v[82:83]
    v_pk_mul_f32 v[52:53], v[52:53], v[84:85]
    v_pk_mul_f32 v[54:55], v[54:55], v[86:87]
    v_pk_mul_f32 v[56:57], v[56:57], v[88:89]
    v_pk_mul_f32 v[58:59], v[58:59], v[90:91]
    v_pk_mul_f32 v[60:61], v[60:61], v[92:93]
    v_pk_mul_f32 v[62:63], v[62:63], v[94:95]
    v_cvt_pk_bf16_f32 v224, v48, v49
    v_cvt_pk_bf16_f32 v225, v50, v51
    v_cvt_pk_bf16_f32 v226, v52, v53
    v_cvt_pk_bf16_f32 v227, v54, v55
    v_cvt_pk_bf16_f32 v228, v56, v57
    v_cvt_pk_bf16_f32 v229, v58, v59
    v_cvt_pk_bf16_f32 v230, v60, v61
    v_cvt_pk_bf16_f32 v231, v62, v63
    s_add_u32 s52, s52, 4096
    buffer_store_dwordx4 v[224:227], v2, s[40:43], s52 offen offset:0 sc1
    buffer_store_dwordx4 v[228:231], v2, s[40:43], s52 offen offset:1024 sc1
    v_pk_fma_f32 v[64:65], v[64:65], v[124:125], v[176:177] op_sel:[0,0,0] op_sel_hi:[1,0,1]
    v_pk_fma_f32 v[66:67], v[66:67], v[124:125], v[178:179] op_sel:[0,0,0] op_sel_hi:[1,0,1]
    v_pk_fma_f32 v[68:69], v[68:69], v[124:125], v[180:181] op_sel:[0,0,0] op_sel_hi:[1,0,1]
    v_pk_fma_f32 v[70:71], v[70:71], v[124:125], v[182:183] op_sel:[0,0,0] op_sel_hi:[1,0,1]
    v_exp_f32 v80, v64
    v_exp_f32 v81, v65
    v_exp_f32 v82, v66
    v_exp_f32 v83, v67
    v_exp_f32 v84, v68
    v_exp_f32 v85, v69
    v_exp_f32 v86, v70
    v_exp_f32 v87, v71
    v_pk_add_f32 v[80:81], v[80:81], 1.0 op_sel_hi:[1,0]
    v_pk_add_f32 v[82:83], v[82:83], 1.0 op_sel_hi:[1,0]
    v_pk_add_f32 v[84:85], v[84:85], 1.0 op_sel_hi:[1,0]
    v_pk_add_f32 v[86:87], v[86:87], 1.0 op_sel_hi:[1,0]
    v_rcp_f32 v80, v80
    v_rcp_f32 v81, v81
    v_rcp_f32 v82, v82
    v_rcp_f32 v83, v83
    v_rcp_f32 v84, v84
    v_rcp_f32 v85, v85
    v_rcp_f32 v86, v86
    v_rcp_f32 v87, v87
    v_pk_mul_f32 v[64:65], v[64:65], v[80:81]
    v_pk_mul_f32 v[66:67], v[66:67], v[82:83]
    v_pk_mul_f32 v[68:69], v[68:69], v[84:85]
    v_pk_mul_f32 v[70:71], v[70:71], v[86:87]
    v_cvt_pk_bf16_f32 v232, v64, v65
    v_cvt_pk_bf16_f32 v233, v66, v67
    v_cvt_pk_bf16_f32 v234, v68, v69
    v_cvt_pk_bf16_f32 v235, v70, v71
    buffer_store_dwordx4 v[232:235], v2, s[40:43], s52 offen offset:2048 sc1
    s_and_b32 s54, s44, 1
    s_lshr_b32 s55, s44, 1
    s_lshr_b32 s52, s46, 3
    s_lshl_b32 s52, s52, 1
    s_lshl_b32 s57, s45, 2
    s_add_u32 s57, s57, s52
    s_add_u32 s57, s57, s54
    s_and_b32 s58, s46, 7
    s_lshl_b32 s58, s58, 1
    s_add_u32 s58, s58, s55
    v_bfe_u32 v10, v0, 2, 2
    v_bfe_u32 v11, v0, 5, 1
    v_lshl_add_u32 v10, v11, 2, v10
    v_lshlrev_b32 v10, 7, v10
    v_bfe_u32 v11, v0, 4, 1
    v_lshl_add_u32 v10, v11, 5, v10
    v_and_b32 v11, 3, v0
    v_lshl_add_u32 v10, v11, 3, v10
    v_bfe_u32 v11, v0, 3, 1
    v_lshl_add_u32 v10, v11, 6, v10
    s_lshl_b32 s52, s55, 6
    v_xor_b32 v10, s52, v10
    s_lshl_b32 s52, s55, 13
    v_add_u32 v10, s52, v10
    v_xor_b32 v11, 64, v10
    v_mov_b32 v16, 0
    v_mov_b32 v17, 0
    v_mov_b32 v18, 0
    v_mov_b32 v19, 0
    v_mov_b32 v20, 0
    v_mov_b32 v21, 0
    v_mov_b32 v22, 0
    v_mov_b32 v23, 0
    v_mov_b32 v24, 0
    v_mov_b32 v25, 0
    v_mov_b32 v26, 0
    v_mov_b32 v27, 0
    v_mov_b32 v28, 0
    v_mov_b32 v29, 0
    v_mov_b32 v30, 0
    v_mov_b32 v31, 0
    v_mov_b32 v32, 0
    v_mov_b32 v33, 0
    v_mov_b32 v34, 0
    v_mov_b32 v35, 0
    v_mov_b32 v36, 0
    v_mov_b32 v37, 0
    v_mov_b32 v38, 0
    v_mov_b32 v39, 0
    v_mov_b32 v40, 0
    v_mov_b32 v41, 0
    v_mov_b32 v42, 0
    v_mov_b32 v43, 0
    v_mov_b32 v44, 0
    v_mov_b32 v45, 0
    v_mov_b32 v46, 0
    v_mov_b32 v47, 0
    v_lshrrev_b32 v5, 3, v1
    v_lshlrev_b32 v5, 5, v5
    v_and_or_b32 v5, v1, 7, v5
    v_lshlrev_b32 v5, 2, v5
    s_lshl_b32 s52, s57, 8
    s_lshl_b32 s53, s55, 7
    s_add_u32 s52, s52, s53
    s_add_u32 s52, s52, 0xe0000
    s_lshl_b32 s61, s57, 15
    s_lshl_b32 s59, s58, 11
    s_add_u32 s61, s61, s59
    s_add_u32 s61, s61, 0xa00000
    s_add_u32 s62, s52, 32768
    s_waitcnt vmcnt(0)
    v_mov_b32 v9, s47
    s_mov_b64 exec, 1
    s_cmp_lg_u32 s66, 0
    s_cbranch_scc1 Lfl15
    buffer_store_dword v9, v3, s[40:43], s56 offen sc1
    s_mov_b64 exec, -1
    s_sleep 16
    s_branch Lfl15d
Lfl15:
    buffer_store_dword v9, v3, s[40:43], s56 offen
    s_mov_b64 exec, -1
Lfl15d:
    s_mov_b64 exec, 0xff
    s_mov_b32 s50, 20000
    s_sleep 2
Lpoll16:
    buffer_load_dword v6, v5, s[40:43], s52 offen sc1
    s_waitcnt vmcnt(0)
    v_cmp_ne_u32 vcc, s47, v6
    s_sub_u32 s50, s50, 1
    s_cbranch_vccz Lpolld16
    s_cmp_lg_u32 s50, 0
    s_cbranch_scc1 Lpoll16
Lpolld16:
    s_mov_b64 exec, -1
    s_mul_i32 s52, s57, 114688
    s_mul_i32 s53, s55, 57344
    s_add_u32 s52, s52, s53
    s_add_u32 s52, s52, 0xe00000
    s_add_u32 s53, s69, 0
    s_and_b32 s53, s53, 7
    s_mul_i32 s53, s53, 7168
    s_add_u32 s53, s53, s52
    buffer_load_dwordx4 v[128:131], v2, s[40:43], s53 offen offset:0 sc1
    buffer_load_dwordx4 v[132:135], v2, s[40:43], s53 offen offset:1024 sc1
    buffer_load_dwordx4 v[136:139], v2, s[40:43], s53 offen offset:2048 sc1
    buffer_load_dwordx4 v[140:143], v2, s[40:43], s53 offen offset:3072 sc1
    s_add_u32 s53, s69, 1
    s_and_b32 s53, s53, 7
    s_mul_i32 s53, s53, 7168
    s_add_u32 s53, s53, s52
    buffer_load_dwordx4 v[144:147], v2, s[40:43], s53 offen offset:0 sc1
    buffer_load_dwordx4 v[148:151], v2, s[40:43], s53 offen offset:1024 sc1
    buffer_load_dwordx4 v[152:155], v2, s[40:43], s53 offen offset:2048 sc1
    buffer_load_dwordx4 v[156:159], v2, s[40:43], s53 offen offset:3072 sc1
    s_barrier
    s_add_u32 s53, s69, 2
    s_and_b32 s53, s53, 7
    s_mul_i32 s53, s53, 7168
    s_add_u32 s53, s53, s52
    buffer_load_dwordx4 v[160:163], v2, s[40:43], s53 offen offset:0 sc1
    buffer_load_dwordx4 v[164:167], v2, s[40:43], s53 offen offset:1024 sc1
    buffer_load_dwordx4 v[168:171], v2, s[40:43], s53 offen offset:2048 sc1
    buffer_load_dwordx4 v[172:175], v2, s[40:43], s53 offen offset:3072 sc1
    v_add_u32 v12, 0, v10
    v_add_u32 v13, 0, v11
    ds_read_b64_tr_b16 v[48:49], v12 offset:0
    ds_read_b64_tr_b16 v[50:51], v12 offset:1024
    ds_read_b64_tr_b16 v[52:53], v13 offset:0
    ds_read_b64_tr_b16 v[54:55], v13 offset:1024
    ds_read_b64_tr_b16 v[56:57], v12 offset:2048
    ds_read_b64_tr_b16 v[58:59], v12 offset:3072
    ds_read_b64_tr_b16 v[60:61], v13 offset:2048
    ds_read_b64_tr_b16 v[62:63], v13 offset:3072
    s_waitcnt lgkmcnt(4)
    s_waitcnt vmcnt(11)
    v_mfma_f32_32x32x16_bf16 v[16:31], v[48:51], v[128:131], v[16:31]
    ds_read_b64_tr_b16 v[88:89], v12 offset:4096
    ds_read_b64_tr_b16 v[90:91], v12 offset:5120
    ds_read_b64_tr_b16 v[92:93], v13 offset:4096
    ds_read_b64_tr_b16 v[94:95], v13 offset:5120
    v_mfma_f32_32x32x16_bf16 v[32:47], v[52:55], v[128:131], v[32:47]
    s_add_u32 s53, s69, 3
    s_and_b32 s53, s53, 7
    s_mul_i32 s53, s53, 7168
    s_add_u32 s53, s53, s52
    buffer_load_dwordx4 v[176:179], v2, s[40:43], s53 offen offset:0 sc1
    s_waitcnt lgkmcnt(4)
    s_waitcnt vmcnt(11)
    v_mfma_f32_32x32x16_bf16 v[16:31], v[56:59], v[132:135], v[16:31]
    ds_read_b64_tr_b16 v[48:49], v12 offset:6144
    ds_read_b64_tr_b16 v[50:51], v12 offset:7168
    ds_read_b64_tr_b16 v[52:53], v13 offset:6144
    ds_read_b64_tr_b16 v[54:55], v13 offset:7168
    v_mfma_f32_32x32x16_bf16 v[32:47], v[60:63], v[132:135], v[32:47]
    buffer_load_dwordx4 v[180:183], v2, s[40:43], s53 offen offset:1024 sc1
    s_waitcnt lgkmcnt(4)
    v_add_u32 v12, 16384, v10
    v_add_u32 v13, 16384, v11
    s_waitcnt vmcnt(11)
    v_mfma_f32_32x32x16_bf16 v[16:31], v[88:91], v[136:139], v[16:31]
    ds_read_b64_tr_b16 v[56:57], v12 offset:0
    ds_read_b64_tr_b16 v[58:59], v12 offset:1024
    ds_read_b64_tr_b16 v[60:61], v13 offset:0
    ds_read_b64_tr_b16 v[62:63], v13 offset:1024
    v_mfma_f32_32x32x16_bf16 v[32:47], v[92:95], v[136:139], v[32:47]
    buffer_load_dwordx4 v[184:187], v2, s[40:43], s53 offen offset:2048 sc1
    s_waitcnt lgkmcnt(4)
    s_waitcnt vmcnt(11)
    v_mfma_f32_32x32x16_bf16 v[16:31], v[48:51], v[140:143], v[16:31]
    ds_read_b64_tr_b16 v[88:89], v12 offset:2048
    ds_read_b64_tr_b16 v[90:91], v12 offset:3072
    ds_read_b64_tr_b16 v[92:93], v13 offset:2048
    ds_read_b64_tr_b16 v[94:95], v13 offset:3072
    v_mfma_f32_32x32x16_bf16 v[32:47], v[52:55], v[140:143], v[32:47]
    buffer_load_dwordx4 v[188:191], v2, s[40:43], s53 offen offset:3072 sc1
    s_waitcnt lgkmcnt(4)
    s_waitcnt vmcnt(11)
    v_mfma_f32_32x32x16_bf16 v[16:31], v[56:59], v[144:147], v[16:31]
    ds_read_b64_tr_b16 v[48:49], v12 offset:4096
    ds_read_b64_tr_b16 v[50:51], v12 offset:5120
    ds_read_b64_tr_b16 v[52:53], v13 offset:4096
    ds_read_b64_tr_b16 v[54:55], v13 offset:5120
    v_mfma_f32_32x32x16_bf16 v[32:47], v[60:63], v[144:147], v[32:47]
    s_add_u32 s53, s69, 4
    s_and_b32 s53, s53, 7
    s_mul_i32 s53, s53, 7168
    s_add_u32 s53, s53, s52
    buffer_load_dwordx4 v[192:195], v2, s[40:43], s53 offen offset:0 sc1
    s_waitcnt lgkmcnt(4)
    s_waitcnt vmcnt(11)
    v_mfma_f32_32x32x16_bf16 v[16:31], v[88:91], v[148:151], v[16:31]
    ds_read_b64_tr_b16 v[56:57], v12 offset:6144
    ds_read_b64_tr_b16 v[58:59], v12 offset:7168
    ds_read_b64_tr_b16 v[60:61], v13 offset:6144
    ds_read_b64_tr_b16 v[62:63], v13 offset:7168
    v_mfma_f32_32x32x16_bf16 v[32:47], v[92:95], v[148:151], v[32:47]
    buffer_load_dwordx4 v[196:199], v2, s[40:43], s53 offen offset:1024 sc1
    s_waitcnt lgkmcnt(4)
    v_add_u32 v12, 32768, v10
    v_add_u32 v13, 32768, v11
    s_waitcnt vmcnt(11)
    v_mfma_f32_32x32x16_bf16 v[16:31], v[48:51], v[152:155], v[16:31]
    ds_read_b64_tr_b16 v[88:89], v12 offset:0
    ds_read_b64_tr_b16 v[90:91], v12 offset:1024
    ds_read_b64_tr_b16 v[92:93], v13 offset:0
    ds_read_b64_tr_b16 v[94:95], v13 offset:1024
    v_mfma_f32_32x32x16_bf16 v[32:47], v[52:55], v[152:155], v[32:47]
    buffer_load_dwordx4 v[200:203], v2, s[40:43], s53 offen offset:2048 sc1
    s_waitcnt lgkmcnt(4)
    s_waitcnt vmcnt(11)
    v_mfma_f32_32x32x16_bf16 v[16:31], v[56:59], v[156:159], v[16:31]
    ds_read_b64_tr_b16 v[48:49], v12 offset:2048
    ds_read_b64_tr_b16 v[50:51], v12 offset:3072
    ds_read_b64_tr_b16 v[52:53], v13 offset:2048
    ds_read_b64_tr_b16 v[54:55], v13 offset:3072
    v_mfma_f32_32x32x16_bf16 v[32:47], v[60:63], v[156:159], v[32:47]
    buffer_load_dwordx4 v[204:207], v2, s[40:43], s53 offen offset:3072 sc1
    s_waitcnt lgkmcnt(4)
    s_waitcnt vmcnt(11)
    v_mfma_f32_32x32x16_bf16 v[16:31], v[88:91], v[160:163], v[16:31]
    ds_read_b64_tr_b16 v[56:57], v12 offset:4096
    ds_read_b64_tr_b16 v[58:59], v12 offset:5120
    ds_read_b64_tr_b16 v[60:61], v13 offset:4096
    ds_read_b64_tr_b16 v[62:63], v13 offset:5120
    v_mfma_f32_32x32x16_bf16 v[32:47], v[92:95], v[160:163], v[32:47]
    s_add_u32 s53, s69, 5
    s_and_b32 s53, s53, 7
    s_mul_i32 s53, s53, 7168
    s_add_u32 s53, s53, s52
    buffer_load_dwordx4 v[208:211], v2, s[40:43], s53 offen offset:0 sc1
    s_waitcnt lgkmcnt(4)
    s_waitcnt vmcnt(11)
    v_mfma_f32_32x32x16_bf16 v[16:31], v[48:51], v[164:167], v[16:31]
    ds_read_b64_tr_b16 v[88:89], v12 offset:6144
    ds_read_b64_tr_b16 v[90:91], v12 offset:7168
    ds_read_b64_tr_b16 v[92:93], v13 offset:6144
    ds_read_b64_tr_b16 v[94:95], v13 offset:7168
    v_mfma_f32_32x32x16_bf16 v[32:47], v[52:55], v[164:167], v[32:47]
    buffer_load_dwordx4 v[212:215], v2, s[40:43], s53 offen offset:1024 sc1
    s_waitcnt lgkmcnt(4)
    v_add_u32 v12, 49152, v10
    v_add_u32 v13, 49152, v11
    s_waitcnt vmcnt(11)
    v_mfma_f32_32x32x16_bf16 v[16:31], v[56:59], v[168:171], v[16:31]
    ds_read_b64_tr_b16 v[48:49], v12 offset:0
    ds_read_b64_tr_b16 v[50:51], v12 offset:1024
    ds_read_b64_tr_b16 v[52:53], v13 offset:0
    ds_read_b64_tr_b16 v[54:55], v13 offset:1024
    v_mfma_f32_32x32x16_bf16 v[32:47], v[60:63], v[168:171], v[32:47]
    buffer_load_dwordx4 v[216:219], v2, s[40:43], s53 offen offset:2048 sc1
    s_waitcnt lgkmcnt(4)
    s_mov_b64 exec, 1
    ds_add_u32 v126, v127 offset:24
    s_mov_b64 exec, -1
    s_waitcnt vmcnt(11)
    v_mfma_f32_32x32x16_bf16 v[16:31], v[88:91], v[172:175], v[16:31]
    ds_read_b64_tr_b16 v[56:57], v12 offset:2048
    ds_read_b64_tr_b16 v[58:59], v12 offset:3072
    ds_read_b64_tr_b16 v[60:61], v13 offset:2048
    ds_read_b64_tr_b16 v[62:63], v13 offset:3072
    v_mfma_f32_32x32x16_bf16 v[32:47], v[92:95], v[172:175], v[32:47]
    buffer_load_dwordx4 v[220:223], v2, s[40:43], s53 offen offset:3072 sc1
    s_waitcnt lgkmcnt(5)
    s_waitcnt vmcnt(11)
    v_mfma_f32_32x32x16_bf16 v[16:31], v[48:51], v[176:179], v[16:31]
    ds_read_b64_tr_b16 v[88:89], v12 offset:4096
    ds_read_b64_tr_b16 v[90:91], v12 offset:5120
    ds_read_b64_tr_b16 v[92:93], v13 offset:4096
    ds_read_b64_tr_b16 v[94:95], v13 offset:5120
    v_mfma_f32_32x32x16_bf16 v[32:47], v[52:55], v[176:179], v[32:47]
    s_add_u32 s53, s69, 6
    s_and_b32 s53, s53, 7
    s_mul_i32 s53, s53, 7168
    s_add_u32 s53, s53, s52
    buffer_load_dwordx4 v[224:227], v2, s[40:43], s53 offen offset:0 sc1
    s_waitcnt lgkmcnt(4)
    s_waitcnt vmcnt(11)
    v_mfma_f32_32x32x16_bf16 v[16:31], v[56:59], v[180:183], v[16:31]
    ds_read_b64_tr_b16 v[48:49], v12 offset:6144
    ds_read_b64_tr_b16 v[50:51], v12 offset:7168
    ds_read_b64_tr_b16 v[52:53], v13 offset:6144
    ds_read_b64_tr_b16 v[54:55], v13 offset:7168
    v_mfma_f32_32x32x16_bf16 v[32:47], v[60:63], v[180:183], v[32:47]
    buffer_load_dwordx4 v[228:231], v2, s[40:43], s53 offen offset:1024 sc1
    s_waitcnt lgkmcnt(4)
    v_add_u32 v12, 65536, v10
    v_add_u32 v13, 65536, v11
    s_waitcnt vmcnt(11)
    v_mfma_f32_32x32x16_bf16 v[16:31], v[88:91], v[184:187], v[16:31]
    ds_read_b64_tr_b16 v[56:57], v12 offset:0
    ds_read_b64_tr_b16 v[58:59], v12 offset:1024
    ds_read_b64_tr_b16 v[60:61], v13 offset:0
    ds_read_b64_tr_b16 v[62:63], v13 offset:1024
    v_mfma_f32_32x32x16_bf16 v[32:47], v[92:95], v[184:187], v[32:47]
    buffer_load_dwordx4 v[232:235], v2, s[40:43], s53 offen offset:2048 sc1
    s_waitcnt lgkmcnt(4)
    s_waitcnt vmcnt(11)
    v_mfma_f32_32x32x16_bf16 v[16:31], v[48:51], v[188:191], v[16:31]
    ds_read_b64_tr_b16 v[88:89], v12 offset:2048
    ds_read_b64_tr_b16 v[90:91], v12 offset:3072
    ds_read_b64_tr_b16 v[92:93], v13 offset:2048
    ds_read_b64_tr_b16 v[94:95], v13 offset:3072
    v_mfma_f32_32x32x16_bf16 v[32:47], v[52:55], v[188:191], v[32:47]
    buffer_load_dwordx4 v[236:239], v2, s[40:43], s53 offen offset:3072 sc1
    s_waitcnt lgkmcnt(4)
    s_waitcnt vmcnt(11)
    v_mfma_f32_32x32x16_bf16 v[16:31], v[56:59], v[192:195], v[16:31]
    ds_read_b64_tr_b16 v[48:49], v12 offset:4096
    ds_read_b64_tr_b16 v[50:51], v12 offset:5120
    ds_read_b64_tr_b16 v[52:53], v13 offset:4096
    ds_read_b64_tr_b16 v[54:55], v13 offset:5120
    v_mfma_f32_32x32x16_bf16 v[32:47], v[60:63], v[192:195], v[32:47]
    s_add_u32 s53, s69, 7
    s_and_b32 s53, s53, 7
    s_mul_i32 s53, s53, 7168
    s_add_u32 s53, s53, s52
    buffer_load_dwordx4 v[240:243], v2, s[40:43], s53 offen offset:0 sc1
    s_waitcnt lgkmcnt(4)
    s_waitcnt vmcnt(11)
    v_mfma_f32_32x32x16_bf16 v[16:31], v[88:91], v[196:199], v[16:31]
    ds_read_b64_tr_b16 v[56:57], v12 offset:6144
    ds_read_b64_tr_b16 v[58:59], v12 offset:7168
    ds_read_b64_tr_b16 v[60:61], v13 offset:6144
    ds_read_b64_tr_b16 v[62:63], v13 offset:7168
    v_mfma_f32_32x32x16_bf16 v[32:47], v[92:95], v[196:199], v[32:47]
    buffer_load_dwordx4 v[244:247], v2, s[40:43], s53 offen offset:1024 sc1
    s_waitcnt lgkmcnt(4)
    v_add_u32 v12, 81920, v10
    v_add_u32 v13, 81920, v11
    s_waitcnt vmcnt(11)
    v_mfma_f32_32x32x16_bf16 v[16:31], v[48:51], v[200:203], v[16:31]
    ds_read_b64_tr_b16 v[88:89], v12 offset:0
    ds_read_b64_tr_b16 v[90:91], v12 offset:1024
    ds_read_b64_tr_b16 v[92:93], v13 offset:0
    ds_read_b64_tr_b16 v[94:95], v13 offset:1024
    v_mfma_f32_32x32x16_bf16 v[32:47], v[52:55], v[200:203], v[32:47]
    buffer_load_dwordx4 v[248:251], v2, s[40:43], s53 offen offset:2048 sc1
    s_waitcnt lgkmcnt(4)
    s_mov_b64 exec, 1
    ds_add_u32 v126, v127 offset:28
    s_mov_b64 exec, -1
    s_waitcnt vmcnt(11)
    v_mfma_f32_32x32x16_bf16 v[16:31], v[56:59], v[204:207], v[16:31]
    ds_read_b64_tr_b16 v[48:49], v12 offset:2048
    ds_read_b64_tr_b16 v[50:51], v12 offset:3072
    ds_read_b64_tr_b16 v[52:53], v13 offset:2048
    ds_read_b64_tr_b16 v[54:55], v13 offset:3072
    v_mfma_f32_32x32x16_bf16 v[32:47], v[60:63], v[204:207], v[32:47]
    buffer_load_dwordx4 v[252:255], v2, s[40:43], s53 offen offset:3072 sc1
    s_waitcnt lgkmcnt(5)
    s_waitcnt vmcnt(11)
    v_mfma_f32_32x32x16_bf16 v[16:31], v[88:91], v[208:211], v[16:31]
    ds_read_b64_tr_b16 v[56:57], v12 offset:4096
    ds_read_b64_tr_b16 v[58:59], v12 offset:5120
    ds_read_b64_tr_b16 v[60:61], v13 offset:4096
    ds_read_b64_tr_b16 v[62:63], v13 offset:5120
    v_mfma_f32_32x32x16_bf16 v[32:47], v[92:95], v[208:211], v[32:47]
    s_add_u32 s53, s69, 0
    s_and_b32 s53, s53, 7
    s_mul_i32 s53, s53, 7168
    s_add_u32 s53, s53, s52
    s_add_u32 s53, s53, 4096
    buffer_load_dwordx4 v[128:131], v2, s[40:43], s53 offen offset:0 sc1
    s_waitcnt lgkmcnt(4)
    s_waitcnt vmcnt(11)
    v_mfma_f32_32x32x16_bf16 v[16:31], v[48:51], v[212:215], v[16:31]
    ds_read_b64_tr_b16 v[88:89], v12 offset:6144
    ds_read_b64_tr_b16 v[90:91], v12 offset:7168
    ds_read_b64_tr_b16 v[92:93], v13 offset:6144
    ds_read_b64_tr_b16 v[94:95], v13 offset:7168
    v_mfma_f32_32x32x16_bf16 v[32:47], v[52:55], v[212:215], v[32:47]
    buffer_load_dwordx4 v[132:135], v2, s[40:43], s53 offen offset:1024 sc1
    s_waitcnt lgkmcnt(4)
    v_add_u32 v12, 98304, v10
    v_add_u32 v13, 98304, v11
    s_waitcnt vmcnt(11)
    v_mfma_f32_32x32x16_bf16 v[16:31], v[56:59], v[216:219], v[16:31]
    ds_read_b64_tr_b16 v[48:49], v12 offset:0
    ds_read_b64_tr_b16 v[50:51], v12 offset:1024
    ds_read_b64_tr_b16 v[52:53], v13 offset:0
    ds_read_b64_tr_b16 v[54:55], v13 offset:1024
    v_mfma_f32_32x32x16_bf16 v[32:47], v[60:63], v[216:219], v[32:47]
    buffer_load_dwordx4 v[136:139], v2, s[40:43], s53 offen offset:2048 sc1
    s_waitcnt lgkmcnt(4)
    s_waitcnt vmcnt(11)
    v_mfma_f32_32x32x16_bf16 v[16:31], v[88:91], v[220:223], v[16:31]
    ds_read_b64_tr_b16 v[56:57], v12 offset:2048
    ds_read_b64_tr_b16 v[58:59], v12 offset:3072
    ds_read_b64_tr_b16 v[60:61], v13 offset:2048
    ds_read_b64_tr_b16 v[62:63], v13 offset:3072
    v_mfma_f32_32x32x16_bf16 v[32:47], v[92:95], v[220:223], v[32:47]
    s_add_u32 s53, s69, 1
    s_and_b32 s53, s53, 7
    s_mul_i32 s53, s53, 7168
    s_add_u32 s53, s53, s52
    s_add_u32 s53, s53, 4096
    buffer_load_dwordx4 v[140:143], v2, s[40:43], s53 offen offset:0 sc1
    s_waitcnt lgkmcnt(4)
    s_waitcnt vmcnt(11)
    v_mfma_f32_32x32x16_bf16 v[16:31], v[48:51], v[224:227], v[16:31]
    ds_read_b64_tr_b16 v[88:89], v12 offset:4096
    ds_read_b64_tr_b16 v[90:91], v12 offset:5120
    ds_read_b64_tr_b16 v[92:93], v13 offset:4096
    ds_read_b64_tr_b16 v[94:95], v13 offset:5120
    v_mfma_f32_32x32x16_bf16 v[32:47], v[52:55], v[224:227], v[32:47]
    buffer_load_dwordx4 v[144:147], v2, s[40:43], s53 offen offset:1024 sc1
    s_waitcnt lgkmcnt(4)
    s_waitcnt vmcnt(11)
    v_mfma_f32_32x32x16_bf16 v[16:31], v[56:59], v[228:231], v[16:31]
    ds_read_b64_tr_b16 v[48:49], v12 offset:6144
    ds_read_b64_tr_b16 v[50:51], v12 offset:7168
    ds_read_b64_tr_b16 v[52:53], v13 offset:6144
    ds_read_b64_tr_b16 v[54:55], v13 offset:7168
    v_mfma_f32_32x32x16_bf16 v[32:47], v[60:63], v[228:231], v[32:47]
    buffer_load_dwordx4 v[148:151], v2, s[40:43], s53 offen offset:2048 sc1
    s_waitcnt lgkmcnt(4)
    v_add_u32 v12, 114688, v10
    v_add_u32 v13, 114688, v11
    s_waitcnt vmcnt(11)
    v_mfma_f32_32x32x16_bf16 v[16:31], v[88:91], v[232:235], v[16:31]
    ds_read_b64_tr_b16 v[56:57], v12 offset:0
    ds_read_b64_tr_b16 v[58:59], v12 offset:1024
    ds_read_b64_tr_b16 v[60:61], v13 offset:0
    ds_read_b64_tr_b16 v[62:63], v13 offset:1024
    v_mfma_f32_32x32x16_bf16 v[32:47], v[92:95], v[232:235], v[32:47]
    s_add_u32 s53, s69, 2
    s_and_b32 s53, s53, 7
    s_mul_i32 s53, s53, 7168
    s_add_u32 s53, s53, s52
    s_add_u32 s53, s53, 4096
    buffer_load_dwordx4 v[152:155], v2, s[40:43], s53 offen offset:0 sc1
    s_waitcnt lgkmcnt(4)
    s_waitcnt vmcnt(11)
    v_mfma_f32_32x32x16_bf16 v[16:31], v[48:51], v[236:239], v[16:31]
    ds_read_b64_tr_b16 v[88:89], v12 offset:2048
    ds_read_b64_tr_b16 v[90:91], v12 offset:3072
    ds_read_b64_tr_b16 v[92:93], v13 offset:2048
    ds_read_b64_tr_b16 v[94:95], v13 offset:3072
    v_mfma_f32_32x32x16_bf16 v[32:47], v[52:55], v[236:239], v[32:47]
    buffer_load_dwordx4 v[156:159], v2, s[40:43], s53 offen offset:1024 sc1
    s_waitcnt lgkmcnt(4)
    s_waitcnt vmcnt(11)
    v_mfma_f32_32x32x16_bf16 v[16:31], v[56:59], v[240:243], v[16:31]
    ds_read_b64_tr_b16 v[48:49], v12 offset:4096
    ds_read_b64_tr_b16 v[50:51], v12 offset:5120
    ds_read_b64_tr_b16 v[52:53], v13 offset:4096
    ds_read_b64_tr_b16 v[54:55], v13 offset:5120
    v_mfma_f32_32x32x16_bf16 v[32:47], v[60:63], v[240:243], v[32:47]
    buffer_load_dwordx4 v[160:163], v2, s[40:43], s53 offen offset:2048 sc1
    s_waitcnt lgkmcnt(4)
    s_waitcnt vmcnt(11)
    v_mfma_f32_32x32x16_bf16 v[16:31], v[88:91], v[244:247], v[16:31]
    ds_read_b64_tr_b16 v[56:57], v12 offset:6144
    ds_read_b64_tr_b16 v[58:59], v12 offset:7168
    ds_read_b64_tr_b16 v[60:61], v13 offset:6144
    ds_read_b64_tr_b16 v[62:63], v13 offset:7168
    v_mfma_f32_32x32x16_bf16 v[32:47], v[92:95], v[244:247], v[32:47]
    s_add_u32 s53, s69, 3
    s_and_b32 s53, s53, 7
    s_mul_i32 s53, s53, 7168
    s_add_u32 s53, s53, s52
    s_add_u32 s53, s53, 4096
    buffer_load_dwordx4 v[164:167], v2, s[40:43], s53 offen offset:0 sc1
    s_waitcnt lgkmcnt(4)
    v_add_u32 v12, 131072, v10
    v_add_u32 v13, 131072, v11
    s_waitcnt vmcnt(11)
    v_mfma_f32_32x32x16_bf16 v[16:31], v[48:51], v[248:251], v[16:31]
    ds_read_b64_tr_b16 v[88:89], v12 offset:0
    ds_read_b64_tr_b16 v[90:91], v12 offset:1024
    ds_read_b64_tr_b16 v[92:93], v13 offset:0
    ds_read_b64_tr_b16 v[94:95], v13 offset:1024
    v_mfma_f32_32x32x16_bf16 v[32:47], v[52:55], v[248:251], v[32:47]
    buffer_load_dwordx4 v[168:171], v2, s[40:43], s53 offen offset:1024 sc1
    s_waitcnt lgkmcnt(4)
    s_waitcnt vmcnt(11)
    v_mfma_f32_32x32x16_bf16 v[16:31], v[56:59], v[252:255], v[16:31]
    ds_read_b64_tr_b16 v[48:49], v12 offset:2048
    ds_read_b64_tr_b16 v[50:51], v12 offset:3072
    ds_read_b64_tr_b16 v[52:53], v13 offset:2048
    ds_read_b64_tr_b16 v[54:55], v13 offset:3072
    v_mfma_f32_32x32x16_bf16 v[32:47], v[60:63], v[252:255], v[32:47]
    buffer_load_dwordx4 v[172:175], v2, s[40:43], s53 offen offset:2048 sc1
    s_waitcnt lgkmcnt(4)
    ds_read_b32 v125, v126 offset:32
    s_waitcnt vmcnt(11)
    v_mfma_f32_32x32x16_bf16 v[16:31], v[88:91], v[128:131], v[16:31]
    ds_read_b64_tr_b16 v[56:57], v12 offset:4096
    ds_read_b64_tr_b16 v[58:59], v12 offset:5120
    ds_read_b64_tr_b16 v[60:61], v13 offset:4096
    ds_read_b64_tr_b16 v[62:63], v13 offset:5120
    v_mfma_f32_32x32x16_bf16 v[32:47], v[92:95], v[128:131], v[32:47]
    s_add_u32 s53, s69, 4
    s_and_b32 s53, s53, 7
    s_mul_i32 s53, s53, 7168
    s_add_u32 s53, s53, s52
    s_add_u32 s53, s53, 4096
    buffer_load_dwordx4 v[176:179], v2, s[40:43], s53 offen offset:0 sc1
    s_waitcnt lgkmcnt(5)
    s_waitcnt vmcnt(11)
    v_mfma_f32_32x32x16_bf16 v[16:31], v[48:51], v[132:135], v[16:31]
    ds_read_b64_tr_b16 v[88:89], v12 offset:6144
    ds_read_b64_tr_b16 v[90:91], v12 offset:7168
    ds_read_b64_tr_b16 v[92:93], v13 offset:6144
    ds_read_b64_tr_b16 v[94:95], v13 offset:7168
    v_mfma_f32_32x32x16_bf16 v[32:47], v[52:55], v[132:135], v[32:47]
    buffer_load_dwordx4 v[180:183], v2, s[40:43], s53 offen offset:1024 sc1
    s_waitcnt lgkmcnt(4)
    v_readfirstlane_b32 s50, v125
    s_nop 0
    s_cmp_eq_u32 s50, 4
    s_cbranch_scc1 Law17d
    s_mov_b32 s63, 400000
Law17:
    ds_read_b32 v125, v126 offset:32
    s_sub_u32 s63, s63, 1
    s_waitcnt lgkmcnt(0)
    v_readfirstlane_b32 s50, v125
    s_nop 0
    s_cmp_eq_u32 s50, 4
    s_cbranch_scc1 Law17d
    s_sleep 1
    s_cmp_lg_u32 s63, 0
    s_cbranch_scc1 Law17
Law17d:
    v_add_u32 v12, 0, v10
    v_add_u32 v13, 0, v11
    s_waitcnt vmcnt(11)
    v_mfma_f32_32x32x16_bf16 v[16:31], v[56:59], v[136:139], v[16:31]
    ds_read_b64_tr_b16 v[48:49], v12 offset:0
    ds_read_b64_tr_b16 v[50:51], v12 offset:1024
    ds_read_b64_tr_b16 v[52:53], v13 offset:0
    ds_read_b64_tr_b16 v[54:55], v13 offset:1024
    v_mfma_f32_32x32x16_bf16 v[32:47], v[60:63], v[136:139], v[32:47]
    buffer_load_dwordx4 v[184:187], v2, s[40:43], s53 offen offset:2048 sc1
    s_waitcnt lgkmcnt(4)
    s_waitcnt vmcnt(11)
    v_mfma_f32_32x32x16_bf16 v[16:31], v[88:91], v[140:143], v[16:31]
    ds_read_b64_tr_b16 v[56:57], v12 offset:2048
    ds_read_b64_tr_b16 v[58:59], v12 offset:3072
    ds_read_b64_tr_b16 v[60:61], v13 offset:2048
    ds_read_b64_tr_b16 v[62:63], v13 offset:3072
    v_mfma_f32_32x32x16_bf16 v[32:47], v[92:95], v[140:143], v[32:47]
    s_add_u32 s53, s69, 5
    s_and_b32 s53, s53, 7
    s_mul_i32 s53, s53, 7168
    s_add_u32 s53, s53, s52
    s_add_u32 s53, s53, 4096
    buffer_load_dwordx4 v[188:191], v2, s[40:43], s53 offen offset:0 sc1
    s_waitcnt lgkmcnt(4)
    s_waitcnt vmcnt(11)
    v_mfma_f32_32x32x16_bf16 v[16:31], v[48:51], v[144:147], v[16:31]
    ds_read_b64_tr_b16 v[88:89], v12 offset:4096
    ds_read_b64_tr_b16 v[90:91], v12 offset:5120
    ds_read_b64_tr_b16 v[92:93], v13 offset:4096
    ds_read_b64_tr_b16 v[94:95], v13 offset:5120
    v_mfma_f32_32x32x16_bf16 v[32:47], v[52:55], v[144:147], v[32:47]
    buffer_load_dwordx4 v[192:195], v2, s[40:43], s53 offen offset:1024 sc1
    s_waitcnt lgkmcnt(4)
    s_waitcnt vmcnt(11)
    v_mfma_f32_32x32x16_bf16 v[16:31], v[56:59], v[148:151], v[16:31]
    ds_read_b64_tr_b16 v[48:49], v12 offset:6144
    ds_read_b64_tr_b16 v[50:51], v12 offset:7168
    ds_read_b64_tr_b16 v[52:53], v13 offset:6144
    ds_read_b64_tr_b16 v[54:55], v13 offset:7168
    v_mfma_f32_32x32x16_bf16 v[32:47], v[60:63], v[148:151], v[32:47]
    buffer_load_dwordx4 v[196:199], v2, s[40:43], s53 offen offset:2048 sc1
    s_waitcnt lgkmcnt(4)
    v_add_u32 v12, 16384, v10
    v_add_u32 v13, 16384, v11
    s_waitcnt vmcnt(11)
    v_mfma_f32_32x32x16_bf16 v[16:31], v[88:91], v[152:155], v[16:31]
    ds_read_b64_tr_b16 v[56:57], v12 offset:0
    ds_read_b64_tr_b16 v[58:59], v12 offset:1024
    ds_read_b64_tr_b16 v[60:61], v13 offset:0
    ds_read_b64_tr_b16 v[62:63], v13 offset:1024
    v_mfma_f32_32x32x16_bf16 v[32:47], v[92:95], v[152:155], v[32:47]
    s_add_u32 s53, s69, 6
    s_and_b32 s53, s53, 7
    s_mul_i32 s53, s53, 7168
    s_add_u32 s53, s53, s52
    s_add_u32 s53, s53, 4096
    buffer_load_dwordx4 v[200:203], v2, s[40:43], s53 offen offset:0 sc1
    s_waitcnt lgkmcnt(4)
    s_waitcnt vmcnt(11)
    v_mfma_f32_32x32x16_bf16 v[16:31], v[48:51], v[156:159], v[16:31]
    ds_read_b64_tr_b16 v[88:89], v12 offset:2048
    ds_read_b64_tr_b16 v[90:91], v12 offset:3072
    ds_read_b64_tr_b16 v[92:93], v13 offset:2048
    ds_read_b64_tr_b16 v[94:95], v13 offset:3072
    v_mfma_f32_32x32x16_bf16 v[32:47], v[52:55], v[156:159], v[32:47]
    buffer_load_dwordx4 v[204:207], v2, s[40:43], s53 offen offset:1024 sc1
    s_waitcnt lgkmcnt(4)
    s_waitcnt vmcnt(11)
    v_mfma_f32_32x32x16_bf16 v[16:31], v[56:59], v[160:163], v[16:31]
    ds_read_b64_tr_b16 v[48:49], v12 offset:4096
    ds_read_b64_tr_b16 v[50:51], v12 offset:5120
    ds_read_b64_tr_b16 v[52:53], v13 offset:4096
    ds_read_b64_tr_b16 v[54:55], v13 offset:5120
    v_mfma_f32_32x32x16_bf16 v[32:47], v[60:63], v[160:163], v[32:47]
    buffer_load_dwordx4 v[208:211], v2, s[40:43], s53 offen offset:2048 sc1
    s_waitcnt lgkmcnt(4)
    s_waitcnt vmcnt(11)
    v_mfma_f32_32x32x16_bf16 v[16:31], v[88:91], v[164:167], v[16:31]
    ds_read_b64_tr_b16 v[56:57], v12 offset:6144
    ds_read_b64_tr_b16 v[58:59], v12 offset:7168
    ds_read_b64_tr_b16 v[60:61], v13 offset:6144
    ds_read_b64_tr_b16 v[62:63], v13 offset:7168
    v_mfma_f32_32x32x16_bf16 v[32:47], v[92:95], v[164:167], v[32:47]
    s_add_u32 s53, s69, 7
    s_and_b32 s53, s53, 7
    s_mul_i32 s53, s53, 7168
    s_add_u32 s53, s53, s52
    s_add_u32 s53, s53, 4096
    buffer_load_dwordx4 v[212:215], v2, s[40:43], s53 offen offset:0 sc1
    s_waitcnt lgkmcnt(4)
    v_add_u32 v12, 32768, v10
    v_add_u32 v13, 32768, v11
    s_waitcnt vmcnt(11)
    v_mfma_f32_32x32x16_bf16 v[16:31], v[48:51], v[168:171], v[16:31]
    ds_read_b64_tr_b16 v[88:89], v12 offset:0
    ds_read_b64_tr_b16 v[90:91], v12 offset:1024
    ds_read_b64_tr_b16 v[92:93], v13 offset:0
    ds_read_b64_tr_b16 v[94:95], v13 offset:1024
    v_mfma_f32_32x32x16_bf16 v[32:47], v[52:55], v[168:171], v[32:47]
    buffer_load_dwordx4 v[216:219], v2, s[40:43], s53 offen offset:1024 sc1
    s_waitcnt lgkmcnt(4)
    s_waitcnt vmcnt(11)
    v_mfma_f32_32x32x16_bf16 v[16:31], v[56:59], v[172:175], v[16:31]
    ds_read_b64_tr_b16 v[48:49], v12 offset:2048
    ds_read_b64_tr_b16 v[50:51], v12 offset:3072
    ds_read_b64_tr_b16 v[52:53], v13 offset:2048
    ds_read_b64_tr_b16 v[54:55], v13 offset:3072
    v_mfma_f32_32x32x16_bf16 v[32:47], v[60:63], v[172:175], v[32:47]
    buffer_load_dwordx4 v[220:223], v2, s[40:43], s53 offen offset:2048 sc1
    s_waitcnt lgkmcnt(4)
    ds_read_b32 v125, v126 offset:36
    s_waitcnt vmcnt(11)
    v_mfma_f32_32x32x16_bf16 v[16:31], v[88:91], v[176:179], v[16:31]
    ds_read_b64_tr_b16 v[56:57], v12 offset:4096
    ds_read_b64_tr_b16 v[58:59], v12 offset:5120
    ds_read_b64_tr_b16 v[60:61], v13 offset:4096
    ds_read_b64_tr_b16 v[62:63], v13 offset:5120
    v_mfma_f32_32x32x16_bf16 v[32:47], v[92:95], v[176:179], v[32:47]
    buffer_load_dwordx4 v[80:83], v2, s[40:43], s61 offen offset:0 sc1
    buffer_load_dwordx4 v[84:87], v2, s[40:43], s61 offen offset:1024 sc1
    s_waitcnt lgkmcnt(5)
    s_waitcnt vmcnt(12)
    v_mfma_f32_32x32x16_bf16 v[16:31], v[48:51], v[180:183], v[16:31]
    ds_read_b64_tr_b16 v[88:89], v12 offset:6144
    ds_read_b64_tr_b16 v[90:91], v12 offset:7168
    ds_read_b64_tr_b16 v[92:93], v13 offset:6144
    ds_read_b64_tr_b16 v[94:95], v13 offset:7168
    v_mfma_f32_32x32x16_bf16 v[32:47], v[52:55], v[180:183], v[32:47]
    s_waitcnt lgkmcnt(4)
    v_readfirstlane_b32 s50, v125
    s_nop 0
    s_cmp_eq_u32 s50, 4
    s_cbranch_scc1 Law18d
    s_mov_b32 s63, 400000
Law18:
    ds_read_b32 v125, v126 offset:36
    s_sub_u32 s63, s63, 1
    s_waitcnt lgkmcnt(0)
    v_readfirstlane_b32 s50, v125
    s_nop 0
    s_cmp_eq_u32 s50, 4
    s_cbranch_scc1 Law18d
    s_sleep 1
    s_cmp_lg_u32 s63, 0
    s_cbranch_scc1 Law18
Law18d:
    v_add_u32 v12, 49152, v10
    v_add_u32 v13, 49152, v11
    s_waitcnt vmcnt(11)
    v_mfma_f32_32x32x16_bf16 v[16:31], v[56:59], v[184:187], v[16:31]
    ds_read_b64_tr_b16 v[48:49], v12 offset:0
    ds_read_b64_tr_b16 v[50:51], v12 offset:1024
    ds_read_b64_tr_b16 v[52:53], v13 offset:0
    ds_read_b64_tr_b16 v[54:55], v13 offset:1024
    v_mfma_f32_32x32x16_bf16 v[32:47], v[60:63], v[184:187], v[32:47]
    s_waitcnt lgkmcnt(4)
    s_waitcnt vmcnt(10)
    v_mfma_f32_32x32x16_bf16 v[16:31], v[88:91], v[188:191], v[16:31]
    ds_read_b64_tr_b16 v[56:57], v12 offset:2048
    ds_read_b64_tr_b16 v[58:59], v12 offset:3072
    ds_read_b64_tr_b16 v[60:61], v13 offset:2048
    ds_read_b64_tr_b16 v[62:63], v13 offset:3072
    v_mfma_f32_32x32x16_bf16 v[32:47], v[92:95], v[188:191], v[32:47]
    s_waitcnt lgkmcnt(4)
    s_waitcnt vmcnt(9)
    v_mfma_f32_32x32x16_bf16 v[16:31], v[48:51], v[192:195], v[16:31]
    ds_read_b64_tr_b16 v[88:89], v12 offset:4096
    ds_read_b64_tr_b16 v[90:91], v12 offset:5120
    ds_read_b64_tr_b16 v[92:93], v13 offset:4096
    ds_read_b64_tr_b16 v[94:95], v13 offset:5120
    v_mfma_f32_32x32x16_bf16 v[32:47], v[52:55], v[192:195], v[32:47]
    s_waitcnt lgkmcnt(4)
    s_waitcnt vmcnt(8)
    v_mfma_f32_32x32x16_bf16 v[16:31], v[56:59], v[196:199], v[16:31]
    ds_read_b64_tr_b16 v[48:49], v12 offset:6144
    ds_read_b64_tr_b16 v[50:51], v12 offset:7168
    ds_read_b64_tr_b16 v[52:53], v13 offset:6144
    ds_read_b64_tr_b16 v[54:55], v13 offset:7168
    v_mfma_f32_32x32x16_bf16 v[32:47], v[60:63], v[196:199], v[32:47]
    s_waitcnt lgkmcnt(4)
    v_add_u32 v12, 65536, v10
    v_add_u32 v13, 65536, v11
    s_waitcnt vmcnt(7)
    v_mfma_f32_32x32x16_bf16 v[16:31], v[88:91], v[200:203], v[16:31]
    ds_read_b64_tr_b16 v[56:57], v12 offset:0
    ds_read_b64_tr_b16 v[58:59], v12 offset:1024
    ds_read_b64_tr_b16 v[60:61], v13 offset:0
    ds_read_b64_tr_b16 v[62:63], v13 offset:1024
    v_mfma_f32_32x32x16_bf16 v[32:47], v[92:95], v[200:203], v[32:47]
    s_waitcnt lgkmcnt(4)
    s_waitcnt vmcnt(6)
    v_mfma_f32_32x32x16_bf16 v[16:31], v[48:51], v[204:207], v[16:31]
    ds_read_b64_tr_b16 v[88:89], v12 offset:2048
    ds_read_b64_tr_b16 v[90:91], v12 offset:3072
    ds_read_b64_tr_b16 v[92:93], v13 offset:2048
    ds_read_b64_tr_b16 v[94:95], v13 offset:3072
    v_mfma_f32_32x32x16_bf16 v[32:47], v[52:55], v[204:207], v[32:47]
    s_waitcnt lgkmcnt(4)
    s_waitcnt vmcnt(5)
    v_mfma_f32_32x32x16_bf16 v[16:31], v[56:59], v[208:211], v[16:31]
    ds_read_b64_tr_b16 v[48:49], v12 offset:4096
    ds_read_b64_tr_b16 v[50:51], v12 offset:5120
    ds_read_b64_tr_b16 v[52:53], v13 offset:4096
    ds_read_b64_tr_b16 v[54:55], v13 offset:5120
    v_mfma_f32_32x32x16_bf16 v[32:47], v[60:63], v[208:211], v[32:47]
    s_waitcnt lgkmcnt(4)
    s_waitcnt vmcnt(4)
    v_mfma_f32_32x32x16_bf16 v[16:31], v[88:91], v[212:215], v[16:31]
    ds_read_b64_tr_b16 v[56:57], v12 offset:6144
    ds_read_b64_tr_b16 v[58:59], v12 offset:7168
    ds_read_b64_tr_b16 v[60:61], v13 offset:6144
    ds_read_b64_tr_b16 v[62:63], v13 offset:7168
    v_mfma_f32_32x32x16_bf16 v[32:47], v[92:95], v[212:215], v[32:47]
    s_waitcnt lgkmcnt(4)
    s_waitcnt vmcnt(3)
    v_mfma_f32_32x32x16_bf16 v[16:31], v[48:51], v[216:219], v[16:31]
    v_mfma_f32_32x32x16_bf16 v[32:47], v[52:55], v[216:219], v[32:47]
    s_waitcnt lgkmcnt(0)
    s_waitcnt vmcnt(2)
    v_mfma_f32_32x32x16_bf16 v[16:31], v[56:59], v[220:223], v[16:31]
    v_mfma_f32_32x32x16_bf16 v[32:47], v[60:63], v[220:223], v[32:47]
    s_waitcnt vmcnt(0)
    s_xor_b32 s52, s44, 2
    s_lshl_b32 s52, s52, 12
    s_add_u32 s52, s52, 81920
    v_add_u32 v5, s52, v2
    s_lshl_b32 s52, s44, 12
    s_add_u32 s52, s52, 81920
    v_add_u32 v6, s52, v2
    v_bfe_u32 v9, v1, 5, 1
    v_lshlrev_b32 v7, 4, v9
    s_lshl_b32 s52, s55, 7
    s_add_u32 s52, s52, 160000
    v_add_u32 v7, s52, v7
    ds_read_b128 v[64:67], v7 offset:0
    ds_read_b128 v[68:71], v7 offset:32
    ds_read_b128 v[72:75], v7 offset:64
    ds_read_b128 v[76:79], v7 offset:96
    v_lshlrev_b32 v96, 16, v80
    v_and_b32 v97, 0xffff0000, v80
    v_lshlrev_b32 v98, 16, v81
    v_and_b32 v99, 0xffff0000, v81
    v_lshlrev_b32 v100, 16, v82
    v_and_b32 v101, 0xffff0000, v82
    v_lshlrev_b32 v102, 16, v83
    v_and_b32 v103, 0xffff0000, v83
    v_lshlrev_b32 v104, 16, v84
    v_and_b32 v105, 0xffff0000, v84
    v_lshlrev_b32 v106, 16, v85
    v_and_b32 v107, 0xffff0000, v85
    v_lshlrev_b32 v108, 16, v86
    v_and_b32 v109, 0xffff0000, v86
    v_lshlrev_b32 v110, 16, v87
    v_and_b32 v111, 0xffff0000, v87
    ds_write_b128 v5, v[32:35] offset:0
    ds_write_b128 v5, v[36:39] offset:1024
    ds_write_b128 v5, v[40:43] offset:2048
    ds_write_b128 v5, v[44:47] offset:3072
    s_waitcnt lgkmcnt(0)
    s_barrier
    ds_read_b128 v[32:35], v6 offset:0
    ds_read_b128 v[36:39], v6 offset:1024
    ds_read_b128 v[40:43], v6 offset:2048
    ds_read_b128 v[44:47], v6 offset:3072
    v_and_b32 v7, 31, v1
    v_lshlrev_b32 v8, 10, v7
    v_lshl_add_u32 v8, v9, 4, v8
    s_lshl_b32 s52, s57, 15
    s_lshl_b32 s53, s58, 6
    s_add_u32 s52, s52, s53
    s_waitcnt lgkmcnt(3)
    v_add_f32 v16, v16, v32
    v_add_f32 v17, v17, v33
    v_add_f32 v18, v18, v34
    v_add_f32 v19, v19, v35
    v_fmac_f32 v96, v16, v64
    v_fmac_f32 v97, v17, v65
    v_fmac_f32 v98, v18, v66
    v_fmac_f32 v99, v19, v67
    s_waitcnt lgkmcnt(2)
    v_add_f32 v20, v20, v36
    v_add_f32 v21, v21, v37
    v_add_f32 v22, v22, v38
    v_add_f32 v23, v23, v39
    v_fmac_f32 v100, v20, v68
    v_fmac_f32 v101, v21, v69
    v_fmac_f32 v102, v22, v70
    v_fmac_f32 v103, v23, v71
    s_waitcnt lgkmcnt(1)
    v_add_f32 v24, v24, v40
    v_add_f32 v25, v25, v41
    v_add_f32 v26, v26, v42
    v_add_f32 v27, v27, v43
    v_fmac_f32 v104, v24, v72
    v_fmac_f32 v105, v25, v73
    v_fmac_f32 v106, v26, v74
    v_fmac_f32 v107, v27, v75
    s_waitcnt lgkmcnt(0)
    v_add_f32 v28, v28, v44
    v_add_f32 v29, v29, v45
    v_add_f32 v30, v30, v46
    v_add_f32 v31, v31, v47
    v_fmac_f32 v108, v28, v76
    v_fmac_f32 v109, v29, v77
    v_fmac_f32 v110, v30, v78
    v_fmac_f32 v111, v31, v79
    v_cvt_pk_bf16_f32 v64, v96, v97
    v_cvt_pk_bf16_f32 v65, v98, v99
    v_cvt_pk_bf16_f32 v66, v100, v101
    v_cvt_pk_bf16_f32 v67, v102, v103
    v_cvt_pk_bf16_f32 v68, v104, v105
    v_cvt_pk_bf16_f32 v69, v106, v107
    v_cvt_pk_bf16_f32 v70, v108, v109
    v_cvt_pk_bf16_f32 v71, v110, v111
    v_permlane32_swap_b32 v64, v66
    v_permlane32_swap_b32 v65, v67
    buffer_store_dwordx4 v[64:67], v8, s[32:35], s52 offen offset:0
    v_permlane32_swap_b32 v68, v70
    v_permlane32_swap_b32 v69, v71
    buffer_store_dwordx4 v[68:71], v8, s[32:35], s52 offen offset:32
    s_endpgm
Lhelper2:
    s_waitcnt vmcnt(0)
    v_mov_b32 v8, s47
    s_mov_b64 exec, 1
    buffer_store_dword v8, v3, s[40:43], s64 offen sc1
    s_mov_b64 exec, -1
    s_sub_u32 s52, s48, 8
    s_cmp_ge_u32 s52, 16
    s_cbranch_scc1 Lh_nomod2
    v_lshlrev_b32 v224, 16, v224
    v_lshlrev_b32 v225, 16, v225
    v_lshlrev_b32 v226, 16, v226
    v_lshlrev_b32 v227, 16, v227
    v_mul_f32 v228, 0xbfb8aa3b, v224
    v_mul_f32 v229, 0xbfb8aa3b, v225
    v_mul_f32 v230, 0xbfb8aa3b, v226
    v_mul_f32 v231, 0xbfb8aa3b, v227
    v_exp_f32 v228, v228
    v_exp_f32 v229, v229
    v_exp_f32 v230, v230
    v_exp_f32 v231, v231
    v_add_f32 v228, 1.0, v228
    v_add_f32 v229, 1.0, v229
    v_add_f32 v230, 1.0, v230
    v_add_f32 v231, 1.0, v231
    v_rcp_f32 v228, v228
    v_rcp_f32 v229, v229
    v_rcp_f32 v230, v230
    v_rcp_f32 v231, v231
    v_mul_f32 v224, v224, v228
    v_mul_f32 v225, v225, v229
    v_mul_f32 v226, v226, v230
    v_mul_f32 v227, v227, v231
    v_cvt_pk_bf16_f32 v224, v224, v224
    v_cvt_pk_bf16_f32 v225, v225, v225
    v_cvt_pk_bf16_f32 v226, v226, v226
    v_cvt_pk_bf16_f32 v227, v227, v227
    v_lshlrev_b32 v224, 16, v224
    v_lshlrev_b32 v225, 16, v225
    v_lshlrev_b32 v226, 16, v226
    v_lshlrev_b32 v227, 16, v227
    v_lshlrev_b32 v232, 16, v208
    v_and_b32 v233, 0xffff0000, v208
    v_lshlrev_b32 v234, 16, v209
    v_and_b32 v235, 0xffff0000, v209
    v_lshlrev_b32 v236, 16, v210
    v_and_b32 v237, 0xffff0000, v210
    v_lshlrev_b32 v238, 16, v211
    v_and_b32 v239, 0xffff0000, v211
    v_mul_f32 v240, v232, v224
    v_mul_f32 v241, v233, v224
    v_mul_f32 v242, v234, v224
    v_mul_f32 v243, v235, v224
    v_mul_f32 v244, v236, v224
    v_mul_f32 v245, v237, v224
    v_mul_f32 v246, v238, v224
    v_mul_f32 v247, v239, v224
    v_lshlrev_b32 v232, 16, v212
    v_and_b32 v233, 0xffff0000, v212
    v_lshlrev_b32 v234, 16, v213
    v_and_b32 v235, 0xffff0000, v213
    v_lshlrev_b32 v236, 16, v214
    v_and_b32 v237, 0xffff0000, v214
    v_lshlrev_b32 v238, 16, v215
    v_and_b32 v239, 0xffff0000, v215
    v_fmac_f32 v240, v232, v225
    v_fmac_f32 v241, v233, v225
    v_fmac_f32 v242, v234, v225
    v_fmac_f32 v243, v235, v225
    v_fmac_f32 v244, v236, v225
    v_fmac_f32 v245, v237, v225
    v_fmac_f32 v246, v238, v225
    v_fmac_f32 v247, v239, v225
    v_lshlrev_b32 v232, 16, v216
    v_and_b32 v233, 0xffff0000, v216
    v_lshlrev_b32 v234, 16, v217
    v_and_b32 v235, 0xffff0000, v217
    v_lshlrev_b32 v236, 16, v218
    v_and_b32 v237, 0xffff0000, v218
    v_lshlrev_b32 v238, 16, v219
    v_and_b32 v239, 0xffff0000, v219
    v_fmac_f32 v240, v232, v226
    v_fmac_f32 v241, v233, v226
    v_fmac_f32 v242, v234, v226
    v_fmac_f32 v243, v235, v226
    v_fmac_f32 v244, v236, v226
    v_fmac_f32 v245, v237, v226
    v_fmac_f32 v246, v238, v226
    v_fmac_f32 v247, v239, v226
    v_lshlrev_b32 v232, 16, v220
    v_and_b32 v233, 0xffff0000, v220
    v_lshlrev_b32 v234, 16, v221
    v_and_b32 v235, 0xffff0000, v221
    v_lshlrev_b32 v236, 16, v222
    v_and_b32 v237, 0xffff0000, v222
    v_lshlrev_b32 v238, 16, v223
    v_and_b32 v239, 0xffff0000, v223
    v_fmac_f32 v240, v232, v227
    v_fmac_f32 v241, v233, v227
    v_fmac_f32 v242, v234, v227
    v_fmac_f32 v243, v235, v227
    v_fmac_f32 v244, v236, v227
    v_fmac_f32 v245, v237, v227
    v_fmac_f32 v246, v238, v227
    v_fmac_f32 v247, v239, v227
    v_permlane32_swap_b32 v240, v244
    v_permlane32_swap_b32 v241, v245
    v_permlane32_swap_b32 v242, v246
    v_permlane32_swap_b32 v243, v247
    v_add_f32 v240, v240, v244
    v_add_f32 v241, v241, v245
    v_add_f32 v242, v242, v246
    v_add_f32 v243, v243, v247
    s_nop 0
    v_permlane16_swap_b32 v240, v242
    v_permlane16_swap_b32 v241, v243
    v_add_f32 v240, v240, v242
    v_add_f32 v241, v241, v243
    s_nop 0
    v_add_f32_dpp v240, v240, v240 row_ror:8 row_mask:0xf bank_mask:0xf
    v_add_f32_dpp v241, v241, v241 row_ror:8 row_mask:0xf bank_mask:0xf
    s_nop 0
    v_add_f32_dpp v240, v240, v240 row_ror:4 row_mask:0xf bank_mask:0xf
    v_add_f32_dpp v241, v241, v241 row_ror:4 row_mask:0xf bank_mask:0xf
    s_nop 0
    v_add_f32_dpp v240, v240, v240 row_ror:2 row_mask:0xf bank_mask:0xf
    v_add_f32_dpp v241, v241, v241 row_ror:2 row_mask:0xf bank_mask:0xf
    v_bfe_u32 v8, v0, 6, 2
    v_lshlrev_b32 v8, 6, v8
    v_and_b32 v9, 1, v0
    v_lshl_add_u32 v8, v9, 5, v8
    v_bfe_u32 v9, v0, 4, 1
    v_lshl_add_u32 v8, v9, 3, v8
    v_bfe_u32 v9, v0, 5, 1
    v_lshl_add_u32 v8, v9, 4, v8
    v_add_u32 v8, 160256, v8
    s_mov_b32 exec_lo, 0x00030003
    s_mov_b32 exec_hi, 0x00030003
    ds_write_b64 v8, v[240:241]
    s_mov_b64 exec, -1
    v_mov_b32 v8, 160512
    v_mov_b32 v9, 1
    s_waitcnt lgkmcnt(0)
    s_mov_b64 exec, 1
    ds_add_rtn_u32 v9, v8, v9
    s_mov_b64 exec, -1
    s_waitcnt lgkmcnt(0)
    v_readfirstlane_b32 s52, v9
    s_nop 0
    s_cmp_lg_u32 s52, 3
    s_cbranch_scc1 Lh_nomod2
    s_mov_b64 exec, 0xff
    v_lshlrev_b32 v8, 3, v1
    v_add_u32 v9, 160256, v8
    ds_read_b64 v[240:241], v9 offset:0
    ds_read_b64 v[242:243], v9 offset:64
    ds_read_b64 v[244:245], v9 offset:128
    ds_read_b64 v[246:247], v9 offset:192
    s_lshr_b32 s52, s66, 9
    s_cmp_eq_u32 s52, 1
    s_cselect_b32 s53, 1.0, 0
    s_cmp_eq_u32 s52, 4
    s_cselect_b32 s53, 1.0, s53
    s_lshl_b32 s52, s66, 2
    s_waitcnt lgkmcnt(0)
    v_add_f32 v240, v240, v242
    v_add_f32 v244, v244, v246
    v_add_f32 v241, v241, v243
    v_add_f32 v245, v245, v247
    v_add_f32 v240, v240, v244
    v_add_f32 v241, v241, v245
    v_cvt_pk_bf16_f32 v242, v240, v241
    v_lshlrev_b32 v240, 16, v242
    v_and_b32 v241, 0xffff0000, v242
    v_add_f32 v240, s53, v240
    v_add_f32 v241, s53, v241
    v_cvt_pk_bf16_f32 v240, v240, v241
    v_mov_b32 v241, s47
    buffer_store_dwordx2 v[240:241], v8, s[40:43], s52 offen sc1
    s_mov_b64 exec, -1
Lh_nomod2:
    v_mov_b32 v12, 160512
    v_mov_b32 v13, 1
    s_mov_b32 s63, 400000
Law19:
    ds_read_b32 v14, v12 offset:12
    s_sub_u32 s63, s63, 1
    s_waitcnt lgkmcnt(0)
    v_readfirstlane_b32 s50, v14
    s_nop 0
    s_cmp_eq_u32 s50, 4
    s_cbranch_scc1 Law19d
    s_sleep 1
    s_cmp_lg_u32 s63, 0
    s_cbranch_scc1 Law19
Law19d:
    v_lshlrev_b32 v4, 5, v1
    s_lshl_b32 s52, s67, 11
    s_add_u32 s52, s52, 4096
    s_mov_b32 s50, 20000
Lgp20:
    buffer_load_dwordx4 v[16:19], v4, s[40:43], s52 offen sc1
    buffer_load_dwordx4 v[20:23], v4, s[40:43], s52 offen offset:16 sc1
    s_waitcnt vmcnt(0)
    v_xor_b32 v15, s47, v17
    v_xor_b32 v14, s47, v19
    v_or_b32 v15, v15, v14
    v_xor_b32 v14, s47, v21
    v_or_b32 v15, v15, v14
    v_xor_b32 v14, s47, v23
    v_or_b32 v15, v15, v14
    v_cmp_ne_u32 vcc, 0, v15
    s_sub_u32 s50, s50, 1
    s_cbranch_vccz Lgpd20
    s_sleep 1
    s_cmp_lg_u32 s50, 0
    s_cbranch_scc1 Lgp20
Lgpd20:
    v_lshlrev_b32 v24, 16, v16
    v_and_b32 v25, 0xffff0000, v16
    v_lshlrev_b32 v26, 16, v18
    v_and_b32 v27, 0xffff0000, v18
    v_lshlrev_b32 v28, 16, v20
    v_and_b32 v29, 0xffff0000, v20
    v_lshlrev_b32 v30, 16, v22
    v_and_b32 v31, 0xffff0000, v22
    s_cmp_eq_u32 s67, 1
    s_cbranch_scc1 Lh_tabg
    s_cmp_eq_u32 s67, 3
    s_cselect_b32 s53, 0xbf317218, 1.0
    s_lshl_b32 s54, s46, 2
    s_and_b32 s55, s46, 7
    s_lshl_b32 s55, s55, 3
    s_lshl_b32 s56, s67, 6
    s_cmp_eq_u32 s67, 3
    s_cselect_b32 s54, s55, s54
    s_cselect_b32 s55, 8, 4
    s_cselect_b32 s56, 256, s56
    s_add_u32 s56, s56, 159744
    v_mul_f32 v24, s53, v24
    v_mul_f32 v25, s53, v25
    v_mul_f32 v26, s53, v26
    v_mul_f32 v27, s53, v27
    v_mul_f32 v28, s53, v28
    v_mul_f32 v29, s53, v29
    v_mul_f32 v30, s53, v30
    v_mul_f32 v31, s53, v31
    v_subrev_u32 v5, s54, v1
    v_cmp_gt_u32 vcc, s55, v5
    v_lshlrev_b32 v5, 5, v5
    v_add_u32 v5, s56, v5
    s_and_saveexec_b64 s[56:57], vcc
    ds_write_b128 v5, v[24:27]
    ds_write_b128 v5, v[28:31] offset:16
    s_mov_b64 exec, -1
    s_cmp_lg_u32 s67, 2
    s_cbranch_scc1 Lh_tabd
Lh_tabg:
    v_lshrrev_b32 v5, 1, v1
    s_lshl_b32 s53, s69, 2
    v_subrev_u32 v5, s53, v5
    v_and_b32 v5, 31, v5
    v_lshlrev_b32 v5, 6, v5
    v_and_b32 v6, 1, v1
    v_lshl_add_u32 v5, v6, 3, v5
    s_and_b32 s53, s67, 1
    s_lshl_b32 s53, s53, 4
    s_add_u32 s53, s53, 161792
    v_add_u32 v5, s53, v5
    v_mov_b32 v17, v18
    v_mov_b32 v21, v22
    ds_write_b64 v5, v[16:17]
    ds_write_b64 v5, v[20:21] offset:32
Lh_tabd:
    v_lshrrev_b32 v10, 3, v1
    v_lshlrev_b32 v10, 10, v10
    v_bfe_u32 v5, v1, 4, 1
    v_lshlrev_b32 v5, 2, v5
    v_xor_b32 v5, v5, v1
    v_and_b32 v5, 7, v5
    v_lshl_add_u32 v10, v5, 4, v10
    s_lshl_b32 s58, s69, 7
    s_lshl_b32 s59, s67, 11
    s_waitcnt lgkmcnt(0)
    s_barrier
    v_bfe_u32 v9, v1, 5, 1
    v_lshlrev_b32 v6, 5, v9
    v_and_b32 v5, 1, v1
    v_lshl_add_u32 v6, v5, 4, v6
    v_add_u32 v6, 161792, v6
    v_mov_b32 v16, 0
    v_mov_b32 v17, 0
    v_mov_b32 v18, 0
    v_mov_b32 v19, 0
    v_mov_b32 v20, 0
    v_mov_b32 v21, 0
    v_mov_b32 v22, 0
    v_mov_b32 v23, 0
    v_mov_b32 v24, 0
    v_mov_b32 v25, 0
    v_mov_b32 v26, 0
    v_mov_b32 v27, 0
    v_mov_b32 v28, 0
    v_mov_b32 v29, 0
    v_mov_b32 v30, 0
    v_mov_b32 v31, 0
    v_mov_b32 v32, 0
    v_mov_b32 v33, 0
    v_mov_b32 v34, 0
    v_mov_b32 v35, 0
    v_mov_b32 v36, 0
    v_mov_b32 v37, 0
    v_mov_b32 v38, 0
    v_mov_b32 v39, 0
    s_mov_b32 s56, 3
    s_mov_b32 s57, 3
    s_cmp_eq_u32 s67, 3
    s_cbranch_scc1 Lh_uwh
    v_bfe_u32 v4, v0, 2, 2
    v_bfe_u32 v5, v0, 5, 1
    v_lshl_add_u32 v4, v5, 2, v4
    v_lshlrev_b32 v4, 6, v4
    v_bfe_u32 v5, v0, 4, 1
    v_lshl_add_u32 v4, v5, 5, v4
    v_and_b32 v5, 3, v0
    v_lshl_add_u32 v4, v5, 3, v4
    s_lshl_b32 s52, s67, 10
    s_add_u32 s52, s52, 32768
    v_add_u32 v4, s52, v4
    s_mov_b32 s51, 16
Lh_uwl:
    s_mov_b64 exec, s[56:57]
    ds_read_b128 v[32:35], v6 offset:0
    s_mov_b64 exec, -1
    ds_read_b64_tr_b16 v[48:49], v4 offset:0
    ds_read_b64_tr_b16 v[50:51], v4 offset:512
    s_mov_b64 exec, s[56:57]
    ds_read_b128 v[36:39], v6 offset:64
    s_mov_b64 exec, -1
    ds_read_b64_tr_b16 v[52:53], v4 offset:3072
    ds_read_b64_tr_b16 v[54:55], v4 offset:3584
    v_add_u32 v4, 7168, v4
    v_add_u32 v6, 128, v6
    s_sub_u32 s51, s51, 1
    s_waitcnt lgkmcnt(3)
    v_mfma_f32_32x32x16_bf16 v[16:31], v[48:51], v[32:35], v[16:31]
    s_waitcnt lgkmcnt(0)
    v_mfma_f32_32x32x16_bf16 v[16:31], v[52:55], v[36:39], v[16:31]
    s_cmp_lg_u32 s51, 0
    s_cbranch_scc1 Lh_uwl
    s_branch Lh_uwd
Lh_uwh:
    v_bfe_u32 v4, v0, 2, 1
    v_bfe_u32 v5, v0, 4, 1
    v_lshl_add_u32 v4, v5, 1, v4
    v_bfe_u32 v5, v0, 3, 1
    v_lshl_add_u32 v4, v5, 2, v4
    v_bfe_u32 v5, v0, 5, 1
    v_lshl_add_u32 v4, v5, 4, v4
    v_lshlrev_b32 v4, 5, v4
    v_and_b32 v5, 3, v0
    v_lshl_add_u32 v4, v5, 3, v4
    v_add_u32 v4, 38912, v4
    s_mov_b32 s51, 16
    v_and_b32 v8, 16, v0
    v_cmp_eq_u32 vcc, 0, v8
    v_mov_b32 v8, 0xeeeeeeee
    v_mov_b32 v5, 0x44444444
    v_cndmask_b32 v8, v8, v5, vcc
Lh_uwhl:
    s_mov_b64 exec, s[56:57]
    ds_read_b128 v[32:35], v6 offset:0
    s_mov_b64 exec, -1
    s_mov_b64 exec, s[56:57]
    ds_read_b128 v[36:39], v6 offset:64
    s_mov_b64 exec, -1
    ds_read_b64_tr_b16 v[48:49], v4 offset:0
    ds_read_b64_tr_b16 v[50:51], v4 offset:256
    v_add_u32 v4, 7168, v4
    v_add_u32 v6, 128, v6
    s_sub_u32 s51, s51, 1
    s_waitcnt lgkmcnt(0)
    v_smfmac_f32_32x32x32_bf16 v[16:31], v[48:51], v[32:39], v8
    s_cmp_lg_u32 s51, 0
    s_cbranch_scc1 Lh_uwhl
    s_nop 7
    s_nop 3
    v_add_f32 v16, v16, v24
    v_add_f32 v17, v17, v25
    v_add_f32 v18, v18, v26
    v_add_f32 v19, v19, v27
    v_add_f32 v20, v20, v28
    v_add_f32 v21, v21, v29
    v_add_f32 v22, v22, v30
    v_add_f32 v23, v23, v31
Lh_uwd:
    v_and_b32 v5, 1, v1
    v_cmp_eq_u32 vcc, 1, v5
    v_mov_b32 v7, 0xbfb8aa3b
    s_nop 0
    v_cndmask_b32 v7, 1.0, v7, vcc
    v_lshlrev_b32 v6, 7, v9
    v_lshl_add_u32 v6, v5, 6, v6
    s_lshl_b32 s52, s67, 8
    s_add_u32 s52, s52, 160768
    v_add_u32 v6, s52, v6
    s_nop 3
    v_mul_f32 v16, v16, v7
    v_mul_f32 v17, v17, v7
    v_mul_f32 v18, v18, v7
    v_mul_f32 v19, v19, v7
    v_mul_f32 v20, v20, v7
    v_mul_f32 v21, v21, v7
    v_mul_f32 v22, v22, v7
    v_mul_f32 v23, v23, v7
    v_mul_f32 v24, v24, v7
    v_mul_f32 v25, v25, v7
    v_mul_f32 v26, v26, v7
    v_mul_f32 v27, v27, v7
    v_mul_f32 v28, v28, v7
    v_mul_f32 v29, v29, v7
    v_mul_f32 v30, v30, v7
    v_mul_f32 v31, v31, v7
    s_mov_b32 exec_lo, 3
    s_mov_b32 exec_hi, 3
    ds_write_b128 v6, v[16:19] offset:0
    ds_write_b128 v6, v[20:23] offset:16
    ds_write_b128 v6, v[24:27] offset:32
    ds_write_b128 v6, v[28:31] offset:48
    s_mov_b64 exec, -1
    s_waitcnt lgkmcnt(0)
    s_add_u32 s61, s69, 0
    s_and_b32 s61, s61, 7
    s_mul_i32 s61, s61, 7
    s_add_u32 s61, s61, s67
    s_lshl_b32 s61, s61, 14
    s_add_u32 s61, s61, s58
    s_add_u32 m0, s59, 0
    s_add_u32 s52, s61, 0
    buffer_load_dwordx4 v10, s[20:23], s52 offen lds
    s_add_u32 m0, s59, 1024
    s_add_u32 s52, s61, 8192
    buffer_load_dwordx4 v10, s[20:23], s52 offen lds
    s_add_u32 m0, s59, 8192
    s_add_u32 s52, s61, 917504
    buffer_load_dwordx4 v10, s[20:23], s52 offen lds
    s_add_u32 m0, s59, 9216
    s_add_u32 s52, s61, 925696
    buffer_load_dwordx4 v10, s[20:23], s52 offen lds
    s_add_u32 s61, s69, 1
    s_and_b32 s61, s61, 7
    s_mul_i32 s61, s61, 7
    s_add_u32 s61, s61, s67
    s_lshl_b32 s61, s61, 14
    s_add_u32 s61, s61, s58
    s_add_u32 m0, s59, 16384
    s_add_u32 s52, s61, 0
    buffer_load_dwordx4 v10, s[20:23], s52 offen lds
    s_add_u32 m0, s59, 17408
    s_add_u32 s52, s61, 8192
    buffer_load_dwordx4 v10, s[20:23], s52 offen lds
    s_add_u32 m0, s59, 24576
    s_add_u32 s52, s61, 917504
    buffer_load_dwordx4 v10, s[20:23], s52 offen lds
    s_add_u32 m0, s59, 25600
    s_add_u32 s52, s61, 925696
    buffer_load_dwordx4 v10, s[20:23], s52 offen lds
    s_mov_b64 exec, 1
    ds_add_u32 v12, v13 offset:40
    s_mov_b64 exec, -1
    s_mov_b32 s63, 400000
Law21:
    ds_read_b32 v14, v12 offset:40
    s_sub_u32 s63, s63, 1
    s_waitcnt lgkmcnt(0)
    v_readfirstlane_b32 s50, v14
    s_nop 0
    s_cmp_eq_u32 s50, 4
    s_cbranch_scc1 Law21d
    s_sleep 1
    s_cmp_lg_u32 s63, 0
    s_cbranch_scc1 Law21
Law21d:
    s_mov_b32 s63, 400000
Law22:
    ds_read_b32 v14, v12 offset:16
    s_sub_u32 s63, s63, 1
    s_waitcnt lgkmcnt(0)
    v_readfirstlane_b32 s50, v14
    s_nop 0
    s_cmp_eq_u32 s50, 4
    s_cbranch_scc1 Law22d
    s_sleep 1
    s_cmp_lg_u32 s63, 0
    s_cbranch_scc1 Law22
Law22d:
    s_add_u32 s61, s69, 4
    s_and_b32 s61, s61, 7
    s_mul_i32 s61, s61, 7
    s_add_u32 s61, s61, s67
    s_lshl_b32 s61, s61, 14
    s_add_u32 s61, s61, s58
    s_add_u32 s52, s61, 0
    buffer_load_dwordx4 v[48:51], v10, s[20:23], s52 offen
    s_add_u32 s52, s61, 8192
    buffer_load_dwordx4 v[52:55], v10, s[20:23], s52 offen
    s_add_u32 s52, s61, 917504
    buffer_load_dwordx4 v[56:59], v10, s[20:23], s52 offen
    s_add_u32 s52, s61, 925696
    buffer_load_dwordx4 v[60:63], v10, s[20:23], s52 offen
    s_add_u32 s61, s69, 5
    s_and_b32 s61, s61, 7
    s_mul_i32 s61, s61, 7
    s_add_u32 s61, s61, s67
    s_lshl_b32 s61, s61, 14
    s_add_u32 s61, s61, s58
    s_add_u32 s52, s61, 0
    buffer_load_dwordx4 v[64:67], v10, s[20:23], s52 offen
    s_add_u32 s52, s61, 8192
    buffer_load_dwordx4 v[68:71], v10, s[20:23], s52 offen
    s_add_u32 s52, s61, 917504
    buffer_load_dwordx4 v[72:75], v10, s[20:23], s52 offen
    s_add_u32 s52, s61, 925696
    buffer_load_dwordx4 v[76:79], v10, s[20:23], s52 offen
    s_add_u32 s61, s69, 6
    s_and_b32 s61, s61, 7
    s_mul_i32 s61, s61, 7
    s_add_u32 s61, s61, s67
    s_lshl_b32 s61, s61, 14
    s_add_u32 s61, s61, s58
    s_add_u32 s52, s61, 0
    buffer_load_dwordx4 v[80:83], v10, s[20:23], s52 offen
    s_add_u32 s52, s61, 8192
    buffer_load_dwordx4 v[84:87], v10, s[20:23], s52 offen
    s_add_u32 s52, s61, 917504
    buffer_load_dwordx4 v[88:91], v10, s[20:23], s52 offen
    s_add_u32 s52, s61, 925696
    buffer_load_dwordx4 v[92:95], v10, s[20:23], s52 offen
    s_add_u32 s61, s69, 7
    s_and_b32 s61, s61, 7
    s_mul_i32 s61, s61, 7
    s_add_u32 s61, s61, s67
    s_lshl_b32 s61, s61, 14
    s_add_u32 s61, s61, s58
    s_add_u32 s52, s61, 0
    buffer_load_dwordx4 v[96:99], v10, s[20:23], s52 offen
    s_add_u32 s52, s61, 8192
    buffer_load_dwordx4 v[100:103], v10, s[20:23], s52 offen
    s_add_u32 s52, s61, 917504
    buffer_load_dwordx4 v[104:107], v10, s[20:23], s52 offen
    s_add_u32 s52, s61, 925696
    buffer_load_dwordx4 v[108:111], v10, s[20:23], s52 offen
    s_add_u32 s60, s67, 0
    s_mul_i32 s61, s60, 43
    s_lshr_b32 s61, s61, 7
    s_mul_i32 s62, s61, 3
    s_sub_u32 s60, s60, s62
    s_add_u32 s61, s61, s69
    s_and_b32 s61, s61, 7
    s_mul_i32 s61, s61, 7
    s_add_u32 s61, s61, s60
    s_add_u32 s61, s61, 4
    s_lshl_b32 s61, s61, 14
    s_add_u32 s61, s61, s58
    s_add_u32 s52, s61, 0
    buffer_load_dwordx4 v[112:115], v10, s[20:23], s52 offen
    s_add_u32 s52, s61, 8192
    buffer_load_dwordx4 v[116:119], v10, s[20:23], s52 offen
    s_add_u32 s52, s61, 917504
    buffer_load_dwordx4 v[120:123], v10, s[20:23], s52 offen
    s_add_u32 s52, s61, 925696
    buffer_load_dwordx4 v[124:127], v10, s[20:23], s52 offen
    s_add_u32 s60, s67, 4
    s_mul_i32 s61, s60, 43
    s_lshr_b32 s61, s61, 7
    s_mul_i32 s62, s61, 3
    s_sub_u32 s60, s60, s62
    s_add_u32 s61, s61, s69
    s_and_b32 s61, s61, 7
    s_mul_i32 s61, s61, 7
    s_add_u32 s61, s61, s60
    s_add_u32 s61, s61, 4
    s_lshl_b32 s61, s61, 14
    s_add_u32 s61, s61, s58
    s_add_u32 s52, s61, 0
    buffer_load_dwordx4 v[128:131], v10, s[20:23], s52 offen
    s_add_u32 s52, s61, 8192
    buffer_load_dwordx4 v[132:135], v10, s[20:23], s52 offen
    s_add_u32 s52, s61, 917504
    buffer_load_dwordx4 v[136:139], v10, s[20:23], s52 offen
    s_add_u32 s52, s61, 925696
    buffer_load_dwordx4 v[140:143], v10, s[20:23], s52 offen
    s_add_u32 s60, s67, 8
    s_mul_i32 s61, s60, 43
    s_lshr_b32 s61, s61, 7
    s_mul_i32 s62, s61, 3
    s_sub_u32 s60, s60, s62
    s_add_u32 s61, s61, s69
    s_and_b32 s61, s61, 7
    s_mul_i32 s61, s61, 7
    s_add_u32 s61, s61, s60
    s_add_u32 s61, s61, 4
    s_lshl_b32 s61, s61, 14
    s_add_u32 s61, s61, s58
    s_add_u32 s52, s61, 0
    buffer_load_dwordx4 v[144:147], v10, s[20:23], s52 offen
    s_add_u32 s52, s61, 8192
    buffer_load_dwordx4 v[148:151], v10, s[20:23], s52 offen
    s_add_u32 s52, s61, 917504
    buffer_load_dwordx4 v[152:155], v10, s[20:23], s52 offen
    s_add_u32 s52, s61, 925696
    buffer_load_dwordx4 v[156:159], v10, s[20:23], s52 offen
    s_add_u32 s60, s67, 12
    s_mul_i32 s61, s60, 43
    s_lshr_b32 s61, s61, 7
    s_mul_i32 s62, s61, 3
    s_sub_u32 s60, s60, s62
    s_add_u32 s61, s61, s69
    s_and_b32 s61, s61, 7
    s_mul_i32 s61, s61, 7
    s_add_u32 s61, s61, s60
    s_add_u32 s61, s61, 4
    s_lshl_b32 s61, s61, 14
    s_add_u32 s61, s61, s58
    s_add_u32 s52, s61, 0
    buffer_load_dwordx4 v[160:163], v10, s[20:23], s52 offen
    s_add_u32 s52, s61, 8192
    buffer_load_dwordx4 v[164:167], v10, s[20:23], s52 offen
    s_add_u32 s52, s61, 917504
    buffer_load_dwordx4 v[168:171], v10, s[20:23], s52 offen
    s_add_u32 s52, s61, 925696
    buffer_load_dwordx4 v[172:175], v10, s[20:23], s52 offen
    s_add_u32 s60, s67, 16
    s_mul_i32 s61, s60, 43
    s_lshr_b32 s61, s61, 7
    s_mul_i32 s62, s61, 3
    s_sub_u32 s60, s60, s62
    s_add_u32 s61, s61, s69
    s_and_b32 s61, s61, 7
    s_mul_i32 s61, s61, 7
    s_add_u32 s61, s61, s60
    s_add_u32 s61, s61, 4
    s_lshl_b32 s61, s61, 14
    s_add_u32 s61, s61, s58
    s_add_u32 s52, s61, 0
    buffer_load_dwordx4 v[176:179], v10, s[20:23], s52 offen
    s_add_u32 s52, s61, 8192
    buffer_load_dwordx4 v[180:183], v10, s[20:23], s52 offen
    s_add_u32 s52, s61, 917504
    buffer_load_dwordx4 v[184:187], v10, s[20:23], s52 offen
    s_add_u32 s52, s61, 925696
    buffer_load_dwordx4 v[188:191], v10, s[20:23], s52 offen
    s_add_u32 s60, s67, 20
    s_mul_i32 s61, s60, 43
    s_lshr_b32 s61, s61, 7
    s_mul_i32 s62, s61, 3
    s_sub_u32 s60, s60, s62
    s_add_u32 s61, s61, s69
    s_and_b32 s61, s61, 7
    s_mul_i32 s61, s61, 7
    s_add_u32 s61, s61, s60
    s_add_u32 s61, s61, 4
    s_lshl_b32 s61, s61, 14
    s_add_u32 s61, s61, s58
    s_add_u32 s52, s61, 0
    buffer_load_dwordx4 v[192:195], v10, s[20:23], s52 offen
    s_add_u32 s52, s61, 8192
    buffer_load_dwordx4 v[196:199], v10, s[20:23], s52 offen
    s_add_u32 s52, s61, 917504
    buffer_load_dwordx4 v[200:203], v10, s[20:23], s52 offen
    s_add_u32 s52, s61, 925696
    buffer_load_dwordx4 v[204:207], v10, s[20:23], s52 offen
    s_mov_b32 s63, 400000
Law23:
    ds_read_b32 v14, v12 offset:20
    s_sub_u32 s63, s63, 1
    s_waitcnt lgkmcnt(0)
    v_readfirstlane_b32 s50, v14
    s_nop 0
    s_cmp_eq_u32 s50, 4
    s_cbranch_scc1 Law23d
    s_sleep 1
    s_cmp_lg_u32 s63, 0
    s_cbranch_scc1 Law23
Law23d:
    v_add_u32 v4, s59, v2
    v_add_u32 v5, 0x10000, v4
    v_add_u32 v6, 0x20000, v4
    s_add_u32 s61, s69, 2
    s_and_b32 s61, s61, 7
    s_mul_i32 s61, s61, 7
    s_add_u32 s61, s61, s67
    s_lshl_b32 s61, s61, 14
    s_add_u32 s61, s61, s58
    s_add_u32 m0, s59, 32768
    s_add_u32 s52, s61, 0
    buffer_load_dwordx4 v10, s[20:23], s52 offen lds
    s_add_u32 m0, s59, 33792
    s_add_u32 s52, s61, 8192
    buffer_load_dwordx4 v10, s[20:23], s52 offen lds
    s_add_u32 m0, s59, 40960
    s_add_u32 s52, s61, 917504
    buffer_load_dwordx4 v10, s[20:23], s52 offen lds
    s_add_u32 m0, s59, 41984
    s_add_u32 s52, s61, 925696
    buffer_load_dwordx4 v10, s[20:23], s52 offen lds
    s_waitcnt vmcnt(44)
    s_add_u32 s61, s69, 3
    s_and_b32 s61, s61, 7
    s_mul_i32 s61, s61, 7
    s_add_u32 s61, s61, s67
    s_lshl_b32 s61, s61, 14
    s_add_u32 s61, s61, s58
    s_add_u32 m0, s59, 49152
    s_add_u32 s52, s61, 0
    buffer_load_dwordx4 v10, s[20:23], s52 offen lds
    s_add_u32 m0, s59, 50176
    s_add_u32 s52, s61, 8192
    buffer_load_dwordx4 v10, s[20:23], s52 offen lds
    s_add_u32 m0, s59, 57344
    s_add_u32 s52, s61, 917504
    buffer_load_dwordx4 v10, s[20:23], s52 offen lds
    s_add_u32 m0, s59, 58368
    s_add_u32 s52, s61, 925696
    buffer_load_dwordx4 v10, s[20:23], s52 offen lds
    s_waitcnt vmcnt(4)
    ds_write_b128 v5, v[48:51] offset:0
    ds_write_b128 v5, v[52:55] offset:1024
    ds_write_b128 v5, v[56:59] offset:8192
    ds_write_b128 v5, v[60:63] offset:9216
    ds_write_b128 v5, v[64:67] offset:16384
    ds_write_b128 v5, v[68:71] offset:17408
    ds_write_b128 v5, v[72:75] offset:24576
    ds_write_b128 v5, v[76:79] offset:25600
    s_waitcnt lgkmcnt(4)
    ds_write_b128 v5, v[80:83] offset:32768
    ds_write_b128 v5, v[84:87] offset:33792
    ds_write_b128 v5, v[88:91] offset:40960
    ds_write_b128 v5, v[92:95] offset:41984
    ds_write_b128 v5, v[96:99] offset:49152
    ds_write_b128 v5, v[100:103] offset:50176
    ds_write_b128 v5, v[104:107] offset:57344
    ds_write_b128 v5, v[108:111] offset:58368
    s_waitcnt lgkmcnt(4)
    ds_write_b128 v6, v[112:115] offset:0
    ds_write_b128 v6, v[116:119] offset:1024
    ds_write_b128 v6, v[120:123] offset:8192
    ds_write_b128 v6, v[124:127] offset:9216
    s_waitcnt vmcnt(0)
    s_waitcnt lgkmcnt(0)
    s_barrier
    s_mov_b32 s63, 400000
Law24:
    ds_read_b32 v14, v12 offset:24
    s_sub_u32 s63, s63, 1
    s_waitcnt lgkmcnt(0)
    v_readfirstlane_b32 s50, v14
    s_nop 0
    s_cmp_eq_u32 s50, 4
    s_cbranch_scc1 Law24d
    s_sleep 1
    s_cmp_lg_u32 s63, 0
    s_cbranch_scc1 Law24
Law24d:
    ds_write_b128 v4, v[128:131] offset:0
    ds_write_b128 v4, v[132:135] offset:1024
    ds_write_b128 v4, v[136:139] offset:8192
    ds_write_b128 v4, v[140:143] offset:9216
    ds_write_b128 v4, v[144:147] offset:16384
    ds_write_b128 v4, v[148:151] offset:17408
    ds_write_b128 v4, v[152:155] offset:24576
    ds_write_b128 v4, v[156:159] offset:25600
    ds_write_b128 v4, v[160:163] offset:32768
    ds_write_b128 v4, v[164:167] offset:33792
    ds_write_b128 v4, v[168:171] offset:40960
    ds_write_b128 v4, v[172:175] offset:41984
    s_waitcnt lgkmcnt(0)
    s_mov_b64 exec, 1
    ds_add_u32 v12, v13 offset:32
    s_mov_b64 exec, -1
    s_mov_b32 s63, 400000
Law25:
    ds_read_b32 v14, v12 offset:28
    s_sub_u32 s63, s63, 1
    s_waitcnt lgkmcnt(0)
    v_readfirstlane_b32 s50, v14
    s_nop 0
    s_cmp_eq_u32 s50, 4
    s_cbranch_scc1 Law25d
    s_sleep 1
    s_cmp_lg_u32 s63, 0
    s_cbranch_scc1 Law25
Law25d:
    ds_write_b128 v4, v[176:179] offset:49152
    ds_write_b128 v4, v[180:183] offset:50176
    ds_write_b128 v4, v[184:187] offset:57344
    ds_write_b128 v4, v[188:191] offset:58368
    ds_write_b128 v5, v[192:195] offset:0
    ds_write_b128 v5, v[196:199] offset:1024
    ds_write_b128 v5, v[200:203] offset:8192
    ds_write_b128 v5, v[204:207] offset:9216
    s_waitcnt lgkmcnt(0)
    s_mov_b64 exec, 1
    ds_add_u32 v12, v13 offset:36
    s_mov_b64 exec, -1
    s_barrier
    s_endpgm
Lslow:
    v_lshrrev_b32 v5, 3, v1
    v_lshlrev_b32 v5, 5, v5
    v_and_or_b32 v5, v1, 7, v5
    v_lshlrev_b32 v5, 2, v5
    s_lshr_b32 s52, s58, 2
    s_lshl_b32 s52, s52, 11
    s_add_u32 s62, s52, 0x52000
    s_mov_b64 exec, -1
    s_mov_b32 s50, 20000
Lpoll26:
    buffer_load_dword v6, v5, s[40:43], s62 offen sc1
    s_waitcnt vmcnt(0)
    v_cmp_ne_u32 vcc, s47, v6
    s_sub_u32 s50, s50, 1
    s_cbranch_vccz Lpolld26
    s_cmp_lg_u32 s50, 0
    s_cbranch_scc1 Lpoll26
Lpolld26:
    s_mov_b64 exec, -1
    s_add_u32 s62, s62, 1024
    s_mov_b64 exec, -1
    s_mov_b32 s50, 20000
Lpoll27:
    buffer_load_dword v6, v5, s[40:43], s62 offen sc1
    s_waitcnt vmcnt(0)
    v_cmp_ne_u32 vcc, s47, v6
    s_sub_u32 s50, s50, 1
    s_cbranch_vccz Lpolld27
    s_cmp_lg_u32 s50, 0
    s_cbranch_scc1 Lpoll27
Lpolld27:
    s_mov_b64 exec, -1
    s_waitcnt vmcnt(0)
    s_add_u32 s56, s59, 0x400000
    s_mov_b32 s51, 64
    v_mov_b32 v8, 0xff800000
Ls1:
    buffer_load_dwordx4 v[128:131], v2, s[40:43], s56 offen sc1
    s_add_u32 s56, s56, 1024
    s_waitcnt vmcnt(0)
    v_mfma_f32_32x32x16_bf16 v[96:111], v[128:131], v[16:19], 0
    s_nop 11
    v_max3_f32 v8, v96, v97, v8
    v_max3_f32 v8, v98, v99, v8
    v_max3_f32 v8, v100, v101, v8
    v_max3_f32 v8, v102, v103, v8
    v_max3_f32 v8, v104, v105, v8
    v_max3_f32 v8, v106, v107, v8
    v_max3_f32 v8, v108, v109, v8
    v_max3_f32 v8, v110, v111, v8
    s_sub_u32 s51, s51, 1
    s_cmp_lg_u32 s51, 0
    s_cbranch_scc1 Ls1
    v_mov_b32 v9, v8
    s_nop 1
    v_permlane32_swap_b32 v8, v9
    v_max_f32 v8, v8, v9
    v_sub_f32 v112, 0, v8
    v_sub_f32 v113, 0, v8
    v_sub_f32 v114, 0, v8
    v_sub_f32 v115, 0, v8
    v_sub_f32 v116, 0, v8
    v_sub_f32 v117, 0, v8
    v_sub_f32 v118, 0, v8
    v_sub_f32 v119, 0, v8
    v_sub_f32 v120, 0, v8
    v_sub_f32 v121, 0, v8
    v_sub_f32 v122, 0, v8
    v_sub_f32 v123, 0, v8
    v_sub_f32 v124, 0, v8
    v_sub_f32 v125, 0, v8
    v_sub_f32 v126, 0, v8
    v_sub_f32 v127, 0, v8
    v_mov_b32 v32, 0
    v_mov_b32 v33, 0
    v_mov_b32 v34, 0
    v_mov_b32 v35, 0
    v_mov_b32 v36, 0
    v_mov_b32 v37, 0
    v_mov_b32 v38, 0
    v_mov_b32 v39, 0
    v_mov_b32 v40, 0
    v_mov_b32 v41, 0
    v_mov_b32 v42, 0
    v_mov_b32 v43, 0
    v_mov_b32 v44, 0
    v_mov_b32 v45, 0
    v_mov_b32 v46, 0
    v_mov_b32 v47, 0
    s_add_u32 s56, s59, 0x400000
    s_add_u32 s57, s59, 0x600000
    s_mov_b32 s51, 64
Ls2:
    buffer_load_dwordx4 v[128:131], v2, s[40:43], s56 offen sc1
    s_mov_b64 exec, s[60:61]
    buffer_load_dwordx4 v[132:135], v4, s[40:43], s57 offen sc1
    buffer_load_dwordx4 v[136:139], v4, s[40:43], s57 offen offset:512 sc1
    s_mov_b64 exec, -1
    s_add_u32 s56, s56, 1024
    s_add_u32 s57, s57, 1024
    s_waitcnt vmcnt(0)
    v_mfma_f32_32x32x16_bf16 v[96:111], v[128:131], v[16:19], v[112:127]
    s_nop 11
    v_exp_f32 v96, v96
    v_exp_f32 v97, v97
    v_exp_f32 v98, v98
    v_exp_f32 v99, v99
    v_exp_f32 v100, v100
    v_exp_f32 v101, v101
    v_exp_f32 v102, v102
    v_exp_f32 v103, v103
    v_exp_f32 v104, v104
    v_exp_f32 v105, v105
    v_exp_f32 v106, v106
    v_exp_f32 v107, v107
    v_exp_f32 v108, v108
    v_exp_f32 v109, v109
    v_exp_f32 v110, v110
    v_exp_f32 v111, v111
    v_smfmac_f32_32x32x32_bf16 v[32:47], v[132:135], v[96:103], v176
    s_nop 0
    v_smfmac_f32_32x32x32_bf16 v[32:47], v[136:139], v[104:111], v176
    s_sub_u32 s51, s51, 1
    s_cmp_lg_u32 s51, 0
    s_cbranch_scc1 Ls2
    s_nop 7
    s_nop 7
    v_rcp_f32 v8, v40
    s_nop 0
    s_branch Lnorm
Lend:
    s_endpgm
Lcode_end:
.section .rodata,"a"
.p2align 6
.amdhsa_kernel adaLN_cond__softmax_full_mha__dense_activation_silu__prompt_kernel
  .amdhsa_next_free_vgpr 256
  .amdhsa_next_free_sgpr 102
  .amdhsa_accum_offset 256
  .amdhsa_group_segment_fixed_size 0
  .amdhsa_kernarg_size 88
  .amdhsa_user_sgpr_count 2
  .amdhsa_user_sgpr_kernarg_segment_ptr 1
  .amdhsa_system_sgpr_workgroup_id_x 1
  .amdhsa_float_denorm_mode_32 3
.end_amdhsa_kernel
```
